```python
import torch

def _softmax(x, axis=-1):
    return torch.softmax(x, dim=axis)

def _gelu(x):
    return torch.nn.functional.gelu(x, approximate='tanh')

def _silu(x):
    return torch.nn.functional.silu(x)

def _sigmoid(x):
    return torch.sigmoid(x)

def _layernorm(x, axis=-1, eps=1e-05):
    m = x.mean(dim=axis, keepdim=True)
    v = x.var(dim=axis, keepdim=True, unbiased=False)
    return (x - m) / torch.sqrt(v + eps)

def _scatter_add(tgt, idx, src, axis=0):
    return tgt.clone().index_add_(axis, idx, src)

def _segment_sum(src, seg, n):
    out = torch.zeros((n,) + src.shape[1:], dtype=src.dtype)
    return out.index_add_(0, seg, src)

def _pad(x, pw):
    flat = tuple((v for pair in reversed(pw) for v in pair))
    return torch.nn.functional.pad(x, flat)
kernel_name = 'adaLN_cond__ssm_conv_s4__mixer_gmlp__prompt'

def setup_inputs():

    _w = lambda a: (lambda t: t.to(torch.bfloat16) if t.is_floating_point() else t)(torch.as_tensor(a))

    def _A_setup():
        B, L, D, N = (1, 2048, 576, 128)
        A_re = -(lambda _x: torch.exp(torch.as_tensor(_x)))((lambda *s: torch.randn(*s, dtype=torch.bfloat16) * 3.2)(D, N))
        A_im = torch.pi * (lambda *s: torch.randn(*s, dtype=torch.bfloat16) * 0.1)(D, N)
        B_re = (lambda *s: torch.randn(*s, dtype=torch.bfloat16) * 0.2)(D, N)
        B_im = (lambda *s: torch.randn(*s, dtype=torch.bfloat16) * 0.2)(D, N)
        C_re = (lambda *s: torch.randn(*s, dtype=torch.bfloat16) * 0.2)(D, N)
        C_im = (lambda *s: torch.randn(*s, dtype=torch.bfloat16) * 0.2)(D, N)
        log_dt = (lambda *s: torch.randn(*s, dtype=torch.bfloat16) * 0.1)(D) * 0.5 - 4.0
        Dskip = (lambda *s: torch.randn(*s, dtype=torch.bfloat16) * 0.2)(D)
        return {'u': _w((lambda *s: torch.randn(*s, dtype=torch.bfloat16) * 0.05)(B, L, D)), 'A_re': _w(A_re), 'A_im': _w(A_im), 'B_re': _w(B_re), 'B_im': _w(B_im), 'C_re': _w(C_re), 'C_im': _w(C_im), 'log_dt': _w(log_dt), 'Dskip': _w(Dskip)}
    _A_in = _A_setup()

    def _B_setup():
        B, S, D, F = (1, 2048, 576, 4608)
        Fh = F // 2
        return {'x': _w((lambda *s: torch.randn(*s, dtype=torch.bfloat16) * 0.05)(B, S, D)), 'w_in': _w((lambda *s: torch.randn(*s, dtype=torch.bfloat16) * 0.2)(D, 2 * Fh)), 'w_sp': _w(0.01 * (lambda *s: torch.randn(*s, dtype=torch.bfloat16) * 0.2)(S, S)), 'b_sp': _w(1.0 + 0.01 * (lambda *s: torch.randn(*s, dtype=torch.bfloat16) * 0.05)(S)), 'w_out': _w((lambda *s: torch.randn(*s, dtype=torch.bfloat16) * 0.05)(Fh, D))}
    _B_in = _B_setup()
    return {'A_u': _A_in['u'], 'A_A_re': _A_in['A_re'], 'A_A_im': _A_in['A_im'], 'A_B_re': _A_in['B_re'], 'A_B_im': _A_in['B_im'], 'A_C_re': _A_in['C_re'], 'A_C_im': _A_in['C_im'], 'A_log_dt': _A_in['log_dt'], 'A_Dskip': _A_in['Dskip'], 'B_x': _B_in['x'], 'B_w_in': _B_in['w_in'], 'B_w_sp': _B_in['w_sp'], 'B_b_sp': _B_in['b_sp'], 'B_w_out': _B_in['w_out'], 'c': _w((lambda *s: torch.randn(*s, dtype=torch.bfloat16) * 0.1)(1, 576) * 8.0), 'w_mod': _w((lambda *s: torch.randn(*s, dtype=torch.bfloat16) * 0.1)(576, 6 * 576) * 576 ** (-0.5) * 8.0)}

def reference(A_u, A_A_re, A_A_im, A_B_re, A_B_im, A_C_re, A_C_im, A_log_dt, A_Dskip, B_x, B_w_in, B_w_sp, B_b_sp, B_w_out, c, w_mod):

    def _A_ref(u, A_re, A_im, B_re, B_im, C_re, C_im, log_dt, Dskip):
        Bsz, L, D = u.shape
        dt = torch.exp(log_dt)[:, None]
        A = A_re + 1j * A_im
        Bc = B_re + 1j * B_im
        Cc = C_re + 1j * C_im
        logdA = dt * A
        dB = dt * Bc
        l = (lambda x, dt: x.to(dt))(torch.arange(L), A_re.dtype)
        P = torch.exp(logdA[:, :, None] * l[None, None, :])
        K = torch.einsum('dn,dnl,dn->dl', Cc, P, dB).real
        L2 = 2 * L
        Kp = _pad(K, ((0, 0), (0, L)))
        up = (lambda x, *d: x.permute(*d))(u, 0, 2, 1)
        up = _pad(up, ((0, 0), (0, 0), (0, L)))
        Kf = (lambda x, axes=(-2, -1): torch.fft.rfft2(x.float(), dim=axes))(Kp[:, None, :], axes=(-2, -1))
        Uf = (lambda x, axes=(-2, -1): torch.fft.rfft2(x.float(), dim=axes))(up[:, :, None, :], axes=(-2, -1))
        Yf = Uf * Kf[None, :, :, :]
        y = (lambda x, s, axes=(-2, -1): torch.fft.irfft2(x, s=s, dim=axes).to(torch.bfloat16))(Yf, (1, L2), axes=(-2, -1))[:, :, 0, :L]
        y = (lambda x, *d: x.permute(*d))(y, 0, 2, 1) + u * Dskip[None, None, :]
        return y

    def _B_ref(x, w_in, w_sp, b_sp, w_out):
        B, S, D = x.shape
        F = w_in.shape[-1]
        Fh = F // 2
        z = _gelu(torch.einsum('bsd,df->bsf', x, w_in))
        z1 = z[..., :Fh].clone()
        z2 = _layernorm(z[..., Fh:], axis=-1)
        g = torch.einsum('ts,bsf->btf', w_sp, z2) + b_sp[None, :, None]
        return torch.einsum('bsf,fd->bsd', z1 * g, w_out)
    x = A_u
    mod = (_silu(c) @ w_mod).reshape(c.shape[0], 6, 1, -1)
    sa, ca, ga, sb, cb, gb = (mod[:, 0].clone(), mod[:, 1].clone(), mod[:, 2].clone(), mod[:, 3].clone(), mod[:, 4].clone(), mod[:, 5].clone())
    h = _layernorm(x, axis=-1) * (1 + ca) + sa
    x = x + ga * _A_ref(h, A_A_re, A_A_im, A_B_re, A_B_im, A_C_re, A_C_im, A_log_dt, A_Dskip)
    h = _layernorm(x, axis=-1) * (1 + cb) + sb
    x = x + gb * _B_ref(h, B_w_in, B_w_sp, B_b_sp, B_w_out)
    return x
```

```asm
; @launch kernel=front_kernel grid=(758,1,1) block=(256,1,1) lds=52744
; @launch kernel=back_kernel grid=(256,1,1) block=(512,1,1) lds=144640
.amdgcn_target "amdgcn-amd-amdhsa--gfx950"
.text
.globl front_kernel
.p2align 8
.type front_kernel,@function
front_kernel:
    s_cmp_ge_u32 s2, 758
    s_cbranch_scc1 front_kernel_end
    s_load_dwordx2 s[6:7], s[0:1], 144
    s_load_dwordx2 s[58:59], s[0:1], 136
    v_mov_b32 v159, v0
    v_lshrrev_b32 v1, 6, v0
    v_and_b32 v2, 63, v0
    s_cmp_ge_u32 s2, 182
    v_readfirstlane_b32 s17, v1
    s_cbranch_scc1 front_kernel_C
    s_setprio 3
    s_cmp_lt_u32 s2, 64
    s_cbranch_scc1 front_kernel_B
    s_cmp_ge_u32 s2, 172
    s_cbranch_scc1 front_kernel_svc0
    s_sub_u32 s12, s2, 64
    s_load_dwordx2 s[8:9], s[0:1], 120
    s_load_dwordx2 s[10:11], s[0:1], 112
    v_lshrrev_b32 v3, 2, v0
    v_and_b32 v4, 3, v0
    v_mul_u32_u24 v5, 6912, v3
    v_lshlrev_b32 v6, 4, v4
    v_add_u32 v5, v5, v6
    v_lshlrev_b32 v6, 1, v3
    s_and_b32 s20, s12, 7
    s_lshr_b32 s21, s12, 3
    s_lshr_b32 s22, s21, 1
    s_lshl_b32 s22, s22, 3
    s_add_u32 s20, s20, s22
    s_lshl_b32 s20, s20, 1
    s_and_b32 s21, s21, 1
    s_add_u32 s20, s20, s21
    s_cmp_lt_u32 s12, 96
    s_cselect_b32 s12, s20, s12
    s_lshl_b32 s20, s12, 6
    s_waitcnt lgkmcnt(0)
    s_mov_b32 s48, s8
    s_and_b32 s49, s9, 0xffff
    s_mov_b32 s50, 3981312
    s_mov_b32 s51, 0x20000
    s_mov_b32 s52, s10
    s_and_b32 s53, s11, 0xffff
    s_mov_b32 s54, 1152
    s_mov_b32 s55, 0x20000
    s_add_u32 s21, s20, 0
    buffer_load_dwordx4 v[8:11], v5, s[48:51], s21 offen
    s_add_u32 s21, s20, 442368
    buffer_load_dwordx4 v[12:15], v5, s[48:51], s21 offen
    s_add_u32 s21, s20, 884736
    buffer_load_dwordx4 v[16:19], v5, s[48:51], s21 offen
    s_add_u32 s21, s20, 1327104
    buffer_load_dwordx4 v[20:23], v5, s[48:51], s21 offen
    s_add_u32 s21, s20, 1769472
    buffer_load_dwordx4 v[24:27], v5, s[48:51], s21 offen
    s_add_u32 s21, s20, 2211840
    buffer_load_dwordx4 v[28:31], v5, s[48:51], s21 offen
    s_add_u32 s21, s20, 2654208
    buffer_load_dwordx4 v[32:35], v5, s[48:51], s21 offen
    s_add_u32 s21, s20, 3096576
    buffer_load_dwordx4 v[36:39], v5, s[48:51], s21 offen
    s_add_u32 s21, s20, 3538944
    buffer_load_dwordx4 v[40:43], v5, s[48:51], s21 offen
    buffer_load_ushort v80, v6, s[52:55], 0 offen offset:0
    buffer_load_ushort v81, v6, s[52:55], 0 offen offset:128
    buffer_load_ushort v82, v6, s[52:55], 0 offen offset:256
    buffer_load_ushort v83, v6, s[52:55], 0 offen offset:384
    buffer_load_ushort v84, v6, s[52:55], 0 offen offset:512
    buffer_load_ushort v85, v6, s[52:55], 0 offen offset:640
    buffer_load_ushort v86, v6, s[52:55], 0 offen offset:768
    buffer_load_ushort v87, v6, s[52:55], 0 offen offset:896
    buffer_load_ushort v88, v6, s[52:55], 0 offen offset:1024
    v_mov_b32 v100, 0
    v_mov_b32 v101, 0
    v_mov_b32 v102, 0
    v_mov_b32 v103, 0
    v_mov_b32 v104, 0
    v_mov_b32 v105, 0
    v_mov_b32 v106, 0
    v_mov_b32 v107, 0
    s_waitcnt vmcnt(0)
    v_lshlrev_b32 v80, 16, v80
    v_lshlrev_b32 v81, 16, v81
    v_lshlrev_b32 v82, 16, v82
    v_lshlrev_b32 v83, 16, v83
    v_lshlrev_b32 v84, 16, v84
    v_lshlrev_b32 v85, 16, v85
    v_lshlrev_b32 v86, 16, v86
    v_lshlrev_b32 v87, 16, v87
    v_lshlrev_b32 v88, 16, v88
    v_mul_f32 v108, 0xbfb8aa3b, v80
    v_mul_f32 v109, 0xbfb8aa3b, v81
    v_mul_f32 v110, 0xbfb8aa3b, v82
    v_mul_f32 v111, 0xbfb8aa3b, v83
    v_mul_f32 v112, 0xbfb8aa3b, v84
    v_mul_f32 v113, 0xbfb8aa3b, v85
    v_mul_f32 v114, 0xbfb8aa3b, v86
    v_mul_f32 v115, 0xbfb8aa3b, v87
    v_mul_f32 v116, 0xbfb8aa3b, v88
    v_exp_f32 v108, v108
    v_exp_f32 v109, v109
    v_exp_f32 v110, v110
    v_exp_f32 v111, v111
    v_exp_f32 v112, v112
    v_exp_f32 v113, v113
    v_exp_f32 v114, v114
    v_exp_f32 v115, v115
    v_exp_f32 v116, v116
    v_add_f32 v108, 1.0, v108
    v_add_f32 v109, 1.0, v109
    v_add_f32 v110, 1.0, v110
    v_add_f32 v111, 1.0, v111
    v_add_f32 v112, 1.0, v112
    v_add_f32 v113, 1.0, v113
    v_add_f32 v114, 1.0, v114
    v_add_f32 v115, 1.0, v115
    v_add_f32 v116, 1.0, v116
    v_rcp_f32 v108, v108
    v_rcp_f32 v109, v109
    v_rcp_f32 v110, v110
    v_rcp_f32 v111, v111
    v_rcp_f32 v112, v112
    v_rcp_f32 v113, v113
    v_rcp_f32 v114, v114
    v_rcp_f32 v115, v115
    v_rcp_f32 v116, v116
    s_nop 0
    v_mul_f32 v80, v80, v108
    v_mul_f32 v81, v81, v109
    v_mul_f32 v82, v82, v110
    v_mul_f32 v83, v83, v111
    v_mul_f32 v84, v84, v112
    v_mul_f32 v85, v85, v113
    v_mul_f32 v86, v86, v114
    v_mul_f32 v87, v87, v115
    v_mul_f32 v88, v88, v116
    v_cvt_pk_bf16_f32 v80, v80, v80
    v_cvt_pk_bf16_f32 v81, v81, v81
    v_cvt_pk_bf16_f32 v82, v82, v82
    v_cvt_pk_bf16_f32 v83, v83, v83
    v_cvt_pk_bf16_f32 v84, v84, v84
    v_cvt_pk_bf16_f32 v85, v85, v85
    v_cvt_pk_bf16_f32 v86, v86, v86
    v_cvt_pk_bf16_f32 v87, v87, v87
    v_cvt_pk_bf16_f32 v88, v88, v88
    v_lshlrev_b32 v80, 16, v80
    v_lshlrev_b32 v81, 16, v81
    v_lshlrev_b32 v82, 16, v82
    v_lshlrev_b32 v83, 16, v83
    v_lshlrev_b32 v84, 16, v84
    v_lshlrev_b32 v85, 16, v85
    v_lshlrev_b32 v86, 16, v86
    v_lshlrev_b32 v87, 16, v87
    v_lshlrev_b32 v88, 16, v88
    v_lshlrev_b32 v108, 16, v8
    v_and_b32 v109, 0xffff0000, v8
    v_lshlrev_b32 v110, 16, v9
    v_and_b32 v111, 0xffff0000, v9
    v_lshlrev_b32 v112, 16, v10
    v_and_b32 v113, 0xffff0000, v10
    v_lshlrev_b32 v114, 16, v11
    v_and_b32 v115, 0xffff0000, v11
    v_pk_fma_f32 v[100:101], v[80:81], v[108:109], v[100:101] op_sel_hi:[0,1,1]
    v_pk_fma_f32 v[102:103], v[80:81], v[110:111], v[102:103] op_sel_hi:[0,1,1]
    v_pk_fma_f32 v[104:105], v[80:81], v[112:113], v[104:105] op_sel_hi:[0,1,1]
    v_pk_fma_f32 v[106:107], v[80:81], v[114:115], v[106:107] op_sel_hi:[0,1,1]
    v_lshlrev_b32 v108, 16, v12
    v_and_b32 v109, 0xffff0000, v12
    v_lshlrev_b32 v110, 16, v13
    v_and_b32 v111, 0xffff0000, v13
    v_lshlrev_b32 v112, 16, v14
    v_and_b32 v113, 0xffff0000, v14
    v_lshlrev_b32 v114, 16, v15
    v_and_b32 v115, 0xffff0000, v15
    v_pk_fma_f32 v[100:101], v[80:81], v[108:109], v[100:101] op_sel:[1,0,0]
    v_pk_fma_f32 v[102:103], v[80:81], v[110:111], v[102:103] op_sel:[1,0,0]
    v_pk_fma_f32 v[104:105], v[80:81], v[112:113], v[104:105] op_sel:[1,0,0]
    v_pk_fma_f32 v[106:107], v[80:81], v[114:115], v[106:107] op_sel:[1,0,0]
    v_lshlrev_b32 v108, 16, v16
    v_and_b32 v109, 0xffff0000, v16
    v_lshlrev_b32 v110, 16, v17
    v_and_b32 v111, 0xffff0000, v17
    v_lshlrev_b32 v112, 16, v18
    v_and_b32 v113, 0xffff0000, v18
    v_lshlrev_b32 v114, 16, v19
    v_and_b32 v115, 0xffff0000, v19
    v_pk_fma_f32 v[100:101], v[82:83], v[108:109], v[100:101] op_sel_hi:[0,1,1]
    v_pk_fma_f32 v[102:103], v[82:83], v[110:111], v[102:103] op_sel_hi:[0,1,1]
    v_pk_fma_f32 v[104:105], v[82:83], v[112:113], v[104:105] op_sel_hi:[0,1,1]
    v_pk_fma_f32 v[106:107], v[82:83], v[114:115], v[106:107] op_sel_hi:[0,1,1]
    v_lshlrev_b32 v108, 16, v20
    v_and_b32 v109, 0xffff0000, v20
    v_lshlrev_b32 v110, 16, v21
    v_and_b32 v111, 0xffff0000, v21
    v_lshlrev_b32 v112, 16, v22
    v_and_b32 v113, 0xffff0000, v22
    v_lshlrev_b32 v114, 16, v23
    v_and_b32 v115, 0xffff0000, v23
    v_pk_fma_f32 v[100:101], v[82:83], v[108:109], v[100:101] op_sel:[1,0,0]
    v_pk_fma_f32 v[102:103], v[82:83], v[110:111], v[102:103] op_sel:[1,0,0]
    v_pk_fma_f32 v[104:105], v[82:83], v[112:113], v[104:105] op_sel:[1,0,0]
    v_pk_fma_f32 v[106:107], v[82:83], v[114:115], v[106:107] op_sel:[1,0,0]
    v_lshlrev_b32 v108, 16, v24
    v_and_b32 v109, 0xffff0000, v24
    v_lshlrev_b32 v110, 16, v25
    v_and_b32 v111, 0xffff0000, v25
    v_lshlrev_b32 v112, 16, v26
    v_and_b32 v113, 0xffff0000, v26
    v_lshlrev_b32 v114, 16, v27
    v_and_b32 v115, 0xffff0000, v27
    v_pk_fma_f32 v[100:101], v[84:85], v[108:109], v[100:101] op_sel_hi:[0,1,1]
    v_pk_fma_f32 v[102:103], v[84:85], v[110:111], v[102:103] op_sel_hi:[0,1,1]
    v_pk_fma_f32 v[104:105], v[84:85], v[112:113], v[104:105] op_sel_hi:[0,1,1]
    v_pk_fma_f32 v[106:107], v[84:85], v[114:115], v[106:107] op_sel_hi:[0,1,1]
    v_lshlrev_b32 v108, 16, v28
    v_and_b32 v109, 0xffff0000, v28
    v_lshlrev_b32 v110, 16, v29
    v_and_b32 v111, 0xffff0000, v29
    v_lshlrev_b32 v112, 16, v30
    v_and_b32 v113, 0xffff0000, v30
    v_lshlrev_b32 v114, 16, v31
    v_and_b32 v115, 0xffff0000, v31
    v_pk_fma_f32 v[100:101], v[84:85], v[108:109], v[100:101] op_sel:[1,0,0]
    v_pk_fma_f32 v[102:103], v[84:85], v[110:111], v[102:103] op_sel:[1,0,0]
    v_pk_fma_f32 v[104:105], v[84:85], v[112:113], v[104:105] op_sel:[1,0,0]
    v_pk_fma_f32 v[106:107], v[84:85], v[114:115], v[106:107] op_sel:[1,0,0]
    v_lshlrev_b32 v108, 16, v32
    v_and_b32 v109, 0xffff0000, v32
    v_lshlrev_b32 v110, 16, v33
    v_and_b32 v111, 0xffff0000, v33
    v_lshlrev_b32 v112, 16, v34
    v_and_b32 v113, 0xffff0000, v34
    v_lshlrev_b32 v114, 16, v35
    v_and_b32 v115, 0xffff0000, v35
    v_pk_fma_f32 v[100:101], v[86:87], v[108:109], v[100:101] op_sel_hi:[0,1,1]
    v_pk_fma_f32 v[102:103], v[86:87], v[110:111], v[102:103] op_sel_hi:[0,1,1]
    v_pk_fma_f32 v[104:105], v[86:87], v[112:113], v[104:105] op_sel_hi:[0,1,1]
    v_pk_fma_f32 v[106:107], v[86:87], v[114:115], v[106:107] op_sel_hi:[0,1,1]
    v_lshlrev_b32 v108, 16, v36
    v_and_b32 v109, 0xffff0000, v36
    v_lshlrev_b32 v110, 16, v37
    v_and_b32 v111, 0xffff0000, v37
    v_lshlrev_b32 v112, 16, v38
    v_and_b32 v113, 0xffff0000, v38
    v_lshlrev_b32 v114, 16, v39
    v_and_b32 v115, 0xffff0000, v39
    v_pk_fma_f32 v[100:101], v[86:87], v[108:109], v[100:101] op_sel:[1,0,0]
    v_pk_fma_f32 v[102:103], v[86:87], v[110:111], v[102:103] op_sel:[1,0,0]
    v_pk_fma_f32 v[104:105], v[86:87], v[112:113], v[104:105] op_sel:[1,0,0]
    v_pk_fma_f32 v[106:107], v[86:87], v[114:115], v[106:107] op_sel:[1,0,0]
    v_lshlrev_b32 v108, 16, v40
    v_and_b32 v109, 0xffff0000, v40
    v_lshlrev_b32 v110, 16, v41
    v_and_b32 v111, 0xffff0000, v41
    v_lshlrev_b32 v112, 16, v42
    v_and_b32 v113, 0xffff0000, v42
    v_lshlrev_b32 v114, 16, v43
    v_and_b32 v115, 0xffff0000, v43
    v_pk_fma_f32 v[100:101], v[88:89], v[108:109], v[100:101] op_sel_hi:[0,1,1]
    v_pk_fma_f32 v[102:103], v[88:89], v[110:111], v[102:103] op_sel_hi:[0,1,1]
    v_pk_fma_f32 v[104:105], v[88:89], v[112:113], v[104:105] op_sel_hi:[0,1,1]
    v_pk_fma_f32 v[106:107], v[88:89], v[114:115], v[106:107] op_sel_hi:[0,1,1]
    s_nop 1
    v_add_f32_dpp v100, v100, v100 row_ror:4 row_mask:0xf bank_mask:0xf
    v_add_f32_dpp v101, v101, v101 row_ror:4 row_mask:0xf bank_mask:0xf
    v_add_f32_dpp v102, v102, v102 row_ror:4 row_mask:0xf bank_mask:0xf
    v_add_f32_dpp v103, v103, v103 row_ror:4 row_mask:0xf bank_mask:0xf
    v_add_f32_dpp v104, v104, v104 row_ror:4 row_mask:0xf bank_mask:0xf
    v_add_f32_dpp v105, v105, v105 row_ror:4 row_mask:0xf bank_mask:0xf
    v_add_f32_dpp v106, v106, v106 row_ror:4 row_mask:0xf bank_mask:0xf
    v_add_f32_dpp v107, v107, v107 row_ror:4 row_mask:0xf bank_mask:0xf
    v_add_f32_dpp v100, v100, v100 row_ror:8 row_mask:0xf bank_mask:0xf
    v_add_f32_dpp v101, v101, v101 row_ror:8 row_mask:0xf bank_mask:0xf
    v_add_f32_dpp v102, v102, v102 row_ror:8 row_mask:0xf bank_mask:0xf
    v_add_f32_dpp v103, v103, v103 row_ror:8 row_mask:0xf bank_mask:0xf
    v_add_f32_dpp v104, v104, v104 row_ror:8 row_mask:0xf bank_mask:0xf
    v_add_f32_dpp v105, v105, v105 row_ror:8 row_mask:0xf bank_mask:0xf
    v_add_f32_dpp v106, v106, v106 row_ror:8 row_mask:0xf bank_mask:0xf
    v_add_f32_dpp v107, v107, v107 row_ror:8 row_mask:0xf bank_mask:0xf
    v_and_b32 v3, 15, v2
    v_lshrrev_b32 v7, 4, v0
    v_lshlrev_b32 v7, 7, v7
    v_lshlrev_b32 v5, 5, v4
    v_add_u32 v7, v7, v5
    v_cmp_gt_u32 vcc, 4, v3
    s_and_saveexec_b64 s[44:45], vcc
    ds_write_b128 v7, v[100:103]
    ds_write_b128 v7, v[104:107] offset:16
    s_mov_b64 exec, s[44:45]
    s_waitcnt lgkmcnt(0)
    s_barrier
    s_cmp_eq_u32 s17, 0
    s_cbranch_scc0 front_kernel_Apub
    v_and_b32 v7, 31, v0
    v_lshlrev_b32 v7, 2, v7
    ds_read_b32 v8, v7 offset:0
    ds_read_b32 v9, v7 offset:128
    ds_read_b32 v10, v7 offset:256
    ds_read_b32 v11, v7 offset:384
    ds_read_b32 v12, v7 offset:512
    ds_read_b32 v13, v7 offset:640
    ds_read_b32 v14, v7 offset:768
    ds_read_b32 v15, v7 offset:896
    ds_read_b32 v16, v7 offset:1024
    ds_read_b32 v17, v7 offset:1152
    ds_read_b32 v18, v7 offset:1280
    ds_read_b32 v19, v7 offset:1408
    ds_read_b32 v20, v7 offset:1536
    ds_read_b32 v21, v7 offset:1664
    ds_read_b32 v22, v7 offset:1792
    ds_read_b32 v23, v7 offset:1920
    s_waitcnt lgkmcnt(0)
    v_add_f32 v8, v8, v9
    v_add_f32 v8, v8, v10
    v_add_f32 v8, v8, v11
    v_add_f32 v8, v8, v12
    v_add_f32 v8, v8, v13
    v_add_f32 v8, v8, v14
    v_add_f32 v8, v8, v15
    v_add_f32 v8, v8, v16
    v_add_f32 v8, v8, v17
    v_add_f32 v8, v8, v18
    v_add_f32 v8, v8, v19
    v_add_f32 v8, v8, v20
    v_add_f32 v8, v8, v21
    v_add_f32 v8, v8, v22
    v_add_f32 v8, v8, v23
    v_cvt_pk_bf16_f32 v8, v8, v8
    v_lshlrev_b32 v8, 16, v8
    s_add_u32 s26, s6, 0
    s_addc_u32 s27, s7, 0
    s_mov_b32 s48, s26
    s_and_b32 s49, s27, 0xffff
    s_mov_b32 s50, 13824
    s_mov_b32 s51, 0x20000
    s_lshl_b32 s20, s12, 7
    v_cmp_gt_u32 vcc, 32, v0
    s_and_saveexec_b64 s[44:45], vcc
    buffer_store_dword v8, v7, s[48:51], s20 offen sc1
    s_mov_b64 exec, s[44:45]
front_kernel_Apub:
    s_mov_b32 s42, 68
    s_mov_b32 s43, 2
    s_mov_b32 s47, 107
    s_branch front_kernel_pub
front_kernel_B:
    s_load_dwordx2 s[8:9], s[0:1], 0
    s_mov_b32 s12, s2
    v_lshrrev_b32 v3, 3, v0
    v_and_b32 v4, 7, v0
    v_mul_u32_u24 v5, 1152, v3
    v_lshlrev_b32 v6, 4, v4
    v_add_u32 v5, v5, v6
    v_mul_u32_u24 v7, 1184, v3
    v_add_u32 v7, v7, v6
    s_mul_i32 s20, s12, 36864
    s_waitcnt lgkmcnt(0)
    s_mov_b32 s48, s8
    s_and_b32 s49, s9, 0xffff
    s_mov_b32 s50, 2359296
    s_mov_b32 s51, 0x20000
    buffer_load_dwordx4 v[16:19], v5, s[48:51], s20 offen offset:0
    buffer_load_dwordx4 v[20:23], v5, s[48:51], s20 offen offset:128
    buffer_load_dwordx4 v[24:27], v5, s[48:51], s20 offen offset:256
    buffer_load_dwordx4 v[28:31], v5, s[48:51], s20 offen offset:384
    buffer_load_dwordx4 v[32:35], v5, s[48:51], s20 offen offset:512
    buffer_load_dwordx4 v[36:39], v5, s[48:51], s20 offen offset:640
    buffer_load_dwordx4 v[40:43], v5, s[48:51], s20 offen offset:768
    buffer_load_dwordx4 v[44:47], v5, s[48:51], s20 offen offset:896
    buffer_load_dwordx4 v[48:51], v5, s[48:51], s20 offen offset:1024
    s_add_u32 s26, s6, 1048576
    s_addc_u32 s27, s7, 0
    s_mov_b32 s52, s26
    s_and_b32 s53, s27, 0xffff
    s_mov_b32 s54, 2359296
    s_mov_b32 s55, 0x20000
    v_lshrrev_b32 v8, 4, v2
    v_bfe_u32 v10, v2, 2, 2
    v_and_b32 v11, 3, v2
    v_lshlrev_b32 v12, 3, v8
    v_add_u32 v12, v12, v10
    v_mul_u32_u24 v12, 1184, v12
    v_lshlrev_b32 v14, 3, v11
    v_add_u32 v12, v12, v14
    s_mul_i32 s21, s17, 288
    v_add_u32 v12, s21, v12
    v_lshlrev_b32 v13, 4, v2
    s_lshl_b32 s21, s12, 10
    s_mul_i32 s22, s17, 589824
    s_add_u32 s21, s21, s22
    s_waitcnt vmcnt(8)
    ds_write_b128 v7, v[16:19] offset:0
    s_waitcnt vmcnt(7)
    ds_write_b128 v7, v[20:23] offset:128
    s_waitcnt vmcnt(6)
    ds_write_b128 v7, v[24:27] offset:256
    s_waitcnt vmcnt(5)
    ds_write_b128 v7, v[28:31] offset:384
    s_waitcnt vmcnt(4)
    ds_write_b128 v7, v[32:35] offset:512
    s_waitcnt vmcnt(3)
    ds_write_b128 v7, v[36:39] offset:640
    s_waitcnt vmcnt(2)
    ds_write_b128 v7, v[40:43] offset:768
    s_waitcnt vmcnt(1)
    ds_write_b128 v7, v[44:47] offset:896
    s_waitcnt vmcnt(0)
    ds_write_b128 v7, v[48:51] offset:1024
    s_waitcnt lgkmcnt(0)
    s_barrier
    ds_read_b64_tr_b16 v[64:65], v12 offset:0
    ds_read_b64_tr_b16 v[66:67], v12 offset:4736
    ds_read_b64_tr_b16 v[68:69], v12 offset:32
    ds_read_b64_tr_b16 v[70:71], v12 offset:4768
    ds_read_b64_tr_b16 v[72:73], v12 offset:64
    ds_read_b64_tr_b16 v[74:75], v12 offset:4800
    s_add_u32 s23, s21, 0
    s_waitcnt lgkmcnt(4)
    buffer_store_dwordx4 v[64:67], v13, s[52:55], s23 offen sc1
    s_add_u32 s23, s21, 65536
    s_waitcnt lgkmcnt(2)
    buffer_store_dwordx4 v[68:71], v13, s[52:55], s23 offen sc1
    s_add_u32 s23, s21, 131072
    s_waitcnt lgkmcnt(0)
    buffer_store_dwordx4 v[72:75], v13, s[52:55], s23 offen sc1
    ds_read_b64_tr_b16 v[76:77], v12 offset:96
    ds_read_b64_tr_b16 v[78:79], v12 offset:4832
    ds_read_b64_tr_b16 v[80:81], v12 offset:128
    ds_read_b64_tr_b16 v[82:83], v12 offset:4864
    ds_read_b64_tr_b16 v[84:85], v12 offset:160
    ds_read_b64_tr_b16 v[86:87], v12 offset:4896
    s_add_u32 s23, s21, 196608
    s_waitcnt lgkmcnt(4)
    buffer_store_dwordx4 v[76:79], v13, s[52:55], s23 offen sc1
    s_add_u32 s23, s21, 262144
    s_waitcnt lgkmcnt(2)
    buffer_store_dwordx4 v[80:83], v13, s[52:55], s23 offen sc1
    s_add_u32 s23, s21, 327680
    s_waitcnt lgkmcnt(0)
    buffer_store_dwordx4 v[84:87], v13, s[52:55], s23 offen sc1
    ds_read_b64_tr_b16 v[88:89], v12 offset:192
    ds_read_b64_tr_b16 v[90:91], v12 offset:4928
    ds_read_b64_tr_b16 v[92:93], v12 offset:224
    ds_read_b64_tr_b16 v[94:95], v12 offset:4960
    ds_read_b64_tr_b16 v[96:97], v12 offset:256
    ds_read_b64_tr_b16 v[98:99], v12 offset:4992
    s_add_u32 s23, s21, 393216
    s_waitcnt lgkmcnt(4)
    buffer_store_dwordx4 v[88:91], v13, s[52:55], s23 offen sc1
    s_add_u32 s23, s21, 458752
    s_waitcnt lgkmcnt(2)
    buffer_store_dwordx4 v[92:95], v13, s[52:55], s23 offen sc1
    s_add_u32 s23, s21, 524288
    s_waitcnt lgkmcnt(0)
    buffer_store_dwordx4 v[96:99], v13, s[52:55], s23 offen sc1
    v_mov_b32 v56, 0
    v_mov_b32 v57, 0
    v_mov_b32 v58, 0
    v_mov_b32 v59, 0
    v_mov_b32 v60, 0
    v_mov_b32 v61, 0
    v_lshlrev_b32 v60, 16, v16
    v_and_b32 v61, 0xffff0000, v16
    v_pk_add_f32 v[56:57], v[56:57], v[60:61]
    v_pk_fma_f32 v[58:59], v[60:61], v[60:61], v[58:59]
    v_lshlrev_b32 v60, 16, v17
    v_and_b32 v61, 0xffff0000, v17
    v_pk_add_f32 v[56:57], v[56:57], v[60:61]
    v_pk_fma_f32 v[58:59], v[60:61], v[60:61], v[58:59]
    v_lshlrev_b32 v60, 16, v18
    v_and_b32 v61, 0xffff0000, v18
    v_pk_add_f32 v[56:57], v[56:57], v[60:61]
    v_pk_fma_f32 v[58:59], v[60:61], v[60:61], v[58:59]
    v_lshlrev_b32 v60, 16, v19
    v_and_b32 v61, 0xffff0000, v19
    v_pk_add_f32 v[56:57], v[56:57], v[60:61]
    v_pk_fma_f32 v[58:59], v[60:61], v[60:61], v[58:59]
    v_lshlrev_b32 v60, 16, v20
    v_and_b32 v61, 0xffff0000, v20
    v_pk_add_f32 v[56:57], v[56:57], v[60:61]
    v_pk_fma_f32 v[58:59], v[60:61], v[60:61], v[58:59]
    v_lshlrev_b32 v60, 16, v21
    v_and_b32 v61, 0xffff0000, v21
    v_pk_add_f32 v[56:57], v[56:57], v[60:61]
    v_pk_fma_f32 v[58:59], v[60:61], v[60:61], v[58:59]
    v_lshlrev_b32 v60, 16, v22
    v_and_b32 v61, 0xffff0000, v22
    v_pk_add_f32 v[56:57], v[56:57], v[60:61]
    v_pk_fma_f32 v[58:59], v[60:61], v[60:61], v[58:59]
    v_lshlrev_b32 v60, 16, v23
    v_and_b32 v61, 0xffff0000, v23
    v_pk_add_f32 v[56:57], v[56:57], v[60:61]
    v_pk_fma_f32 v[58:59], v[60:61], v[60:61], v[58:59]
    v_lshlrev_b32 v60, 16, v24
    v_and_b32 v61, 0xffff0000, v24
    v_pk_add_f32 v[56:57], v[56:57], v[60:61]
    v_pk_fma_f32 v[58:59], v[60:61], v[60:61], v[58:59]
    v_lshlrev_b32 v60, 16, v25
    v_and_b32 v61, 0xffff0000, v25
    v_pk_add_f32 v[56:57], v[56:57], v[60:61]
    v_pk_fma_f32 v[58:59], v[60:61], v[60:61], v[58:59]
    v_lshlrev_b32 v60, 16, v26
    v_and_b32 v61, 0xffff0000, v26
    v_pk_add_f32 v[56:57], v[56:57], v[60:61]
    v_pk_fma_f32 v[58:59], v[60:61], v[60:61], v[58:59]
    v_lshlrev_b32 v60, 16, v27
    v_and_b32 v61, 0xffff0000, v27
    v_pk_add_f32 v[56:57], v[56:57], v[60:61]
    v_pk_fma_f32 v[58:59], v[60:61], v[60:61], v[58:59]
    v_lshlrev_b32 v60, 16, v28
    v_and_b32 v61, 0xffff0000, v28
    v_pk_add_f32 v[56:57], v[56:57], v[60:61]
    v_pk_fma_f32 v[58:59], v[60:61], v[60:61], v[58:59]
    v_lshlrev_b32 v60, 16, v29
    v_and_b32 v61, 0xffff0000, v29
    v_pk_add_f32 v[56:57], v[56:57], v[60:61]
    v_pk_fma_f32 v[58:59], v[60:61], v[60:61], v[58:59]
    v_lshlrev_b32 v60, 16, v30
    v_and_b32 v61, 0xffff0000, v30
    v_pk_add_f32 v[56:57], v[56:57], v[60:61]
    v_pk_fma_f32 v[58:59], v[60:61], v[60:61], v[58:59]
    v_lshlrev_b32 v60, 16, v31
    v_and_b32 v61, 0xffff0000, v31
    v_pk_add_f32 v[56:57], v[56:57], v[60:61]
    v_pk_fma_f32 v[58:59], v[60:61], v[60:61], v[58:59]
    v_lshlrev_b32 v60, 16, v32
    v_and_b32 v61, 0xffff0000, v32
    v_pk_add_f32 v[56:57], v[56:57], v[60:61]
    v_pk_fma_f32 v[58:59], v[60:61], v[60:61], v[58:59]
    v_lshlrev_b32 v60, 16, v33
    v_and_b32 v61, 0xffff0000, v33
    v_pk_add_f32 v[56:57], v[56:57], v[60:61]
    v_pk_fma_f32 v[58:59], v[60:61], v[60:61], v[58:59]
    v_lshlrev_b32 v60, 16, v34
    v_and_b32 v61, 0xffff0000, v34
    v_pk_add_f32 v[56:57], v[56:57], v[60:61]
    v_pk_fma_f32 v[58:59], v[60:61], v[60:61], v[58:59]
    v_lshlrev_b32 v60, 16, v35
    v_and_b32 v61, 0xffff0000, v35
    v_pk_add_f32 v[56:57], v[56:57], v[60:61]
    v_pk_fma_f32 v[58:59], v[60:61], v[60:61], v[58:59]
    v_lshlrev_b32 v60, 16, v36
    v_and_b32 v61, 0xffff0000, v36
    v_pk_add_f32 v[56:57], v[56:57], v[60:61]
    v_pk_fma_f32 v[58:59], v[60:61], v[60:61], v[58:59]
    v_lshlrev_b32 v60, 16, v37
    v_and_b32 v61, 0xffff0000, v37
    v_pk_add_f32 v[56:57], v[56:57], v[60:61]
    v_pk_fma_f32 v[58:59], v[60:61], v[60:61], v[58:59]
    v_lshlrev_b32 v60, 16, v38
    v_and_b32 v61, 0xffff0000, v38
    v_pk_add_f32 v[56:57], v[56:57], v[60:61]
    v_pk_fma_f32 v[58:59], v[60:61], v[60:61], v[58:59]
    v_lshlrev_b32 v60, 16, v39
    v_and_b32 v61, 0xffff0000, v39
    v_pk_add_f32 v[56:57], v[56:57], v[60:61]
    v_pk_fma_f32 v[58:59], v[60:61], v[60:61], v[58:59]
    v_lshlrev_b32 v60, 16, v40
    v_and_b32 v61, 0xffff0000, v40
    v_pk_add_f32 v[56:57], v[56:57], v[60:61]
    v_pk_fma_f32 v[58:59], v[60:61], v[60:61], v[58:59]
    v_lshlrev_b32 v60, 16, v41
    v_and_b32 v61, 0xffff0000, v41
    v_pk_add_f32 v[56:57], v[56:57], v[60:61]
    v_pk_fma_f32 v[58:59], v[60:61], v[60:61], v[58:59]
    v_lshlrev_b32 v60, 16, v42
    v_and_b32 v61, 0xffff0000, v42
    v_pk_add_f32 v[56:57], v[56:57], v[60:61]
    v_pk_fma_f32 v[58:59], v[60:61], v[60:61], v[58:59]
    v_lshlrev_b32 v60, 16, v43
    v_and_b32 v61, 0xffff0000, v43
    v_pk_add_f32 v[56:57], v[56:57], v[60:61]
    v_pk_fma_f32 v[58:59], v[60:61], v[60:61], v[58:59]
    v_lshlrev_b32 v60, 16, v44
    v_and_b32 v61, 0xffff0000, v44
    v_pk_add_f32 v[56:57], v[56:57], v[60:61]
    v_pk_fma_f32 v[58:59], v[60:61], v[60:61], v[58:59]
    v_lshlrev_b32 v60, 16, v45
    v_and_b32 v61, 0xffff0000, v45
    v_pk_add_f32 v[56:57], v[56:57], v[60:61]
    v_pk_fma_f32 v[58:59], v[60:61], v[60:61], v[58:59]
    v_lshlrev_b32 v60, 16, v46
    v_and_b32 v61, 0xffff0000, v46
    v_pk_add_f32 v[56:57], v[56:57], v[60:61]
    v_pk_fma_f32 v[58:59], v[60:61], v[60:61], v[58:59]
    v_lshlrev_b32 v60, 16, v47
    v_and_b32 v61, 0xffff0000, v47
    v_pk_add_f32 v[56:57], v[56:57], v[60:61]
    v_pk_fma_f32 v[58:59], v[60:61], v[60:61], v[58:59]
    v_lshlrev_b32 v60, 16, v48
    v_and_b32 v61, 0xffff0000, v48
    v_pk_add_f32 v[56:57], v[56:57], v[60:61]
    v_pk_fma_f32 v[58:59], v[60:61], v[60:61], v[58:59]
    v_lshlrev_b32 v60, 16, v49
    v_and_b32 v61, 0xffff0000, v49
    v_pk_add_f32 v[56:57], v[56:57], v[60:61]
    v_pk_fma_f32 v[58:59], v[60:61], v[60:61], v[58:59]
    v_lshlrev_b32 v60, 16, v50
    v_and_b32 v61, 0xffff0000, v50
    v_pk_add_f32 v[56:57], v[56:57], v[60:61]
    v_pk_fma_f32 v[58:59], v[60:61], v[60:61], v[58:59]
    v_lshlrev_b32 v60, 16, v51
    v_and_b32 v61, 0xffff0000, v51
    v_pk_add_f32 v[56:57], v[56:57], v[60:61]
    v_pk_fma_f32 v[58:59], v[60:61], v[60:61], v[58:59]
    v_add_f32 v56, v56, v57
    v_add_f32 v57, v58, v59
    s_nop 1
    v_add_f32_dpp v56, v56, v56 quad_perm:[1,0,3,2] row_mask:0xf bank_mask:0xf
    v_add_f32_dpp v57, v57, v57 quad_perm:[1,0,3,2] row_mask:0xf bank_mask:0xf
    s_nop 1
    v_add_f32_dpp v56, v56, v56 quad_perm:[2,3,0,1] row_mask:0xf bank_mask:0xf
    v_add_f32_dpp v57, v57, v57 quad_perm:[2,3,0,1] row_mask:0xf bank_mask:0xf
    s_nop 1
    v_add_f32_dpp v56, v56, v56 row_half_mirror row_mask:0xf bank_mask:0xf
    v_add_f32_dpp v57, v57, v57 row_half_mirror row_mask:0xf bank_mask:0xf
    v_mul_f32 v56, 0x3ae38e39, v56
    v_mul_f32 v57, 0x3ae38e39, v57
    v_fma_f32 v57, -v56, v56, v57
    v_max_f32 v57, 0, v57
    v_cvt_pk_bf16_f32 v56, v56, v56
    v_lshlrev_b32 v56, 16, v56
    v_cvt_pk_bf16_f32 v57, v57, v57
    v_lshlrev_b32 v57, 16, v57
    v_add_f32 v57, 0x3727c5ac, v57
    v_cvt_pk_bf16_f32 v57, v57, v57
    v_lshlrev_b32 v57, 16, v57
    v_sqrt_f32 v57, v57
    s_nop 0
    v_cvt_pk_bf16_f32 v57, v57, v57
    v_lshlrev_b32 v57, 16, v57
    v_rcp_f32 v57, v57
    s_add_u32 s26, s6, 65536
    s_addc_u32 s27, s7, 0
    s_mov_b32 s48, s26
    s_and_b32 s49, s27, 0xffff
    s_mov_b32 s50, 16384
    s_mov_b32 s51, 0x20000
    s_lshl_b32 s21, s12, 8
    v_lshlrev_b32 v8, 3, v3
    v_cmp_eq_u32 vcc, 0, v4
    s_and_saveexec_b64 s[44:45], vcc
    buffer_store_dwordx2 v[56:57], v8, s[48:51], s21 offen sc1
    s_mov_b64 exec, s[44:45]
    s_lshr_b32 s43, s12, 5
    s_lshl_b32 s42, s43, 6
    s_mov_b32 s47, 31
front_kernel_pub:
    s_waitcnt vmcnt(0)
    s_barrier
    s_cmp_eq_u32 s17, 0
    s_cbranch_scc0 front_kernel_svc
    v_mov_b32 v3, s42
    v_mov_b32 v4, 1
    s_mov_b64 s[44:45], exec
    s_mov_b64 exec, 1
    global_atomic_add v5, v3, v4, s[58:59] sc0 sc1
    s_waitcnt vmcnt(0)
    v_readfirstlane_b32 s46, v5
    s_lshl_b32 s43, s43, 2
    s_add_u32 s43, s43, 128
    s_nop 1
    s_cmp_eq_u32 s46, s47
    s_cbranch_scc0 front_kernel_pubd
    v_mov_b32 v5, s43
    global_store_dword v5, v4, s[58:59] sc0 sc1
front_kernel_pubd:
    s_mov_b64 exec, s[44:45]
    s_branch front_kernel_svc
front_kernel_svc0:
    s_waitcnt lgkmcnt(0)
front_kernel_svc:
    s_mov_b64 exec, -1
    s_setprio 0
    s_cmp_lt_u32 s2, 36
    s_cbranch_scc1 front_kernel_Dj
    s_sub_u32 s16, s2, 36
    s_cmp_ge_u32 s16, 144
    s_cbranch_scc1 front_kernel_fin
    s_load_dwordx2 s[10:11], s[0:1], 80
    s_mov_b32 s12, s16
    s_barrier
    s_waitcnt lgkmcnt(0)
    v_mov_b32 v70, v2
    s_lshl_b32 s20, s12, 6
    s_add_u32 s10, s10, s20
    s_addc_u32 s11, s11, 0
    s_mov_b32 s28, s10
    s_and_b32 s29, s11, 0xffff
    s_mov_b32 s30, 5308416
    s_mov_b32 s31, 0x20000
    v_lshrrev_b32 v3, 2, v2
    v_and_b32 v4, 3, v2
    v_bfe_u32 v5, v2, 5, 1
    v_lshlrev_b32 v5, 1, v5
    v_xor_b32 v4, v4, v5
    v_lshlrev_b32 v4, 4, v4
    v_mul_u32_u24 v3, 9216, v3
    v_add_u32 v3, v3, v4
    s_mul_i32 s21, s17, 1327104
    s_mul_i32 s22, s17, 9216
    s_add_u32 m0, s22, 0
    s_add_u32 s23, s21, 0
    buffer_load_dwordx4 v3, s[28:31], s23 offen  lds
    s_add_u32 m0, s22, 1024
    s_add_u32 s23, s21, 147456
    buffer_load_dwordx4 v3, s[28:31], s23 offen  lds
    s_add_u32 m0, s22, 2048
    s_add_u32 s23, s21, 294912
    buffer_load_dwordx4 v3, s[28:31], s23 offen  lds
    s_add_u32 m0, s22, 3072
    s_add_u32 s23, s21, 442368
    buffer_load_dwordx4 v3, s[28:31], s23 offen  lds
    s_add_u32 m0, s22, 4096
    s_add_u32 s23, s21, 589824
    buffer_load_dwordx4 v3, s[28:31], s23 offen  lds
    s_add_u32 m0, s22, 5120
    s_add_u32 s23, s21, 737280
    buffer_load_dwordx4 v3, s[28:31], s23 offen  lds
    s_add_u32 m0, s22, 6144
    s_add_u32 s23, s21, 884736
    buffer_load_dwordx4 v3, s[28:31], s23 offen  lds
    s_add_u32 m0, s22, 7168
    s_add_u32 s23, s21, 1032192
    buffer_load_dwordx4 v3, s[28:31], s23 offen  lds
    s_add_u32 m0, s22, 8192
    s_add_u32 s23, s21, 1179648
    buffer_load_dwordx4 v3, s[28:31], s23 offen  lds
    s_add_u32 s26, s6, 24117248
    s_addc_u32 s27, s7, 0
    s_mov_b32 s36, s26
    s_and_b32 s37, s27, 0xffff
    s_mov_b32 s38, 262144
    s_mov_b32 s39, 0x20000
    s_lshl_b32 s20, s16, 11
    v_lshlrev_b32 v6, 3, v0
    v_mov_b32 v16, 0xbf800000
    v_mov_b32 v17, 0xbf800000
    buffer_store_dwordx2 v[16:17], v6, s[36:39], s20 offen
    s_cmp_eq_u32 s16, 128
    s_cbranch_scc0 front_kernel_noflg
    s_add_u32 s26, s6, 24641536
    s_addc_u32 s27, s7, 0
    s_mov_b32 s36, s26
    s_and_b32 s37, s27, 0xffff
    s_mov_b32 s38, 2048
    v_mov_b32 v18, 0
    v_mov_b32 v19, 0
    buffer_store_dwordx2 v[18:19], v6, s[36:39], 0 offen
front_kernel_noflg:
    s_cmp_ge_u32 s16, 16
    s_cbranch_scc1 front_kernel_nopc
    s_getpc_b64 s[20:21]
    front_kernel_pcref:
    s_add_u32 s20, s20, back_kernel-front_kernel_pcref
    s_addc_u32 s21, s21, 0
    v_lshlrev_b32 v3, 4, v0
    v_add_u32 v4, 0, v3
    v_min_u32 v4, back_kernel_end-back_kernel-16, v4
    global_load_dwordx4 v[80:83], v4, s[20:21]
    v_add_u32 v4, 4096, v3
    v_min_u32 v4, back_kernel_end-back_kernel-16, v4
    global_load_dwordx4 v[84:87], v4, s[20:21]
    v_add_u32 v4, 8192, v3
    v_min_u32 v4, back_kernel_end-back_kernel-16, v4
    global_load_dwordx4 v[88:91], v4, s[20:21]
    v_add_u32 v4, 12288, v3
    v_min_u32 v4, back_kernel_end-back_kernel-16, v4
    global_load_dwordx4 v[92:95], v4, s[20:21]
    v_add_u32 v4, 16384, v3
    v_min_u32 v4, back_kernel_end-back_kernel-16, v4
    global_load_dwordx4 v[96:99], v4, s[20:21]
    v_add_u32 v4, 20480, v3
    v_min_u32 v4, back_kernel_end-back_kernel-16, v4
    global_load_dwordx4 v[100:103], v4, s[20:21]
    v_add_u32 v4, 24576, v3
    v_min_u32 v4, back_kernel_end-back_kernel-16, v4
    global_load_dwordx4 v[104:107], v4, s[20:21]
    v_add_u32 v4, 28672, v3
    v_min_u32 v4, back_kernel_end-back_kernel-16, v4
    global_load_dwordx4 v[108:111], v4, s[20:21]
    v_add_u32 v4, 32768, v3
    v_min_u32 v4, back_kernel_end-back_kernel-16, v4
    global_load_dwordx4 v[80:83], v4, s[20:21]
    v_add_u32 v4, 36864, v3
    v_min_u32 v4, back_kernel_end-back_kernel-16, v4
    global_load_dwordx4 v[84:87], v4, s[20:21]
front_kernel_nopc:
    s_cmp_eq_u32 s17, 0
    s_cbranch_scc0 front_kernel_wpoll_ok
    v_mov_b32 v9, 0
    s_mov_b32 s46, 0
front_kernel_wpoll:
    global_load_dword v8, v9, s[58:59] offset:136 sc1
    s_waitcnt vmcnt(0)
    v_readfirstlane_b32 s47, v8
    s_nop 3
    s_cmp_lg_u32 s47, 0
    s_cbranch_scc1 front_kernel_wpoll_ok
    s_add_u32 s46, s46, 1
    s_cmp_lt_u32 s46, 0x20000
    s_cbranch_scc0 front_kernel_wpoll_ok
    s_sleep 8
    s_branch front_kernel_wpoll
front_kernel_wpoll_ok:
    s_barrier
    s_add_u32 s26, s6, 0
    s_addc_u32 s27, s7, 0
    s_mov_b32 s48, s26
    s_and_b32 s49, s27, 0xffff
    s_mov_b32 s50, 13824
    s_mov_b32 s51, 0x20000
    v_lshlrev_b32 v5, 2, v0
    s_mov_b32 s24, 9216
    s_mov_b32 s25, 6912
    buffer_load_dword v8, v5, s[48:51], s24 offen offset:0 sc1
    buffer_load_dword v12, v5, s[48:51], s25 offen offset:0 sc1
    buffer_load_dword v9, v5, s[48:51], s24 offen offset:1024 sc1
    buffer_load_dword v13, v5, s[48:51], s25 offen offset:1024 sc1
    buffer_load_dword v10, v5, s[48:51], s24 offen offset:2048 sc1
    buffer_load_dword v14, v5, s[48:51], s25 offen offset:2048 sc1
    s_waitcnt vmcnt(0)
    v_add_f32 v8, 1.0, v8
    v_cvt_pk_bf16_f32 v8, v8, v8
    v_lshlrev_b32 v8, 16, v8
    v_add_f32 v9, 1.0, v9
    v_cvt_pk_bf16_f32 v9, v9, v9
    v_lshlrev_b32 v9, 16, v9
    v_add_f32 v10, 1.0, v10
    v_cvt_pk_bf16_f32 v10, v10, v10
    v_lshlrev_b32 v10, 16, v10
    ds_write_b32 v5, v8 offset:36864
    ds_write_b32 v5, v12 offset:39168
    ds_write_b32 v5, v9 offset:37888
    ds_write_b32 v5, v13 offset:40192
    v_cmp_gt_u32 vcc, 64, v0
    s_and_saveexec_b64 s[44:45], vcc
    ds_write_b32 v5, v10 offset:38912
    ds_write_b32 v5, v14 offset:41216
    s_mov_b64 exec, s[44:45]
    s_waitcnt lgkmcnt(0)
    s_barrier
    s_and_b32 s18, s17, 1
    s_lshr_b32 s19, s17, 1
    s_lshl_b32 s20, s12, 1
    s_add_u32 s20, s20, s18
    s_cmp_ge_u32 s20, 144
    s_cselect_b32 s21, 0, 18
    s_cselect_b32 s22, 144, 0
    s_sub_u32 s20, s20, s22
    s_mul_i32 s22, s20, 7282
    s_lshr_b32 s22, s22, 16
    s_mul_i32 s23, s22, 9
    s_sub_u32 s23, s20, s23
    s_add_u32 s21, s21, s23
    s_lshl_b32 s21, s21, 10
    s_mul_i32 s22, s22, 331776
    s_add_u32 s21, s21, s22
    s_add_u32 s26, s6, 16777216
    s_addc_u32 s27, s7, 0
    s_mov_b32 s28, s26
    s_and_b32 s29, s27, 0xffff
    s_mov_b32 s30, 5308416
    s_mov_b32 s31, 0x20000
    v_lshrrev_b32 v3, 4, v70
    v_bfe_u32 v4, v70, 2, 2
    v_and_b32 v5, 3, v70
    v_lshlrev_b32 v6, 3, v3
    v_add_u32 v6, v6, v4
    v_lshlrev_b32 v6, 6, v6
    v_and_b32 v7, 1, v3
    v_xor_b32 v7, s18, v7
    v_lshlrev_b32 v7, 5, v7
    v_lshlrev_b32 v5, 3, v5
    v_add3_u32 v6, v6, v7, v5
    s_mul_i32 s22, s19, 18432
    v_add_u32 v6, s22, v6
    v_lshlrev_b32 v7, 5, v3
    s_mul_i32 s22, s19, 1152
    v_add_u32 v7, s22, v7
    v_lshlrev_b32 v8, 4, v70
    v_mov_b32 v20, 0
    v_mov_b32 v21, 0
    v_mov_b32 v22, 0
    v_mov_b32 v23, 0
    ds_read_b64_tr_b16 v[24:25], v6 offset:0
    ds_read_b64_tr_b16 v[26:27], v6 offset:256
    ds_read_b128 v[28:31], v7 offset:36864
    ds_read_b128 v[32:35], v7 offset:36880
    ds_read_b128 v[36:39], v7 offset:39168
    ds_read_b128 v[40:43], v7 offset:39184
    ds_read_b64_tr_b16 v[80:81], v6 offset:2048
    ds_read_b64_tr_b16 v[82:83], v6 offset:2304
    ds_read_b128 v[84:87], v7 offset:36992
    ds_read_b128 v[88:91], v7 offset:37008
    ds_read_b128 v[92:95], v7 offset:39296
    ds_read_b128 v[96:99], v7 offset:39312
    s_mul_i32 s22, s19, 9
    s_add_u32 s22, s22, 0
    s_lshr_b32 s23, s22, 1
    s_mul_i32 s23, s23, 36864
    s_and_b32 s22, s22, 1
    s_mul_i32 s22, s22, 9216
    s_add_u32 s23, s23, s22
    s_add_u32 s23, s23, s21
    s_waitcnt lgkmcnt(6)
    v_lshlrev_b32 v44, 16, v24
    v_and_b32 v45, 0xffff0000, v24
    v_lshlrev_b32 v46, 16, v25
    v_and_b32 v47, 0xffff0000, v25
    v_lshlrev_b32 v48, 16, v26
    v_and_b32 v49, 0xffff0000, v26
    v_lshlrev_b32 v50, 16, v27
    v_and_b32 v51, 0xffff0000, v27
    v_pk_mul_f32 v[52:53], v[44:45], v[28:29]
    v_pk_mul_f32 v[54:55], v[46:47], v[30:31]
    v_pk_mul_f32 v[56:57], v[48:49], v[32:33]
    v_pk_mul_f32 v[58:59], v[50:51], v[34:35]
    v_pk_fma_f32 v[22:23], v[44:45], v[36:37], v[22:23]
    v_pk_fma_f32 v[22:23], v[46:47], v[38:39], v[22:23]
    v_pk_fma_f32 v[22:23], v[48:49], v[40:41], v[22:23]
    v_pk_fma_f32 v[22:23], v[50:51], v[42:43], v[22:23]
    v_cvt_pk_bf16_f32 v60, v52, v53
    v_cvt_pk_bf16_f32 v61, v54, v55
    v_cvt_pk_bf16_f32 v62, v56, v57
    v_cvt_pk_bf16_f32 v63, v58, v59
    v_pk_add_f32 v[20:21], v[20:21], v[52:53]
    v_pk_add_f32 v[20:21], v[20:21], v[54:55]
    v_pk_add_f32 v[20:21], v[20:21], v[56:57]
    v_pk_add_f32 v[20:21], v[20:21], v[58:59]
    buffer_store_dwordx4 v[60:63], v8, s[28:31], s23 offen sc1
    ds_read_b64_tr_b16 v[24:25], v6 offset:4096
    ds_read_b64_tr_b16 v[26:27], v6 offset:4352
    ds_read_b128 v[28:31], v7 offset:37120
    ds_read_b128 v[32:35], v7 offset:37136
    ds_read_b128 v[36:39], v7 offset:39424
    ds_read_b128 v[40:43], v7 offset:39440
    s_mul_i32 s22, s19, 9
    s_add_u32 s22, s22, 1
    s_lshr_b32 s23, s22, 1
    s_mul_i32 s23, s23, 36864
    s_and_b32 s22, s22, 1
    s_mul_i32 s22, s22, 9216
    s_add_u32 s23, s23, s22
    s_add_u32 s23, s23, s21
    s_waitcnt lgkmcnt(6)
    v_lshlrev_b32 v44, 16, v80
    v_and_b32 v45, 0xffff0000, v80
    v_lshlrev_b32 v46, 16, v81
    v_and_b32 v47, 0xffff0000, v81
    v_lshlrev_b32 v48, 16, v82
    v_and_b32 v49, 0xffff0000, v82
    v_lshlrev_b32 v50, 16, v83
    v_and_b32 v51, 0xffff0000, v83
    v_pk_mul_f32 v[52:53], v[44:45], v[84:85]
    v_pk_mul_f32 v[54:55], v[46:47], v[86:87]
    v_pk_mul_f32 v[56:57], v[48:49], v[88:89]
    v_pk_mul_f32 v[58:59], v[50:51], v[90:91]
    v_pk_fma_f32 v[22:23], v[44:45], v[92:93], v[22:23]
    v_pk_fma_f32 v[22:23], v[46:47], v[94:95], v[22:23]
    v_pk_fma_f32 v[22:23], v[48:49], v[96:97], v[22:23]
    v_pk_fma_f32 v[22:23], v[50:51], v[98:99], v[22:23]
    v_cvt_pk_bf16_f32 v64, v52, v53
    v_cvt_pk_bf16_f32 v65, v54, v55
    v_cvt_pk_bf16_f32 v66, v56, v57
    v_cvt_pk_bf16_f32 v67, v58, v59
    v_pk_add_f32 v[20:21], v[20:21], v[52:53]
    v_pk_add_f32 v[20:21], v[20:21], v[54:55]
    v_pk_add_f32 v[20:21], v[20:21], v[56:57]
    v_pk_add_f32 v[20:21], v[20:21], v[58:59]
    buffer_store_dwordx4 v[64:67], v8, s[28:31], s23 offen sc1
    ds_read_b64_tr_b16 v[80:81], v6 offset:6144
    ds_read_b64_tr_b16 v[82:83], v6 offset:6400
    ds_read_b128 v[84:87], v7 offset:37248
    ds_read_b128 v[88:91], v7 offset:37264
    ds_read_b128 v[92:95], v7 offset:39552
    ds_read_b128 v[96:99], v7 offset:39568
    s_mul_i32 s22, s19, 9
    s_add_u32 s22, s22, 2
    s_lshr_b32 s23, s22, 1
    s_mul_i32 s23, s23, 36864
    s_and_b32 s22, s22, 1
    s_mul_i32 s22, s22, 9216
    s_add_u32 s23, s23, s22
    s_add_u32 s23, s23, s21
    s_waitcnt lgkmcnt(6)
    v_lshlrev_b32 v44, 16, v24
    v_and_b32 v45, 0xffff0000, v24
    v_lshlrev_b32 v46, 16, v25
    v_and_b32 v47, 0xffff0000, v25
    v_lshlrev_b32 v48, 16, v26
    v_and_b32 v49, 0xffff0000, v26
    v_lshlrev_b32 v50, 16, v27
    v_and_b32 v51, 0xffff0000, v27
    v_pk_mul_f32 v[52:53], v[44:45], v[28:29]
    v_pk_mul_f32 v[54:55], v[46:47], v[30:31]
    v_pk_mul_f32 v[56:57], v[48:49], v[32:33]
    v_pk_mul_f32 v[58:59], v[50:51], v[34:35]
    v_pk_fma_f32 v[22:23], v[44:45], v[36:37], v[22:23]
    v_pk_fma_f32 v[22:23], v[46:47], v[38:39], v[22:23]
    v_pk_fma_f32 v[22:23], v[48:49], v[40:41], v[22:23]
    v_pk_fma_f32 v[22:23], v[50:51], v[42:43], v[22:23]
    v_cvt_pk_bf16_f32 v60, v52, v53
    v_cvt_pk_bf16_f32 v61, v54, v55
    v_cvt_pk_bf16_f32 v62, v56, v57
    v_cvt_pk_bf16_f32 v63, v58, v59
    v_pk_add_f32 v[20:21], v[20:21], v[52:53]
    v_pk_add_f32 v[20:21], v[20:21], v[54:55]
    v_pk_add_f32 v[20:21], v[20:21], v[56:57]
    v_pk_add_f32 v[20:21], v[20:21], v[58:59]
    buffer_store_dwordx4 v[60:63], v8, s[28:31], s23 offen sc1
    ds_read_b64_tr_b16 v[24:25], v6 offset:8192
    ds_read_b64_tr_b16 v[26:27], v6 offset:8448
    ds_read_b128 v[28:31], v7 offset:37376
    ds_read_b128 v[32:35], v7 offset:37392
    ds_read_b128 v[36:39], v7 offset:39680
    ds_read_b128 v[40:43], v7 offset:39696
    s_mul_i32 s22, s19, 9
    s_add_u32 s22, s22, 3
    s_lshr_b32 s23, s22, 1
    s_mul_i32 s23, s23, 36864
    s_and_b32 s22, s22, 1
    s_mul_i32 s22, s22, 9216
    s_add_u32 s23, s23, s22
    s_add_u32 s23, s23, s21
    s_waitcnt lgkmcnt(6)
    v_lshlrev_b32 v44, 16, v80
    v_and_b32 v45, 0xffff0000, v80
    v_lshlrev_b32 v46, 16, v81
    v_and_b32 v47, 0xffff0000, v81
    v_lshlrev_b32 v48, 16, v82
    v_and_b32 v49, 0xffff0000, v82
    v_lshlrev_b32 v50, 16, v83
    v_and_b32 v51, 0xffff0000, v83
    v_pk_mul_f32 v[52:53], v[44:45], v[84:85]
    v_pk_mul_f32 v[54:55], v[46:47], v[86:87]
    v_pk_mul_f32 v[56:57], v[48:49], v[88:89]
    v_pk_mul_f32 v[58:59], v[50:51], v[90:91]
    v_pk_fma_f32 v[22:23], v[44:45], v[92:93], v[22:23]
    v_pk_fma_f32 v[22:23], v[46:47], v[94:95], v[22:23]
    v_pk_fma_f32 v[22:23], v[48:49], v[96:97], v[22:23]
    v_pk_fma_f32 v[22:23], v[50:51], v[98:99], v[22:23]
    v_cvt_pk_bf16_f32 v64, v52, v53
    v_cvt_pk_bf16_f32 v65, v54, v55
    v_cvt_pk_bf16_f32 v66, v56, v57
    v_cvt_pk_bf16_f32 v67, v58, v59
    v_pk_add_f32 v[20:21], v[20:21], v[52:53]
    v_pk_add_f32 v[20:21], v[20:21], v[54:55]
    v_pk_add_f32 v[20:21], v[20:21], v[56:57]
    v_pk_add_f32 v[20:21], v[20:21], v[58:59]
    buffer_store_dwordx4 v[64:67], v8, s[28:31], s23 offen sc1
    ds_read_b64_tr_b16 v[80:81], v6 offset:10240
    ds_read_b64_tr_b16 v[82:83], v6 offset:10496
    ds_read_b128 v[84:87], v7 offset:37504
    ds_read_b128 v[88:91], v7 offset:37520
    ds_read_b128 v[92:95], v7 offset:39808
    ds_read_b128 v[96:99], v7 offset:39824
    s_mul_i32 s22, s19, 9
    s_add_u32 s22, s22, 4
    s_lshr_b32 s23, s22, 1
    s_mul_i32 s23, s23, 36864
    s_and_b32 s22, s22, 1
    s_mul_i32 s22, s22, 9216
    s_add_u32 s23, s23, s22
    s_add_u32 s23, s23, s21
    s_waitcnt lgkmcnt(6)
    v_lshlrev_b32 v44, 16, v24
    v_and_b32 v45, 0xffff0000, v24
    v_lshlrev_b32 v46, 16, v25
    v_and_b32 v47, 0xffff0000, v25
    v_lshlrev_b32 v48, 16, v26
    v_and_b32 v49, 0xffff0000, v26
    v_lshlrev_b32 v50, 16, v27
    v_and_b32 v51, 0xffff0000, v27
    v_pk_mul_f32 v[52:53], v[44:45], v[28:29]
    v_pk_mul_f32 v[54:55], v[46:47], v[30:31]
    v_pk_mul_f32 v[56:57], v[48:49], v[32:33]
    v_pk_mul_f32 v[58:59], v[50:51], v[34:35]
    v_pk_fma_f32 v[22:23], v[44:45], v[36:37], v[22:23]
    v_pk_fma_f32 v[22:23], v[46:47], v[38:39], v[22:23]
    v_pk_fma_f32 v[22:23], v[48:49], v[40:41], v[22:23]
    v_pk_fma_f32 v[22:23], v[50:51], v[42:43], v[22:23]
    v_cvt_pk_bf16_f32 v60, v52, v53
    v_cvt_pk_bf16_f32 v61, v54, v55
    v_cvt_pk_bf16_f32 v62, v56, v57
    v_cvt_pk_bf16_f32 v63, v58, v59
    v_pk_add_f32 v[20:21], v[20:21], v[52:53]
    v_pk_add_f32 v[20:21], v[20:21], v[54:55]
    v_pk_add_f32 v[20:21], v[20:21], v[56:57]
    v_pk_add_f32 v[20:21], v[20:21], v[58:59]
    buffer_store_dwordx4 v[60:63], v8, s[28:31], s23 offen sc1
    ds_read_b64_tr_b16 v[24:25], v6 offset:12288
    ds_read_b64_tr_b16 v[26:27], v6 offset:12544
    ds_read_b128 v[28:31], v7 offset:37632
    ds_read_b128 v[32:35], v7 offset:37648
    ds_read_b128 v[36:39], v7 offset:39936
    ds_read_b128 v[40:43], v7 offset:39952
    s_mul_i32 s22, s19, 9
    s_add_u32 s22, s22, 5
    s_lshr_b32 s23, s22, 1
    s_mul_i32 s23, s23, 36864
    s_and_b32 s22, s22, 1
    s_mul_i32 s22, s22, 9216
    s_add_u32 s23, s23, s22
    s_add_u32 s23, s23, s21
    s_waitcnt lgkmcnt(6)
    v_lshlrev_b32 v44, 16, v80
    v_and_b32 v45, 0xffff0000, v80
    v_lshlrev_b32 v46, 16, v81
    v_and_b32 v47, 0xffff0000, v81
    v_lshlrev_b32 v48, 16, v82
    v_and_b32 v49, 0xffff0000, v82
    v_lshlrev_b32 v50, 16, v83
    v_and_b32 v51, 0xffff0000, v83
    v_pk_mul_f32 v[52:53], v[44:45], v[84:85]
    v_pk_mul_f32 v[54:55], v[46:47], v[86:87]
    v_pk_mul_f32 v[56:57], v[48:49], v[88:89]
    v_pk_mul_f32 v[58:59], v[50:51], v[90:91]
    v_pk_fma_f32 v[22:23], v[44:45], v[92:93], v[22:23]
    v_pk_fma_f32 v[22:23], v[46:47], v[94:95], v[22:23]
    v_pk_fma_f32 v[22:23], v[48:49], v[96:97], v[22:23]
    v_pk_fma_f32 v[22:23], v[50:51], v[98:99], v[22:23]
    v_cvt_pk_bf16_f32 v64, v52, v53
    v_cvt_pk_bf16_f32 v65, v54, v55
    v_cvt_pk_bf16_f32 v66, v56, v57
    v_cvt_pk_bf16_f32 v67, v58, v59
    v_pk_add_f32 v[20:21], v[20:21], v[52:53]
    v_pk_add_f32 v[20:21], v[20:21], v[54:55]
    v_pk_add_f32 v[20:21], v[20:21], v[56:57]
    v_pk_add_f32 v[20:21], v[20:21], v[58:59]
    buffer_store_dwordx4 v[64:67], v8, s[28:31], s23 offen sc1
    ds_read_b64_tr_b16 v[80:81], v6 offset:14336
    ds_read_b64_tr_b16 v[82:83], v6 offset:14592
    ds_read_b128 v[84:87], v7 offset:37760
    ds_read_b128 v[88:91], v7 offset:37776
    ds_read_b128 v[92:95], v7 offset:40064
    ds_read_b128 v[96:99], v7 offset:40080
    s_mul_i32 s22, s19, 9
    s_add_u32 s22, s22, 6
    s_lshr_b32 s23, s22, 1
    s_mul_i32 s23, s23, 36864
    s_and_b32 s22, s22, 1
    s_mul_i32 s22, s22, 9216
    s_add_u32 s23, s23, s22
    s_add_u32 s23, s23, s21
    s_waitcnt lgkmcnt(6)
    v_lshlrev_b32 v44, 16, v24
    v_and_b32 v45, 0xffff0000, v24
    v_lshlrev_b32 v46, 16, v25
    v_and_b32 v47, 0xffff0000, v25
    v_lshlrev_b32 v48, 16, v26
    v_and_b32 v49, 0xffff0000, v26
    v_lshlrev_b32 v50, 16, v27
    v_and_b32 v51, 0xffff0000, v27
    v_pk_mul_f32 v[52:53], v[44:45], v[28:29]
    v_pk_mul_f32 v[54:55], v[46:47], v[30:31]
    v_pk_mul_f32 v[56:57], v[48:49], v[32:33]
    v_pk_mul_f32 v[58:59], v[50:51], v[34:35]
    v_pk_fma_f32 v[22:23], v[44:45], v[36:37], v[22:23]
    v_pk_fma_f32 v[22:23], v[46:47], v[38:39], v[22:23]
    v_pk_fma_f32 v[22:23], v[48:49], v[40:41], v[22:23]
    v_pk_fma_f32 v[22:23], v[50:51], v[42:43], v[22:23]
    v_cvt_pk_bf16_f32 v60, v52, v53
    v_cvt_pk_bf16_f32 v61, v54, v55
    v_cvt_pk_bf16_f32 v62, v56, v57
    v_cvt_pk_bf16_f32 v63, v58, v59
    v_pk_add_f32 v[20:21], v[20:21], v[52:53]
    v_pk_add_f32 v[20:21], v[20:21], v[54:55]
    v_pk_add_f32 v[20:21], v[20:21], v[56:57]
    v_pk_add_f32 v[20:21], v[20:21], v[58:59]
    buffer_store_dwordx4 v[60:63], v8, s[28:31], s23 offen sc1
    ds_read_b64_tr_b16 v[24:25], v6 offset:16384
    ds_read_b64_tr_b16 v[26:27], v6 offset:16640
    ds_read_b128 v[28:31], v7 offset:37888
    ds_read_b128 v[32:35], v7 offset:37904
    ds_read_b128 v[36:39], v7 offset:40192
    ds_read_b128 v[40:43], v7 offset:40208
    s_mul_i32 s22, s19, 9
    s_add_u32 s22, s22, 7
    s_lshr_b32 s23, s22, 1
    s_mul_i32 s23, s23, 36864
    s_and_b32 s22, s22, 1
    s_mul_i32 s22, s22, 9216
    s_add_u32 s23, s23, s22
    s_add_u32 s23, s23, s21
    s_waitcnt lgkmcnt(6)
    v_lshlrev_b32 v44, 16, v80
    v_and_b32 v45, 0xffff0000, v80
    v_lshlrev_b32 v46, 16, v81
    v_and_b32 v47, 0xffff0000, v81
    v_lshlrev_b32 v48, 16, v82
    v_and_b32 v49, 0xffff0000, v82
    v_lshlrev_b32 v50, 16, v83
    v_and_b32 v51, 0xffff0000, v83
    v_pk_mul_f32 v[52:53], v[44:45], v[84:85]
    v_pk_mul_f32 v[54:55], v[46:47], v[86:87]
    v_pk_mul_f32 v[56:57], v[48:49], v[88:89]
    v_pk_mul_f32 v[58:59], v[50:51], v[90:91]
    v_pk_fma_f32 v[22:23], v[44:45], v[92:93], v[22:23]
    v_pk_fma_f32 v[22:23], v[46:47], v[94:95], v[22:23]
    v_pk_fma_f32 v[22:23], v[48:49], v[96:97], v[22:23]
    v_pk_fma_f32 v[22:23], v[50:51], v[98:99], v[22:23]
    v_cvt_pk_bf16_f32 v64, v52, v53
    v_cvt_pk_bf16_f32 v65, v54, v55
    v_cvt_pk_bf16_f32 v66, v56, v57
    v_cvt_pk_bf16_f32 v67, v58, v59
    v_pk_add_f32 v[20:21], v[20:21], v[52:53]
    v_pk_add_f32 v[20:21], v[20:21], v[54:55]
    v_pk_add_f32 v[20:21], v[20:21], v[56:57]
    v_pk_add_f32 v[20:21], v[20:21], v[58:59]
    buffer_store_dwordx4 v[64:67], v8, s[28:31], s23 offen sc1
    s_mul_i32 s22, s19, 9
    s_add_u32 s22, s22, 8
    s_lshr_b32 s23, s22, 1
    s_mul_i32 s23, s23, 36864
    s_and_b32 s22, s22, 1
    s_mul_i32 s22, s22, 9216
    s_add_u32 s23, s23, s22
    s_add_u32 s23, s23, s21
    s_waitcnt lgkmcnt(0)
    v_lshlrev_b32 v44, 16, v24
    v_and_b32 v45, 0xffff0000, v24
    v_lshlrev_b32 v46, 16, v25
    v_and_b32 v47, 0xffff0000, v25
    v_lshlrev_b32 v48, 16, v26
    v_and_b32 v49, 0xffff0000, v26
    v_lshlrev_b32 v50, 16, v27
    v_and_b32 v51, 0xffff0000, v27
    v_pk_mul_f32 v[52:53], v[44:45], v[28:29]
    v_pk_mul_f32 v[54:55], v[46:47], v[30:31]
    v_pk_mul_f32 v[56:57], v[48:49], v[32:33]
    v_pk_mul_f32 v[58:59], v[50:51], v[34:35]
    v_pk_fma_f32 v[22:23], v[44:45], v[36:37], v[22:23]
    v_pk_fma_f32 v[22:23], v[46:47], v[38:39], v[22:23]
    v_pk_fma_f32 v[22:23], v[48:49], v[40:41], v[22:23]
    v_pk_fma_f32 v[22:23], v[50:51], v[42:43], v[22:23]
    v_cvt_pk_bf16_f32 v60, v52, v53
    v_cvt_pk_bf16_f32 v61, v54, v55
    v_cvt_pk_bf16_f32 v62, v56, v57
    v_cvt_pk_bf16_f32 v63, v58, v59
    v_pk_add_f32 v[20:21], v[20:21], v[52:53]
    v_pk_add_f32 v[20:21], v[20:21], v[54:55]
    v_pk_add_f32 v[20:21], v[20:21], v[56:57]
    v_pk_add_f32 v[20:21], v[20:21], v[58:59]
    buffer_store_dwordx4 v[60:63], v8, s[28:31], s23 offen sc1
    v_add_f32 v20, v20, v21
    v_add_f32 v22, v22, v23
    v_lshlrev_b32 v3, 2, v70
    s_lshl_b32 s22, s17, 8
    v_add_u32 v3, s22, v3
    ds_write_b32 v3, v20 offset:41472
    ds_write_b32 v3, v22 offset:42496
    s_waitcnt lgkmcnt(0)
    s_barrier
    v_cmp_gt_u32 vcc, 32, v0
    s_and_saveexec_b64 s[44:45], vcc
    s_cbranch_execz front_kernel_fin
    v_lshrrev_b32 v3, 4, v0
    v_and_b32 v4, 15, v0
    v_lshlrev_b32 v3, 8, v3
    v_lshlrev_b32 v4, 2, v4
    v_add_u32 v3, v3, v4
    ds_read_b32 v8, v3 offset:41472
    ds_read_b32 v16, v3 offset:42496
    ds_read_b32 v9, v3 offset:41536
    ds_read_b32 v17, v3 offset:42560
    ds_read_b32 v10, v3 offset:41600
    ds_read_b32 v18, v3 offset:42624
    ds_read_b32 v11, v3 offset:41664
    ds_read_b32 v19, v3 offset:42688
    ds_read_b32 v12, v3 offset:41984
    ds_read_b32 v20, v3 offset:43008
    ds_read_b32 v13, v3 offset:42048
    ds_read_b32 v21, v3 offset:43072
    ds_read_b32 v14, v3 offset:42112
    ds_read_b32 v22, v3 offset:43136
    ds_read_b32 v15, v3 offset:42176
    ds_read_b32 v23, v3 offset:43200
    s_waitcnt lgkmcnt(0)
    v_add_f32 v8, v8, v9
    v_add_f32 v16, v16, v17
    v_add_f32 v8, v8, v10
    v_add_f32 v16, v16, v18
    v_add_f32 v8, v8, v11
    v_add_f32 v16, v16, v19
    v_add_f32 v8, v8, v12
    v_add_f32 v16, v16, v20
    v_add_f32 v8, v8, v13
    v_add_f32 v16, v16, v21
    v_add_f32 v8, v8, v14
    v_add_f32 v16, v16, v22
    v_add_f32 v8, v8, v15
    v_add_f32 v16, v16, v23
    s_add_u32 s26, s6, 23068672
    s_addc_u32 s27, s7, 0
    s_mov_b32 s28, s26
    s_and_b32 s29, s27, 0xffff
    s_mov_b32 s30, 36864
    s_mov_b32 s31, 0x20000
    v_mul_f32 v16, 0x3eeff558, v16
    s_lshl_b32 s20, s12, 7
    v_lshlrev_b32 v4, 2, v0
    s_add_u32 s21, s20, 18432
    buffer_store_dword v8, v4, s[28:31], s20 offen
    buffer_store_dword v16, v4, s[28:31], s21 offen
    s_branch front_kernel_fin
front_kernel_Dj:
    s_sub_u32 s24, s2, 0
    s_lshl_b32 s24, s24, 1
    s_mov_b32 s25, 0
    s_load_dwordx2 s[8:9], s[0:1], 104
    s_barrier
front_kernel_Dloop:
    s_mov_b32 s12, s24
    s_mul_i32 s13, s12, 7282
    s_lshr_b32 s13, s13, 16
    s_mul_i32 s14, s13, 9
    s_sub_u32 s14, s12, s14
    s_mul_i32 s15, s13, 18
    s_lshl_b32 s16, s14, 1
    s_add_u32 s18, s15, s16
    s_add_u32 s19, s18, 1
    s_cmp_ge_u32 s14, 4
    s_cselect_b32 s20, 1, 0
    s_add_u32 s18, s18, s20
    s_add_u32 s19, s19, s20
    s_cmp_eq_u32 s14, 8
    s_cbranch_scc0 front_kernel_D1
    s_add_u32 s18, s15, 8
    s_add_u32 s19, s15, 17
front_kernel_D1:
    s_mul_i32 s18, s18, 18432
    s_mul_i32 s19, s19, 18432
    s_sub_u32 s19, s19, 18432
    s_waitcnt lgkmcnt(0)
    s_mov_b32 s48, s8
    s_and_b32 s49, s9, 0xffff
    s_mov_b32 s50, 2654208
    s_mov_b32 s51, 0x20000
    v_add_u32 v3, 0, v0
    v_mul_u32_u24 v4, 58255, v3
    v_lshrrev_b32 v4, 22, v4
    v_mul_u32_u24 v5, 72, v4
    v_sub_u32 v5, v3, v5
    v_lshlrev_b32 v5, 4, v5
    v_mul_u32_u24 v6, 1152, v4
    v_add_u32 v6, v6, v5
    v_mov_b32 v7, s18
    v_mov_b32 v8, s19
    v_cmp_gt_u32 vcc, 16, v4
    v_mul_u32_u24 v9, 1184, v4
    v_add_u32 v60, v9, v5
    v_cndmask_b32 v7, v8, v7, vcc
    v_add_u32 v6, v6, v7
    buffer_load_dwordx4 v[16:19], v6, s[48:51], 0 offen
    v_add_u32 v3, 256, v0
    v_mul_u32_u24 v4, 58255, v3
    v_lshrrev_b32 v4, 22, v4
    v_mul_u32_u24 v5, 72, v4
    v_sub_u32 v5, v3, v5
    v_lshlrev_b32 v5, 4, v5
    v_mul_u32_u24 v6, 1152, v4
    v_add_u32 v6, v6, v5
    v_mov_b32 v7, s18
    v_mov_b32 v8, s19
    v_cmp_gt_u32 vcc, 16, v4
    v_mul_u32_u24 v9, 1184, v4
    v_add_u32 v61, v9, v5
    v_cndmask_b32 v7, v8, v7, vcc
    v_add_u32 v6, v6, v7
    buffer_load_dwordx4 v[20:23], v6, s[48:51], 0 offen
    v_add_u32 v3, 512, v0
    v_mul_u32_u24 v4, 58255, v3
    v_lshrrev_b32 v4, 22, v4
    v_mul_u32_u24 v5, 72, v4
    v_sub_u32 v5, v3, v5
    v_lshlrev_b32 v5, 4, v5
    v_mul_u32_u24 v6, 1152, v4
    v_add_u32 v6, v6, v5
    v_mov_b32 v7, s18
    v_mov_b32 v8, s19
    v_cmp_gt_u32 vcc, 16, v4
    v_mul_u32_u24 v9, 1184, v4
    v_add_u32 v62, v9, v5
    v_cndmask_b32 v7, v8, v7, vcc
    v_add_u32 v6, v6, v7
    buffer_load_dwordx4 v[24:27], v6, s[48:51], 0 offen
    v_add_u32 v3, 768, v0
    v_mul_u32_u24 v4, 58255, v3
    v_lshrrev_b32 v4, 22, v4
    v_mul_u32_u24 v5, 72, v4
    v_sub_u32 v5, v3, v5
    v_lshlrev_b32 v5, 4, v5
    v_mul_u32_u24 v6, 1152, v4
    v_add_u32 v6, v6, v5
    v_mov_b32 v7, s18
    v_mov_b32 v8, s19
    v_cmp_gt_u32 vcc, 16, v4
    v_mul_u32_u24 v9, 1184, v4
    v_add_u32 v63, v9, v5
    v_cndmask_b32 v7, v8, v7, vcc
    v_add_u32 v6, v6, v7
    buffer_load_dwordx4 v[28:31], v6, s[48:51], 0 offen
    v_add_u32 v3, 1024, v0
    v_mul_u32_u24 v4, 58255, v3
    v_lshrrev_b32 v4, 22, v4
    v_mul_u32_u24 v5, 72, v4
    v_sub_u32 v5, v3, v5
    v_lshlrev_b32 v5, 4, v5
    v_mul_u32_u24 v6, 1152, v4
    v_add_u32 v6, v6, v5
    v_mov_b32 v7, s18
    v_mov_b32 v8, s19
    v_cmp_gt_u32 vcc, 16, v4
    v_mul_u32_u24 v9, 1184, v4
    v_add_u32 v64, v9, v5
    v_cndmask_b32 v7, v8, v7, vcc
    v_add_u32 v6, v6, v7
    buffer_load_dwordx4 v[32:35], v6, s[48:51], 0 offen
    v_add_u32 v3, 1280, v0
    v_mul_u32_u24 v4, 58255, v3
    v_lshrrev_b32 v4, 22, v4
    v_mul_u32_u24 v5, 72, v4
    v_sub_u32 v5, v3, v5
    v_lshlrev_b32 v5, 4, v5
    v_mul_u32_u24 v6, 1152, v4
    v_add_u32 v6, v6, v5
    v_mov_b32 v7, s18
    v_mov_b32 v8, s19
    v_cmp_gt_u32 vcc, 16, v4
    v_mul_u32_u24 v9, 1184, v4
    v_add_u32 v65, v9, v5
    v_cndmask_b32 v7, v8, v7, vcc
    v_add_u32 v6, v6, v7
    buffer_load_dwordx4 v[36:39], v6, s[48:51], 0 offen
    v_add_u32 v3, 1536, v0
    v_mul_u32_u24 v4, 58255, v3
    v_lshrrev_b32 v4, 22, v4
    v_mul_u32_u24 v5, 72, v4
    v_sub_u32 v5, v3, v5
    v_lshlrev_b32 v5, 4, v5
    v_mul_u32_u24 v6, 1152, v4
    v_add_u32 v6, v6, v5
    v_mov_b32 v7, s18
    v_mov_b32 v8, s19
    v_cmp_gt_u32 vcc, 16, v4
    v_mul_u32_u24 v9, 1184, v4
    v_add_u32 v66, v9, v5
    v_cndmask_b32 v7, v8, v7, vcc
    v_add_u32 v6, v6, v7
    buffer_load_dwordx4 v[40:43], v6, s[48:51], 0 offen
    v_add_u32 v3, 1792, v0
    v_mul_u32_u24 v4, 58255, v3
    v_lshrrev_b32 v4, 22, v4
    v_mul_u32_u24 v5, 72, v4
    v_sub_u32 v5, v3, v5
    v_lshlrev_b32 v5, 4, v5
    v_mul_u32_u24 v6, 1152, v4
    v_add_u32 v6, v6, v5
    v_mov_b32 v7, s18
    v_mov_b32 v8, s19
    v_cmp_gt_u32 vcc, 16, v4
    v_mul_u32_u24 v9, 1184, v4
    v_add_u32 v67, v9, v5
    v_cndmask_b32 v7, v8, v7, vcc
    v_add_u32 v6, v6, v7
    buffer_load_dwordx4 v[44:47], v6, s[48:51], 0 offen
    v_add_u32 v3, 2048, v0
    v_mul_u32_u24 v4, 58255, v3
    v_lshrrev_b32 v4, 22, v4
    v_mul_u32_u24 v5, 72, v4
    v_sub_u32 v5, v3, v5
    v_lshlrev_b32 v5, 4, v5
    v_mul_u32_u24 v6, 1152, v4
    v_add_u32 v6, v6, v5
    v_mov_b32 v7, s18
    v_mov_b32 v8, s19
    v_cmp_gt_u32 vcc, 16, v4
    v_mul_u32_u24 v9, 1184, v4
    v_add_u32 v68, v9, v5
    v_cndmask_b32 v7, v8, v7, vcc
    v_add_u32 v6, v6, v7
    buffer_load_dwordx4 v[48:51], v6, s[48:51], 0 offen
    s_waitcnt vmcnt(0)
    ds_write_b128 v60, v[16:19]
    ds_write_b128 v61, v[20:23]
    ds_write_b128 v62, v[24:27]
    ds_write_b128 v63, v[28:31]
    ds_write_b128 v64, v[32:35]
    ds_write_b128 v65, v[36:39]
    ds_write_b128 v66, v[40:43]
    ds_write_b128 v67, v[44:47]
    ds_write_b128 v68, v[48:51]
    s_add_u32 s26, s6, 12582912
    s_addc_u32 s27, s7, 0
    s_mov_b32 s48, s26
    s_and_b32 s49, s27, 0xffff
    s_mov_b32 s50, 2949120
    s_mov_b32 s51, 0x20000
    v_lshrrev_b32 v3, 4, v2
    v_bfe_u32 v5, v2, 2, 2
    v_and_b32 v6, 3, v2
    v_lshlrev_b32 v3, 2, v3
    v_add_u32 v3, v3, v5
    v_mul_u32_u24 v3, 1184, v3
    v_lshlrev_b32 v6, 3, v6
    v_add_u32 v3, v3, v6
    s_mul_i32 s20, s17, 288
    v_add_u32 v3, s20, v3
    v_lshlrev_b32 v4, 4, v2
    s_mul_i32 s21, s17, 737280
    s_mul_i32 s22, s12, 5120
    s_add_u32 s21, s21, s22
    s_waitcnt lgkmcnt(0)
    s_barrier
    ds_read_b64_tr_b16 v[16:17], v3 offset:0
    ds_read_b64_tr_b16 v[18:19], v3 offset:18944
    s_add_u32 s23, s21, 0
    s_waitcnt lgkmcnt(0)
    buffer_store_dwordx4 v[16:19], v4, s[48:51], s23 offen sc1
    ds_read_b64_tr_b16 v[20:21], v3 offset:32
    ds_read_b64_tr_b16 v[22:23], v3 offset:18976
    s_add_u32 s23, s21, 1024
    s_waitcnt lgkmcnt(0)
    buffer_store_dwordx4 v[20:23], v4, s[48:51], s23 offen sc1
    ds_read_b64_tr_b16 v[24:25], v3 offset:64
    ds_read_b64_tr_b16 v[26:27], v3 offset:19008
    s_add_u32 s23, s21, 2048
    s_waitcnt lgkmcnt(0)
    buffer_store_dwordx4 v[24:27], v4, s[48:51], s23 offen sc1
    ds_read_b64_tr_b16 v[28:29], v3 offset:96
    ds_read_b64_tr_b16 v[30:31], v3 offset:19040
    s_add_u32 s23, s21, 3072
    s_waitcnt lgkmcnt(0)
    buffer_store_dwordx4 v[28:31], v4, s[48:51], s23 offen sc1
    ds_read_b64_tr_b16 v[16:17], v3 offset:128
    ds_read_b64_tr_b16 v[18:19], v3 offset:19072
    s_add_u32 s23, s21, 4096
    s_waitcnt lgkmcnt(0)
    buffer_store_dwordx4 v[16:19], v4, s[48:51], s23 offen sc1
    ds_read_b64_tr_b16 v[20:21], v3 offset:144
    ds_read_b64_tr_b16 v[22:23], v3 offset:19088
    s_add_u32 s23, s21, 368640
    s_waitcnt lgkmcnt(0)
    buffer_store_dwordx4 v[20:23], v4, s[48:51], s23 offen sc1
    ds_read_b64_tr_b16 v[24:25], v3 offset:176
    ds_read_b64_tr_b16 v[26:27], v3 offset:19120
    s_add_u32 s23, s21, 369664
    s_waitcnt lgkmcnt(0)
    buffer_store_dwordx4 v[24:27], v4, s[48:51], s23 offen sc1
    ds_read_b64_tr_b16 v[28:29], v3 offset:208
    ds_read_b64_tr_b16 v[30:31], v3 offset:19152
    s_add_u32 s23, s21, 370688
    s_waitcnt lgkmcnt(0)
    buffer_store_dwordx4 v[28:31], v4, s[48:51], s23 offen sc1
    ds_read_b64_tr_b16 v[16:17], v3 offset:240
    ds_read_b64_tr_b16 v[18:19], v3 offset:19184
    s_add_u32 s23, s21, 371712
    s_waitcnt lgkmcnt(0)
    buffer_store_dwordx4 v[16:19], v4, s[48:51], s23 offen sc1
    ds_read_b64_tr_b16 v[20:21], v3 offset:272
    ds_read_b64_tr_b16 v[22:23], v3 offset:19216
    s_add_u32 s23, s21, 372736
    s_waitcnt lgkmcnt(0)
    buffer_store_dwordx4 v[20:23], v4, s[48:51], s23 offen sc1
    s_barrier
    s_add_u32 s24, s24, 1
    s_add_u32 s25, s25, 1
    s_cmp_lt_u32 s25, 2
    s_cbranch_scc1 front_kernel_Dloop
    s_branch front_kernel_fin
front_kernel_C:
    s_load_dwordx4 s[28:31], s[0:1], 8
    s_load_dwordx4 s[32:35], s[0:1], 24
    s_load_dwordx4 s[36:39], s[0:1], 40
    s_load_dwordx2 s[40:41], s[0:1], 56
    s_load_dwordx2 s[60:61], s[0:1], 64
    s_and_b32 s3, s2, 7
    s_sub_u32 s13, s2, 182
    s_lshr_b32 s13, s13, 3
    s_lshr_b32 s14, s13, 3
    s_lshl_b32 s14, s14, 3
    s_add_u32 s3, s3, s14
    s_lshl_b32 s3, s3, 3
    s_and_b32 s13, s13, 7
    s_add_u32 s3, s3, s13
    v_and_b32 v3, 127, v0
    v_lshlrev_b32 v4, 1, v3
    s_lshl_b32 s13, s3, 8
    v_add_u32 v4, s13, v4
    s_lshl_b32 s14, s3, 1
    s_and_b32 s57, s14, 2
    s_and_b32 s14, s14, 0xfffffffc
    s_waitcnt lgkmcnt(0)
    s_add_u32 s40, s40, s14
    s_addc_u32 s41, s41, 0
    s_add_u32 s60, s60, s14
    s_addc_u32 s61, s61, 0
    s_load_dword s56, s[40:41], 0
    s_load_dword s62, s[60:61], 0
    global_load_ushort v150, v4, s[28:29]
    global_load_ushort v151, v4, s[30:31]
    global_load_ushort v152, v4, s[32:33]
    global_load_ushort v153, v4, s[34:35]
    global_load_ushort v154, v4, s[36:37]
    global_load_ushort v155, v4, s[38:39]
    v_lshlrev_b32 v5, 5, v0
    v_sub_u32 v5, 8192, v5
    v_cvt_f32_i32 v5, v5
    v_mov_b32 v6, v5
    v_add_f32 v7, 0xc0800000, v5
    v_cvt_pk_bf16_f32 v6, v6, v7
    v_and_b32 v7, 0xffff0000, v6
    v_lshlrev_b32 v6, 16, v6
    v_cvt_u32_f32 v100, v6
    v_cvt_u32_f32 v101, v7
    v_add_f32 v6, 0xc1000000, v5
    v_add_f32 v7, 0xc1400000, v5
    v_cvt_pk_bf16_f32 v6, v6, v7
    v_and_b32 v7, 0xffff0000, v6
    v_lshlrev_b32 v6, 16, v6
    v_cvt_u32_f32 v102, v6
    v_cvt_u32_f32 v103, v7
    v_add_f32 v6, 0xc1800000, v5
    v_add_f32 v7, 0xc1a00000, v5
    v_cvt_pk_bf16_f32 v6, v6, v7
    v_and_b32 v7, 0xffff0000, v6
    v_lshlrev_b32 v6, 16, v6
    v_cvt_u32_f32 v104, v6
    v_cvt_u32_f32 v105, v7
    v_add_f32 v6, 0xc1c00000, v5
    v_add_f32 v7, 0xc1e00000, v5
    v_cvt_pk_bf16_f32 v6, v6, v7
    v_and_b32 v7, 0xffff0000, v6
    v_lshlrev_b32 v6, 16, v6
    v_cvt_u32_f32 v106, v6
    v_cvt_u32_f32 v107, v7
    v_add_f32 v6, 0xc2000000, v5
    v_add_f32 v7, 0xc2100000, v5
    v_cvt_pk_bf16_f32 v6, v6, v7
    v_and_b32 v7, 0xffff0000, v6
    v_lshlrev_b32 v6, 16, v6
    v_cvt_u32_f32 v108, v6
    v_cvt_u32_f32 v109, v7
    v_add_f32 v6, 0xc2200000, v5
    v_add_f32 v7, 0xc2300000, v5
    v_cvt_pk_bf16_f32 v6, v6, v7
    v_and_b32 v7, 0xffff0000, v6
    v_lshlrev_b32 v6, 16, v6
    v_cvt_u32_f32 v110, v6
    v_cvt_u32_f32 v111, v7
    v_add_f32 v6, 0xc2400000, v5
    v_add_f32 v7, 0xc2500000, v5
    v_cvt_pk_bf16_f32 v6, v6, v7
    v_and_b32 v7, 0xffff0000, v6
    v_lshlrev_b32 v6, 16, v6
    v_cvt_u32_f32 v112, v6
    v_cvt_u32_f32 v113, v7
    v_add_f32 v6, 0xc2600000, v5
    v_cvt_pk_bf16_f32 v6, v6, v6
    v_lshlrev_b32 v6, 16, v6
    v_cvt_u32_f32 v114, v6
    s_waitcnt lgkmcnt(0)
    s_lshl_b32 s15, s57, 3
    s_lshr_b32 s56, s56, s15
    s_lshl_b32 s56, s56, 16
    s_lshr_b32 s62, s62, s15
    s_lshl_b32 s62, s62, 16
    v_mov_b32 v14, s56
    v_mul_f32 v15, 0x3fb8aa3b, v14
    s_mov_b32 s18, 0x3fb8aa3b
    v_fma_f32 v16, v14, s18, -v15
    v_fmac_f32 v16, 0x32a57060, v14
    v_exp_f32 v15, v15
    v_mul_f32 v16, 0x3f317218, v16
    s_nop 0
    v_fma_f32 v15, v15, v16, v15
    v_cvt_pk_bf16_f32 v15, v15, v15
    v_lshlrev_b32 v15, 16, v15
    s_waitcnt vmcnt(0)
    v_lshlrev_b32 v8, 16, v150
    v_lshlrev_b32 v9, 16, v151
    v_lshlrev_b32 v10, 16, v152
    v_lshlrev_b32 v11, 16, v153
    v_lshlrev_b32 v12, 16, v154
    v_lshlrev_b32 v13, 16, v155
    v_mul_f32 v20, v15, v8
    v_mul_f32 v21, v15, v9
    v_mul_f32 v10, v15, v10
    v_mul_f32 v11, v15, v11
    v_mul_f32 v22, v12, v10
    v_fma_f32 v22, -v13, v11, v22
    v_mul_f32 v23, v12, v11
    v_fmac_f32 v23, v13, v10
    v_lshlrev_b32 v7, 2, v3
    s_cmp_ge_u32 s17, 2
    s_cbranch_scc1 front_kernel_C1
    v_mul_f32 v5, 0x3f800000, v20
    v_mul_f32 v5, 0x3fb8aa3b, v5
    v_mul_f32 v6, 0x3f800000, v21
    v_mul_f32 v6, 0x3e22f983, v6
    v_fract_f32 v6, v6
    v_exp_f32 v5, v5
    v_cos_f32 v24, v6
    v_sin_f32 v25, v6
    s_nop 0
    v_mul_f32 v24, v24, v5
    v_mul_f32 v25, v25, v5
    v_sub_f32 v32, 0, v25
    v_mov_b32 v33, v24
    v_mov_b32 v26, 1.0
    v_mov_b32 v27, 0
    v_pk_mul_f32 v[28:29], v[26:27], v[24:25] op_sel_hi:[0,1]
    v_pk_fma_f32 v[28:29], v[26:27], v[32:33], v[28:29] op_sel:[1,0,0]
    v_cvt_pk_bf16_f32 v30, v26, -v27
    ds_write_b32 v7, v30 offset:33792
    v_pk_mul_f32 v[26:27], v[28:29], v[24:25] op_sel_hi:[0,1]
    v_pk_fma_f32 v[26:27], v[28:29], v[32:33], v[26:27] op_sel:[1,0,0]
    v_cvt_pk_bf16_f32 v30, v28, -v29
    ds_write_b32 v7, v30 offset:34320
    v_pk_mul_f32 v[28:29], v[26:27], v[24:25] op_sel_hi:[0,1]
    v_pk_fma_f32 v[28:29], v[26:27], v[32:33], v[28:29] op_sel:[1,0,0]
    v_cvt_pk_bf16_f32 v30, v26, -v27
    ds_write_b32 v7, v30 offset:34848
    v_pk_mul_f32 v[26:27], v[28:29], v[24:25] op_sel_hi:[0,1]
    v_pk_fma_f32 v[26:27], v[28:29], v[32:33], v[26:27] op_sel:[1,0,0]
    v_cvt_pk_bf16_f32 v30, v28, -v29
    ds_write_b32 v7, v30 offset:35376
    v_pk_mul_f32 v[28:29], v[26:27], v[24:25] op_sel_hi:[0,1]
    v_pk_fma_f32 v[28:29], v[26:27], v[32:33], v[28:29] op_sel:[1,0,0]
    v_cvt_pk_bf16_f32 v30, v26, -v27
    ds_write_b32 v7, v30 offset:35904
    v_pk_mul_f32 v[26:27], v[28:29], v[24:25] op_sel_hi:[0,1]
    v_pk_fma_f32 v[26:27], v[28:29], v[32:33], v[26:27] op_sel:[1,0,0]
    v_cvt_pk_bf16_f32 v30, v28, -v29
    ds_write_b32 v7, v30 offset:36432
    v_pk_mul_f32 v[28:29], v[26:27], v[24:25] op_sel_hi:[0,1]
    v_pk_fma_f32 v[28:29], v[26:27], v[32:33], v[28:29] op_sel:[1,0,0]
    v_cvt_pk_bf16_f32 v30, v26, -v27
    ds_write_b32 v7, v30 offset:36960
    v_pk_mul_f32 v[26:27], v[28:29], v[24:25] op_sel_hi:[0,1]
    v_pk_fma_f32 v[26:27], v[28:29], v[32:33], v[26:27] op_sel:[1,0,0]
    v_cvt_pk_bf16_f32 v30, v28, -v29
    ds_write_b32 v7, v30 offset:37488
    v_pk_mul_f32 v[28:29], v[26:27], v[24:25] op_sel_hi:[0,1]
    v_pk_fma_f32 v[28:29], v[26:27], v[32:33], v[28:29] op_sel:[1,0,0]
    v_cvt_pk_bf16_f32 v30, v26, -v27
    ds_write_b32 v7, v30 offset:38016
    v_pk_mul_f32 v[26:27], v[28:29], v[24:25] op_sel_hi:[0,1]
    v_pk_fma_f32 v[26:27], v[28:29], v[32:33], v[26:27] op_sel:[1,0,0]
    v_cvt_pk_bf16_f32 v30, v28, -v29
    ds_write_b32 v7, v30 offset:38544
    v_pk_mul_f32 v[28:29], v[26:27], v[24:25] op_sel_hi:[0,1]
    v_pk_fma_f32 v[28:29], v[26:27], v[32:33], v[28:29] op_sel:[1,0,0]
    v_cvt_pk_bf16_f32 v30, v26, -v27
    ds_write_b32 v7, v30 offset:39072
    v_pk_mul_f32 v[26:27], v[28:29], v[24:25] op_sel_hi:[0,1]
    v_pk_fma_f32 v[26:27], v[28:29], v[32:33], v[26:27] op_sel:[1,0,0]
    v_cvt_pk_bf16_f32 v30, v28, -v29
    ds_write_b32 v7, v30 offset:39600
    v_pk_mul_f32 v[28:29], v[26:27], v[24:25] op_sel_hi:[0,1]
    v_pk_fma_f32 v[28:29], v[26:27], v[32:33], v[28:29] op_sel:[1,0,0]
    v_cvt_pk_bf16_f32 v30, v26, -v27
    ds_write_b32 v7, v30 offset:40128
    v_pk_mul_f32 v[26:27], v[28:29], v[24:25] op_sel_hi:[0,1]
    v_pk_fma_f32 v[26:27], v[28:29], v[32:33], v[26:27] op_sel:[1,0,0]
    v_cvt_pk_bf16_f32 v30, v28, -v29
    ds_write_b32 v7, v30 offset:40656
    v_pk_mul_f32 v[28:29], v[26:27], v[24:25] op_sel_hi:[0,1]
    v_pk_fma_f32 v[28:29], v[26:27], v[32:33], v[28:29] op_sel:[1,0,0]
    v_cvt_pk_bf16_f32 v30, v26, -v27
    ds_write_b32 v7, v30 offset:41184
    v_pk_mul_f32 v[26:27], v[28:29], v[24:25] op_sel_hi:[0,1]
    v_pk_fma_f32 v[26:27], v[28:29], v[32:33], v[26:27] op_sel:[1,0,0]
    v_cvt_pk_bf16_f32 v30, v28, -v29
    ds_write_b32 v7, v30 offset:41712
    v_pk_mul_f32 v[28:29], v[26:27], v[24:25] op_sel_hi:[0,1]
    v_pk_fma_f32 v[28:29], v[26:27], v[32:33], v[28:29] op_sel:[1,0,0]
    v_cvt_pk_bf16_f32 v30, v26, -v27
    ds_write_b32 v7, v30 offset:42240
    v_pk_mul_f32 v[26:27], v[28:29], v[24:25] op_sel_hi:[0,1]
    v_pk_fma_f32 v[26:27], v[28:29], v[32:33], v[26:27] op_sel:[1,0,0]
    v_cvt_pk_bf16_f32 v30, v28, -v29
    ds_write_b32 v7, v30 offset:42768
    v_pk_mul_f32 v[28:29], v[26:27], v[24:25] op_sel_hi:[0,1]
    v_pk_fma_f32 v[28:29], v[26:27], v[32:33], v[28:29] op_sel:[1,0,0]
    v_cvt_pk_bf16_f32 v30, v26, -v27
    ds_write_b32 v7, v30 offset:43296
    v_pk_mul_f32 v[26:27], v[28:29], v[24:25] op_sel_hi:[0,1]
    v_pk_fma_f32 v[26:27], v[28:29], v[32:33], v[26:27] op_sel:[1,0,0]
    v_cvt_pk_bf16_f32 v30, v28, -v29
    ds_write_b32 v7, v30 offset:43824
    v_pk_mul_f32 v[28:29], v[26:27], v[24:25] op_sel_hi:[0,1]
    v_pk_fma_f32 v[28:29], v[26:27], v[32:33], v[28:29] op_sel:[1,0,0]
    v_cvt_pk_bf16_f32 v30, v26, -v27
    ds_write_b32 v7, v30 offset:44352
    v_pk_mul_f32 v[26:27], v[28:29], v[24:25] op_sel_hi:[0,1]
    v_pk_fma_f32 v[26:27], v[28:29], v[32:33], v[26:27] op_sel:[1,0,0]
    v_cvt_pk_bf16_f32 v30, v28, -v29
    ds_write_b32 v7, v30 offset:44880
    v_pk_mul_f32 v[28:29], v[26:27], v[24:25] op_sel_hi:[0,1]
    v_pk_fma_f32 v[28:29], v[26:27], v[32:33], v[28:29] op_sel:[1,0,0]
    v_cvt_pk_bf16_f32 v30, v26, -v27
    ds_write_b32 v7, v30 offset:45408
    v_pk_mul_f32 v[26:27], v[28:29], v[24:25] op_sel_hi:[0,1]
    v_pk_fma_f32 v[26:27], v[28:29], v[32:33], v[26:27] op_sel:[1,0,0]
    v_cvt_pk_bf16_f32 v30, v28, -v29
    ds_write_b32 v7, v30 offset:45936
    v_pk_mul_f32 v[28:29], v[26:27], v[24:25] op_sel_hi:[0,1]
    v_pk_fma_f32 v[28:29], v[26:27], v[32:33], v[28:29] op_sel:[1,0,0]
    v_cvt_pk_bf16_f32 v30, v26, -v27
    ds_write_b32 v7, v30 offset:46464
    v_pk_mul_f32 v[26:27], v[28:29], v[24:25] op_sel_hi:[0,1]
    v_pk_fma_f32 v[26:27], v[28:29], v[32:33], v[26:27] op_sel:[1,0,0]
    v_cvt_pk_bf16_f32 v30, v28, -v29
    ds_write_b32 v7, v30 offset:46992
    v_pk_mul_f32 v[28:29], v[26:27], v[24:25] op_sel_hi:[0,1]
    v_pk_fma_f32 v[28:29], v[26:27], v[32:33], v[28:29] op_sel:[1,0,0]
    v_cvt_pk_bf16_f32 v30, v26, -v27
    ds_write_b32 v7, v30 offset:47520
    v_pk_mul_f32 v[26:27], v[28:29], v[24:25] op_sel_hi:[0,1]
    v_pk_fma_f32 v[26:27], v[28:29], v[32:33], v[26:27] op_sel:[1,0,0]
    v_cvt_pk_bf16_f32 v30, v28, -v29
    ds_write_b32 v7, v30 offset:48048
    v_pk_mul_f32 v[28:29], v[26:27], v[24:25] op_sel_hi:[0,1]
    v_pk_fma_f32 v[28:29], v[26:27], v[32:33], v[28:29] op_sel:[1,0,0]
    v_cvt_pk_bf16_f32 v30, v26, -v27
    ds_write_b32 v7, v30 offset:48576
    v_pk_mul_f32 v[26:27], v[28:29], v[24:25] op_sel_hi:[0,1]
    v_pk_fma_f32 v[26:27], v[28:29], v[32:33], v[26:27] op_sel:[1,0,0]
    v_cvt_pk_bf16_f32 v30, v28, -v29
    ds_write_b32 v7, v30 offset:49104
    v_pk_mul_f32 v[28:29], v[26:27], v[24:25] op_sel_hi:[0,1]
    v_pk_fma_f32 v[28:29], v[26:27], v[32:33], v[28:29] op_sel:[1,0,0]
    v_cvt_pk_bf16_f32 v30, v26, -v27
    ds_write_b32 v7, v30 offset:49632
    v_cvt_pk_bf16_f32 v30, v28, -v29
    ds_write_b32 v7, v30 offset:50160
    v_mul_f32 v5, 0x42000000, v20
    v_mul_f32 v5, 0x3fb8aa3b, v5
    v_mul_f32 v6, 0x42000000, v21
    v_mul_f32 v6, 0x3e22f983, v6
    v_fract_f32 v6, v6
    v_exp_f32 v5, v5
    v_cos_f32 v24, v6
    v_sin_f32 v25, v6
    s_nop 0
    v_mul_f32 v24, v24, v5
    v_mul_f32 v25, v25, v5
    v_sub_f32 v32, 0, v25
    v_mov_b32 v33, v24
    v_mov_b32 v26, v22
    v_mov_b32 v27, v23
    v_pk_mul_f32 v[28:29], v[26:27], v[24:25] op_sel_hi:[0,1]
    v_pk_fma_f32 v[28:29], v[26:27], v[32:33], v[28:29] op_sel:[1,0,0]
    v_cvt_pk_bf16_f32 v30, v26, v27
    ds_write_b32 v7, v30 offset:0
    v_pk_mul_f32 v[26:27], v[28:29], v[24:25] op_sel_hi:[0,1]
    v_pk_fma_f32 v[26:27], v[28:29], v[32:33], v[26:27] op_sel:[1,0,0]
    v_cvt_pk_bf16_f32 v30, v28, v29
    ds_write_b32 v7, v30 offset:528
    v_pk_mul_f32 v[28:29], v[26:27], v[24:25] op_sel_hi:[0,1]
    v_pk_fma_f32 v[28:29], v[26:27], v[32:33], v[28:29] op_sel:[1,0,0]
    v_cvt_pk_bf16_f32 v30, v26, v27
    ds_write_b32 v7, v30 offset:1056
    v_pk_mul_f32 v[26:27], v[28:29], v[24:25] op_sel_hi:[0,1]
    v_pk_fma_f32 v[26:27], v[28:29], v[32:33], v[26:27] op_sel:[1,0,0]
    v_cvt_pk_bf16_f32 v30, v28, v29
    ds_write_b32 v7, v30 offset:1584
    v_pk_mul_f32 v[28:29], v[26:27], v[24:25] op_sel_hi:[0,1]
    v_pk_fma_f32 v[28:29], v[26:27], v[32:33], v[28:29] op_sel:[1,0,0]
    v_cvt_pk_bf16_f32 v30, v26, v27
    ds_write_b32 v7, v30 offset:2112
    v_pk_mul_f32 v[26:27], v[28:29], v[24:25] op_sel_hi:[0,1]
    v_pk_fma_f32 v[26:27], v[28:29], v[32:33], v[26:27] op_sel:[1,0,0]
    v_cvt_pk_bf16_f32 v30, v28, v29
    ds_write_b32 v7, v30 offset:2640
    v_pk_mul_f32 v[28:29], v[26:27], v[24:25] op_sel_hi:[0,1]
    v_pk_fma_f32 v[28:29], v[26:27], v[32:33], v[28:29] op_sel:[1,0,0]
    v_cvt_pk_bf16_f32 v30, v26, v27
    ds_write_b32 v7, v30 offset:3168
    v_pk_mul_f32 v[26:27], v[28:29], v[24:25] op_sel_hi:[0,1]
    v_pk_fma_f32 v[26:27], v[28:29], v[32:33], v[26:27] op_sel:[1,0,0]
    v_cvt_pk_bf16_f32 v30, v28, v29
    ds_write_b32 v7, v30 offset:3696
    v_pk_mul_f32 v[28:29], v[26:27], v[24:25] op_sel_hi:[0,1]
    v_pk_fma_f32 v[28:29], v[26:27], v[32:33], v[28:29] op_sel:[1,0,0]
    v_cvt_pk_bf16_f32 v30, v26, v27
    ds_write_b32 v7, v30 offset:4224
    v_pk_mul_f32 v[26:27], v[28:29], v[24:25] op_sel_hi:[0,1]
    v_pk_fma_f32 v[26:27], v[28:29], v[32:33], v[26:27] op_sel:[1,0,0]
    v_cvt_pk_bf16_f32 v30, v28, v29
    ds_write_b32 v7, v30 offset:4752
    v_pk_mul_f32 v[28:29], v[26:27], v[24:25] op_sel_hi:[0,1]
    v_pk_fma_f32 v[28:29], v[26:27], v[32:33], v[28:29] op_sel:[1,0,0]
    v_cvt_pk_bf16_f32 v30, v26, v27
    ds_write_b32 v7, v30 offset:5280
    v_pk_mul_f32 v[26:27], v[28:29], v[24:25] op_sel_hi:[0,1]
    v_pk_fma_f32 v[26:27], v[28:29], v[32:33], v[26:27] op_sel:[1,0,0]
    v_cvt_pk_bf16_f32 v30, v28, v29
    ds_write_b32 v7, v30 offset:5808
    v_pk_mul_f32 v[28:29], v[26:27], v[24:25] op_sel_hi:[0,1]
    v_pk_fma_f32 v[28:29], v[26:27], v[32:33], v[28:29] op_sel:[1,0,0]
    v_cvt_pk_bf16_f32 v30, v26, v27
    ds_write_b32 v7, v30 offset:6336
    v_pk_mul_f32 v[26:27], v[28:29], v[24:25] op_sel_hi:[0,1]
    v_pk_fma_f32 v[26:27], v[28:29], v[32:33], v[26:27] op_sel:[1,0,0]
    v_cvt_pk_bf16_f32 v30, v28, v29
    ds_write_b32 v7, v30 offset:6864
    v_pk_mul_f32 v[28:29], v[26:27], v[24:25] op_sel_hi:[0,1]
    v_pk_fma_f32 v[28:29], v[26:27], v[32:33], v[28:29] op_sel:[1,0,0]
    v_cvt_pk_bf16_f32 v30, v26, v27
    ds_write_b32 v7, v30 offset:7392
    v_cvt_pk_bf16_f32 v30, v28, v29
    ds_write_b32 v7, v30 offset:7920
    s_branch front_kernel_C2
front_kernel_C1:
    v_mul_f32 v5, 0x44000000, v20
    v_mul_f32 v5, 0x3fb8aa3b, v5
    v_mul_f32 v6, 0x44000000, v21
    v_mul_f32 v6, 0x3e22f983, v6
    v_fract_f32 v6, v6
    v_exp_f32 v5, v5
    v_cos_f32 v24, v6
    v_sin_f32 v25, v6
    s_nop 0
    v_mul_f32 v24, v24, v5
    v_mul_f32 v25, v25, v5
    v_sub_f32 v32, 0, v25
    v_mov_b32 v33, v24
    v_pk_mul_f32 v[26:27], v[22:23], v[24:25] op_sel_hi:[0,1]
    v_pk_fma_f32 v[26:27], v[22:23], v[32:33], v[26:27] op_sel:[1,0,0]
    v_mul_f32 v5, 0x42000000, v20
    v_mul_f32 v5, 0x3fb8aa3b, v5
    v_mul_f32 v6, 0x42000000, v21
    v_mul_f32 v6, 0x3e22f983, v6
    v_fract_f32 v6, v6
    v_exp_f32 v5, v5
    v_cos_f32 v24, v6
    v_sin_f32 v25, v6
    s_nop 0
    v_mul_f32 v24, v24, v5
    v_mul_f32 v25, v25, v5
    v_sub_f32 v32, 0, v25
    v_mov_b32 v33, v24
    v_pk_mul_f32 v[28:29], v[26:27], v[24:25] op_sel_hi:[0,1]
    v_pk_fma_f32 v[28:29], v[26:27], v[32:33], v[28:29] op_sel:[1,0,0]
    v_cvt_pk_bf16_f32 v30, v26, v27
    ds_write_b32 v7, v30 offset:8448
    v_pk_mul_f32 v[26:27], v[28:29], v[24:25] op_sel_hi:[0,1]
    v_pk_fma_f32 v[26:27], v[28:29], v[32:33], v[26:27] op_sel:[1,0,0]
    v_cvt_pk_bf16_f32 v30, v28, v29
    ds_write_b32 v7, v30 offset:8976
    v_pk_mul_f32 v[28:29], v[26:27], v[24:25] op_sel_hi:[0,1]
    v_pk_fma_f32 v[28:29], v[26:27], v[32:33], v[28:29] op_sel:[1,0,0]
    v_cvt_pk_bf16_f32 v30, v26, v27
    ds_write_b32 v7, v30 offset:9504
    v_pk_mul_f32 v[26:27], v[28:29], v[24:25] op_sel_hi:[0,1]
    v_pk_fma_f32 v[26:27], v[28:29], v[32:33], v[26:27] op_sel:[1,0,0]
    v_cvt_pk_bf16_f32 v30, v28, v29
    ds_write_b32 v7, v30 offset:10032
    v_pk_mul_f32 v[28:29], v[26:27], v[24:25] op_sel_hi:[0,1]
    v_pk_fma_f32 v[28:29], v[26:27], v[32:33], v[28:29] op_sel:[1,0,0]
    v_cvt_pk_bf16_f32 v30, v26, v27
    ds_write_b32 v7, v30 offset:10560
    v_pk_mul_f32 v[26:27], v[28:29], v[24:25] op_sel_hi:[0,1]
    v_pk_fma_f32 v[26:27], v[28:29], v[32:33], v[26:27] op_sel:[1,0,0]
    v_cvt_pk_bf16_f32 v30, v28, v29
    ds_write_b32 v7, v30 offset:11088
    v_pk_mul_f32 v[28:29], v[26:27], v[24:25] op_sel_hi:[0,1]
    v_pk_fma_f32 v[28:29], v[26:27], v[32:33], v[28:29] op_sel:[1,0,0]
    v_cvt_pk_bf16_f32 v30, v26, v27
    ds_write_b32 v7, v30 offset:11616
    v_pk_mul_f32 v[26:27], v[28:29], v[24:25] op_sel_hi:[0,1]
    v_pk_fma_f32 v[26:27], v[28:29], v[32:33], v[26:27] op_sel:[1,0,0]
    v_cvt_pk_bf16_f32 v30, v28, v29
    ds_write_b32 v7, v30 offset:12144
    v_pk_mul_f32 v[28:29], v[26:27], v[24:25] op_sel_hi:[0,1]
    v_pk_fma_f32 v[28:29], v[26:27], v[32:33], v[28:29] op_sel:[1,0,0]
    v_cvt_pk_bf16_f32 v30, v26, v27
    ds_write_b32 v7, v30 offset:12672
    v_pk_mul_f32 v[26:27], v[28:29], v[24:25] op_sel_hi:[0,1]
    v_pk_fma_f32 v[26:27], v[28:29], v[32:33], v[26:27] op_sel:[1,0,0]
    v_cvt_pk_bf16_f32 v30, v28, v29
    ds_write_b32 v7, v30 offset:13200
    v_pk_mul_f32 v[28:29], v[26:27], v[24:25] op_sel_hi:[0,1]
    v_pk_fma_f32 v[28:29], v[26:27], v[32:33], v[28:29] op_sel:[1,0,0]
    v_cvt_pk_bf16_f32 v30, v26, v27
    ds_write_b32 v7, v30 offset:13728
    v_pk_mul_f32 v[26:27], v[28:29], v[24:25] op_sel_hi:[0,1]
    v_pk_fma_f32 v[26:27], v[28:29], v[32:33], v[26:27] op_sel:[1,0,0]
    v_cvt_pk_bf16_f32 v30, v28, v29
    ds_write_b32 v7, v30 offset:14256
    v_pk_mul_f32 v[28:29], v[26:27], v[24:25] op_sel_hi:[0,1]
    v_pk_fma_f32 v[28:29], v[26:27], v[32:33], v[28:29] op_sel:[1,0,0]
    v_cvt_pk_bf16_f32 v30, v26, v27
    ds_write_b32 v7, v30 offset:14784
    v_pk_mul_f32 v[26:27], v[28:29], v[24:25] op_sel_hi:[0,1]
    v_pk_fma_f32 v[26:27], v[28:29], v[32:33], v[26:27] op_sel:[1,0,0]
    v_cvt_pk_bf16_f32 v30, v28, v29
    ds_write_b32 v7, v30 offset:15312
    v_pk_mul_f32 v[28:29], v[26:27], v[24:25] op_sel_hi:[0,1]
    v_pk_fma_f32 v[28:29], v[26:27], v[32:33], v[28:29] op_sel:[1,0,0]
    v_cvt_pk_bf16_f32 v30, v26, v27
    ds_write_b32 v7, v30 offset:15840
    v_pk_mul_f32 v[26:27], v[28:29], v[24:25] op_sel_hi:[0,1]
    v_pk_fma_f32 v[26:27], v[28:29], v[32:33], v[26:27] op_sel:[1,0,0]
    v_cvt_pk_bf16_f32 v30, v28, v29
    ds_write_b32 v7, v30 offset:16368
    v_pk_mul_f32 v[28:29], v[26:27], v[24:25] op_sel_hi:[0,1]
    v_pk_fma_f32 v[28:29], v[26:27], v[32:33], v[28:29] op_sel:[1,0,0]
    v_cvt_pk_bf16_f32 v30, v26, v27
    ds_write_b32 v7, v30 offset:16896
    v_pk_mul_f32 v[26:27], v[28:29], v[24:25] op_sel_hi:[0,1]
    v_pk_fma_f32 v[26:27], v[28:29], v[32:33], v[26:27] op_sel:[1,0,0]
    v_cvt_pk_bf16_f32 v30, v28, v29
    ds_write_b32 v7, v30 offset:17424
    v_pk_mul_f32 v[28:29], v[26:27], v[24:25] op_sel_hi:[0,1]
    v_pk_fma_f32 v[28:29], v[26:27], v[32:33], v[28:29] op_sel:[1,0,0]
    v_cvt_pk_bf16_f32 v30, v26, v27
    ds_write_b32 v7, v30 offset:17952
    v_pk_mul_f32 v[26:27], v[28:29], v[24:25] op_sel_hi:[0,1]
    v_pk_fma_f32 v[26:27], v[28:29], v[32:33], v[26:27] op_sel:[1,0,0]
    v_cvt_pk_bf16_f32 v30, v28, v29
    ds_write_b32 v7, v30 offset:18480
    v_pk_mul_f32 v[28:29], v[26:27], v[24:25] op_sel_hi:[0,1]
    v_pk_fma_f32 v[28:29], v[26:27], v[32:33], v[28:29] op_sel:[1,0,0]
    v_cvt_pk_bf16_f32 v30, v26, v27
    ds_write_b32 v7, v30 offset:19008
    v_pk_mul_f32 v[26:27], v[28:29], v[24:25] op_sel_hi:[0,1]
    v_pk_fma_f32 v[26:27], v[28:29], v[32:33], v[26:27] op_sel:[1,0,0]
    v_cvt_pk_bf16_f32 v30, v28, v29
    ds_write_b32 v7, v30 offset:19536
    v_pk_mul_f32 v[28:29], v[26:27], v[24:25] op_sel_hi:[0,1]
    v_pk_fma_f32 v[28:29], v[26:27], v[32:33], v[28:29] op_sel:[1,0,0]
    v_cvt_pk_bf16_f32 v30, v26, v27
    ds_write_b32 v7, v30 offset:20064
    v_pk_mul_f32 v[26:27], v[28:29], v[24:25] op_sel_hi:[0,1]
    v_pk_fma_f32 v[26:27], v[28:29], v[32:33], v[26:27] op_sel:[1,0,0]
    v_cvt_pk_bf16_f32 v30, v28, v29
    ds_write_b32 v7, v30 offset:20592
    v_pk_mul_f32 v[28:29], v[26:27], v[24:25] op_sel_hi:[0,1]
    v_pk_fma_f32 v[28:29], v[26:27], v[32:33], v[28:29] op_sel:[1,0,0]
    v_cvt_pk_bf16_f32 v30, v26, v27
    ds_write_b32 v7, v30 offset:21120
    v_pk_mul_f32 v[26:27], v[28:29], v[24:25] op_sel_hi:[0,1]
    v_pk_fma_f32 v[26:27], v[28:29], v[32:33], v[26:27] op_sel:[1,0,0]
    v_cvt_pk_bf16_f32 v30, v28, v29
    ds_write_b32 v7, v30 offset:21648
    v_pk_mul_f32 v[28:29], v[26:27], v[24:25] op_sel_hi:[0,1]
    v_pk_fma_f32 v[28:29], v[26:27], v[32:33], v[28:29] op_sel:[1,0,0]
    v_cvt_pk_bf16_f32 v30, v26, v27
    ds_write_b32 v7, v30 offset:22176
    v_pk_mul_f32 v[26:27], v[28:29], v[24:25] op_sel_hi:[0,1]
    v_pk_fma_f32 v[26:27], v[28:29], v[32:33], v[26:27] op_sel:[1,0,0]
    v_cvt_pk_bf16_f32 v30, v28, v29
    ds_write_b32 v7, v30 offset:22704
    v_pk_mul_f32 v[28:29], v[26:27], v[24:25] op_sel_hi:[0,1]
    v_pk_fma_f32 v[28:29], v[26:27], v[32:33], v[28:29] op_sel:[1,0,0]
    v_cvt_pk_bf16_f32 v30, v26, v27
    ds_write_b32 v7, v30 offset:23232
    v_pk_mul_f32 v[26:27], v[28:29], v[24:25] op_sel_hi:[0,1]
    v_pk_fma_f32 v[26:27], v[28:29], v[32:33], v[26:27] op_sel:[1,0,0]
    v_cvt_pk_bf16_f32 v30, v28, v29
    ds_write_b32 v7, v30 offset:23760
    v_pk_mul_f32 v[28:29], v[26:27], v[24:25] op_sel_hi:[0,1]
    v_pk_fma_f32 v[28:29], v[26:27], v[32:33], v[28:29] op_sel:[1,0,0]
    v_cvt_pk_bf16_f32 v30, v26, v27
    ds_write_b32 v7, v30 offset:24288
    v_pk_mul_f32 v[26:27], v[28:29], v[24:25] op_sel_hi:[0,1]
    v_pk_fma_f32 v[26:27], v[28:29], v[32:33], v[26:27] op_sel:[1,0,0]
    v_cvt_pk_bf16_f32 v30, v28, v29
    ds_write_b32 v7, v30 offset:24816
    v_pk_mul_f32 v[28:29], v[26:27], v[24:25] op_sel_hi:[0,1]
    v_pk_fma_f32 v[28:29], v[26:27], v[32:33], v[28:29] op_sel:[1,0,0]
    v_cvt_pk_bf16_f32 v30, v26, v27
    ds_write_b32 v7, v30 offset:25344
    v_pk_mul_f32 v[26:27], v[28:29], v[24:25] op_sel_hi:[0,1]
    v_pk_fma_f32 v[26:27], v[28:29], v[32:33], v[26:27] op_sel:[1,0,0]
    v_cvt_pk_bf16_f32 v30, v28, v29
    ds_write_b32 v7, v30 offset:25872
    v_pk_mul_f32 v[28:29], v[26:27], v[24:25] op_sel_hi:[0,1]
    v_pk_fma_f32 v[28:29], v[26:27], v[32:33], v[28:29] op_sel:[1,0,0]
    v_cvt_pk_bf16_f32 v30, v26, v27
    ds_write_b32 v7, v30 offset:26400
    v_pk_mul_f32 v[26:27], v[28:29], v[24:25] op_sel_hi:[0,1]
    v_pk_fma_f32 v[26:27], v[28:29], v[32:33], v[26:27] op_sel:[1,0,0]
    v_cvt_pk_bf16_f32 v30, v28, v29
    ds_write_b32 v7, v30 offset:26928
    v_pk_mul_f32 v[28:29], v[26:27], v[24:25] op_sel_hi:[0,1]
    v_pk_fma_f32 v[28:29], v[26:27], v[32:33], v[28:29] op_sel:[1,0,0]
    v_cvt_pk_bf16_f32 v30, v26, v27
    ds_write_b32 v7, v30 offset:27456
    v_pk_mul_f32 v[26:27], v[28:29], v[24:25] op_sel_hi:[0,1]
    v_pk_fma_f32 v[26:27], v[28:29], v[32:33], v[26:27] op_sel:[1,0,0]
    v_cvt_pk_bf16_f32 v30, v28, v29
    ds_write_b32 v7, v30 offset:27984
    v_pk_mul_f32 v[28:29], v[26:27], v[24:25] op_sel_hi:[0,1]
    v_pk_fma_f32 v[28:29], v[26:27], v[32:33], v[28:29] op_sel:[1,0,0]
    v_cvt_pk_bf16_f32 v30, v26, v27
    ds_write_b32 v7, v30 offset:28512
    v_pk_mul_f32 v[26:27], v[28:29], v[24:25] op_sel_hi:[0,1]
    v_pk_fma_f32 v[26:27], v[28:29], v[32:33], v[26:27] op_sel:[1,0,0]
    v_cvt_pk_bf16_f32 v30, v28, v29
    ds_write_b32 v7, v30 offset:29040
    v_pk_mul_f32 v[28:29], v[26:27], v[24:25] op_sel_hi:[0,1]
    v_pk_fma_f32 v[28:29], v[26:27], v[32:33], v[28:29] op_sel:[1,0,0]
    v_cvt_pk_bf16_f32 v30, v26, v27
    ds_write_b32 v7, v30 offset:29568
    v_pk_mul_f32 v[26:27], v[28:29], v[24:25] op_sel_hi:[0,1]
    v_pk_fma_f32 v[26:27], v[28:29], v[32:33], v[26:27] op_sel:[1,0,0]
    v_cvt_pk_bf16_f32 v30, v28, v29
    ds_write_b32 v7, v30 offset:30096
    v_pk_mul_f32 v[28:29], v[26:27], v[24:25] op_sel_hi:[0,1]
    v_pk_fma_f32 v[28:29], v[26:27], v[32:33], v[28:29] op_sel:[1,0,0]
    v_cvt_pk_bf16_f32 v30, v26, v27
    ds_write_b32 v7, v30 offset:30624
    v_pk_mul_f32 v[26:27], v[28:29], v[24:25] op_sel_hi:[0,1]
    v_pk_fma_f32 v[26:27], v[28:29], v[32:33], v[26:27] op_sel:[1,0,0]
    v_cvt_pk_bf16_f32 v30, v28, v29
    ds_write_b32 v7, v30 offset:31152
    v_pk_mul_f32 v[28:29], v[26:27], v[24:25] op_sel_hi:[0,1]
    v_pk_fma_f32 v[28:29], v[26:27], v[32:33], v[28:29] op_sel:[1,0,0]
    v_cvt_pk_bf16_f32 v30, v26, v27
    ds_write_b32 v7, v30 offset:31680
    v_pk_mul_f32 v[26:27], v[28:29], v[24:25] op_sel_hi:[0,1]
    v_pk_fma_f32 v[26:27], v[28:29], v[32:33], v[26:27] op_sel:[1,0,0]
    v_cvt_pk_bf16_f32 v30, v28, v29
    ds_write_b32 v7, v30 offset:32208
    v_pk_mul_f32 v[28:29], v[26:27], v[24:25] op_sel_hi:[0,1]
    v_pk_fma_f32 v[28:29], v[26:27], v[32:33], v[28:29] op_sel:[1,0,0]
    v_cvt_pk_bf16_f32 v30, v26, v27
    ds_write_b32 v7, v30 offset:32736
    v_pk_mul_f32 v[26:27], v[28:29], v[24:25] op_sel_hi:[0,1]
    v_pk_fma_f32 v[26:27], v[28:29], v[32:33], v[26:27] op_sel:[1,0,0]
    v_cvt_pk_bf16_f32 v30, v28, v29
    ds_write_b32 v7, v30 offset:33264
    s_nop 1
    v_add_f32_dpp v26, v26, v26 row_ror:8 row_mask:0xf bank_mask:0xf
    s_nop 1
    v_add_f32_dpp v26, v26, v26 row_ror:4 row_mask:0xf bank_mask:0xf
    s_nop 1
    v_add_f32_dpp v26, v26, v26 row_ror:2 row_mask:0xf bank_mask:0xf
    s_nop 1
    v_add_f32_dpp v26, v26, v26 row_ror:1 row_mask:0xf bank_mask:0xf
    s_nop 1
    v_and_b32 v5, 15, v0
    v_lshrrev_b32 v6, 4, v3
    v_lshlrev_b32 v6, 2, v6
    v_cmp_eq_u32 vcc, 0, v5
    s_and_saveexec_b64 s[44:45], vcc
    ds_write_b32 v6, v26 offset:50688
    s_mov_b64 exec, s[44:45]
front_kernel_C2:
    s_waitcnt lgkmcnt(0)
    s_barrier
    s_cmp_ge_u32 s17, 2
    s_cbranch_scc1 front_kernel_C3a
    v_and_b32 v5, 31, v2
    v_mul_u32_u24 v5, 528, v5
    v_lshrrev_b32 v6, 5, v2
    v_lshlrev_b32 v6, 4, v6
    v_add_u32 v5, v5, v6
    s_mul_i32 s20, s17, 16896
    v_add_u32 v6, s20, v5
    v_mov_b32 v64, 0
    v_mov_b32 v65, 0
    v_mov_b32 v66, 0
    v_mov_b32 v67, 0
    v_mov_b32 v68, 0
    v_mov_b32 v69, 0
    v_mov_b32 v70, 0
    v_mov_b32 v71, 0
    v_mov_b32 v72, 0
    v_mov_b32 v73, 0
    v_mov_b32 v74, 0
    v_mov_b32 v75, 0
    v_mov_b32 v76, 0
    v_mov_b32 v77, 0
    v_mov_b32 v78, 0
    v_mov_b32 v79, 0
    ds_read_b128 v[32:35], v6 offset:0
    ds_read_b128 v[36:39], v5 offset:33792
    ds_read_b128 v[40:43], v6 offset:32
    ds_read_b128 v[44:47], v5 offset:33824
    ds_read_b128 v[48:51], v6 offset:64
    ds_read_b128 v[52:55], v5 offset:33856
    ds_read_b128 v[56:59], v6 offset:96
    ds_read_b128 v[60:63], v5 offset:33888
    s_waitcnt lgkmcnt(6)
    v_mfma_f32_32x32x16_bf16 v[64:79], v[32:35], v[36:39], v[64:79]
    ds_read_b128 v[32:35], v6 offset:128
    ds_read_b128 v[36:39], v5 offset:33920
    s_waitcnt lgkmcnt(6)
    v_mfma_f32_32x32x16_bf16 v[64:79], v[40:43], v[44:47], v[64:79]
    ds_read_b128 v[40:43], v6 offset:160
    ds_read_b128 v[44:47], v5 offset:33952
    s_waitcnt lgkmcnt(6)
    v_mfma_f32_32x32x16_bf16 v[64:79], v[48:51], v[52:55], v[64:79]
    ds_read_b128 v[48:51], v6 offset:192
    ds_read_b128 v[52:55], v5 offset:33984
    s_waitcnt lgkmcnt(6)
    v_mfma_f32_32x32x16_bf16 v[64:79], v[56:59], v[60:63], v[64:79]
    ds_read_b128 v[56:59], v6 offset:224
    ds_read_b128 v[60:63], v5 offset:34016
    s_waitcnt lgkmcnt(6)
    v_mfma_f32_32x32x16_bf16 v[64:79], v[32:35], v[36:39], v[64:79]
    ds_read_b128 v[32:35], v6 offset:256
    ds_read_b128 v[36:39], v5 offset:34048
    s_waitcnt lgkmcnt(6)
    v_mfma_f32_32x32x16_bf16 v[64:79], v[40:43], v[44:47], v[64:79]
    ds_read_b128 v[40:43], v6 offset:288
    ds_read_b128 v[44:47], v5 offset:34080
    s_waitcnt lgkmcnt(6)
    v_mfma_f32_32x32x16_bf16 v[64:79], v[48:51], v[52:55], v[64:79]
    ds_read_b128 v[48:51], v6 offset:320
    ds_read_b128 v[52:55], v5 offset:34112
    s_waitcnt lgkmcnt(6)
    v_mfma_f32_32x32x16_bf16 v[64:79], v[56:59], v[60:63], v[64:79]
    ds_read_b128 v[56:59], v6 offset:352
    ds_read_b128 v[60:63], v5 offset:34144
    s_waitcnt lgkmcnt(6)
    v_mfma_f32_32x32x16_bf16 v[64:79], v[32:35], v[36:39], v[64:79]
    ds_read_b128 v[32:35], v6 offset:384
    ds_read_b128 v[36:39], v5 offset:34176
    s_waitcnt lgkmcnt(6)
    v_mfma_f32_32x32x16_bf16 v[64:79], v[40:43], v[44:47], v[64:79]
    ds_read_b128 v[40:43], v6 offset:416
    ds_read_b128 v[44:47], v5 offset:34208
    s_waitcnt lgkmcnt(6)
    v_mfma_f32_32x32x16_bf16 v[64:79], v[48:51], v[52:55], v[64:79]
    ds_read_b128 v[48:51], v6 offset:448
    ds_read_b128 v[52:55], v5 offset:34240
    s_waitcnt lgkmcnt(6)
    v_mfma_f32_32x32x16_bf16 v[64:79], v[56:59], v[60:63], v[64:79]
    ds_read_b128 v[56:59], v6 offset:480
    ds_read_b128 v[60:63], v5 offset:34272
    s_waitcnt lgkmcnt(6)
    v_mfma_f32_32x32x16_bf16 v[64:79], v[32:35], v[36:39], v[64:79]
    s_waitcnt lgkmcnt(4)
    v_mfma_f32_32x32x16_bf16 v[64:79], v[40:43], v[44:47], v[64:79]
    s_waitcnt lgkmcnt(2)
    v_mfma_f32_32x32x16_bf16 v[64:79], v[48:51], v[52:55], v[64:79]
    s_waitcnt lgkmcnt(0)
    v_mfma_f32_32x32x16_bf16 v[64:79], v[56:59], v[60:63], v[64:79]
    s_branch front_kernel_C3
front_kernel_C3a:
    v_mov_b32 v5, 0
    ds_read_b128 v[8:11], v5 offset:50688
    ds_read_b128 v[12:15], v5 offset:50704
    s_waitcnt lgkmcnt(0)
    v_add_f32 v8, v8, v9
    v_add_f32 v10, v10, v11
    v_add_f32 v12, v12, v13
    v_add_f32 v14, v14, v15
    v_add_f32 v8, v8, v10
    v_add_f32 v12, v12, v14
    v_add_f32 v8, v8, v12
front_kernel_C3:
    s_barrier
    s_cmp_ge_u32 s17, 2
    s_cbranch_scc1 front_kernel_C4
    v_and_b32 v5, 31, v2
    v_lshrrev_b32 v6, 5, v2
    v_lshlrev_b32 v6, 9, v6
    v_lshlrev_b32 v5, 2, v5
    v_add_u32 v5, v5, v6
    s_lshl_b32 s20, s17, 12
    v_add_u32 v5, s20, v5
    v_add_u32 v5, 44544, v5
    s_nop 7
    ds_write_b32 v5, v64 offset:0
    ds_write_b32 v5, v65 offset:128
    ds_write_b32 v5, v66 offset:256
    ds_write_b32 v5, v67 offset:384
    ds_write_b32 v5, v68 offset:1024
    ds_write_b32 v5, v69 offset:1152
    ds_write_b32 v5, v70 offset:1280
    ds_write_b32 v5, v71 offset:1408
    ds_write_b32 v5, v72 offset:2048
    ds_write_b32 v5, v73 offset:2176
    ds_write_b32 v5, v74 offset:2304
    ds_write_b32 v5, v75 offset:2432
    ds_write_b32 v5, v76 offset:3072
    ds_write_b32 v5, v77 offset:3200
    ds_write_b32 v5, v78 offset:3328
    ds_write_b32 v5, v79 offset:3456
    s_branch front_kernel_C5
front_kernel_C4:
    v_mov_b32 v5, 52736
    ds_write_b32 v5, v8
front_kernel_C5:
    s_waitcnt lgkmcnt(0)
    s_barrier
    ds_read_b32 v8, v100 offset:44544
    ds_read_b32 v9, v101 offset:44544
    ds_read_b32 v10, v102 offset:44544
    ds_read_b32 v11, v103 offset:44544
    ds_read_b32 v12, v104 offset:44544
    ds_read_b32 v13, v105 offset:44544
    ds_read_b32 v14, v106 offset:44544
    ds_read_b32 v15, v107 offset:44544
    ds_read_b32 v16, v108 offset:44544
    ds_read_b32 v17, v109 offset:44544
    ds_read_b32 v18, v110 offset:44544
    ds_read_b32 v19, v111 offset:44544
    ds_read_b32 v20, v112 offset:44544
    ds_read_b32 v21, v113 offset:44544
    ds_read_b32 v22, v114 offset:44544
    v_lshlrev_b32 v5, 4, v0
    v_cmp_eq_u32 vcc, 0xff, v0
    s_nop 0
    s_waitcnt lgkmcnt(0)
    v_cndmask_b32 v17, v17, 0, vcc
    v_cndmask_b32 v18, v18, 0, vcc
    v_cndmask_b32 v19, v19, 0, vcc
    v_cndmask_b32 v20, v20, 0, vcc
    v_cndmask_b32 v21, v21, 0, vcc
    v_cndmask_b32 v22, v22, 0, vcc
    v_cvt_pk_bf16_f32 v32, v8, v9
    v_cvt_pk_bf16_f32 v33, v10, v11
    v_cvt_pk_bf16_f32 v34, v12, v13
    v_cvt_pk_bf16_f32 v35, v14, v15
    ds_write_b128 v5, v[32:35] offset:0
    v_cvt_pk_bf16_f32 v36, v9, v10
    v_cvt_pk_bf16_f32 v37, v11, v12
    v_cvt_pk_bf16_f32 v38, v13, v14
    v_cvt_pk_bf16_f32 v39, v15, v16
    ds_write_b128 v5, v[36:39] offset:4816
    v_lshlrev_b32 v56, 16, v36
    v_and_b32 v57, 0xffff0000, v36
    v_lshlrev_b32 v58, 16, v37
    v_and_b32 v59, 0xffff0000, v37
    v_lshlrev_b32 v60, 16, v38
    v_and_b32 v61, 0xffff0000, v38
    v_lshlrev_b32 v62, 16, v39
    v_and_b32 v63, 0xffff0000, v39
    v_mov_b32 v132, v63
    v_add_f32 v133, v132, v62
    v_add_f32 v134, v133, v61
    v_add_f32 v135, v134, v60
    v_add_f32 v136, v135, v59
    v_add_f32 v137, v136, v58
    v_add_f32 v138, v137, v57
    v_add_f32 v139, v138, v56
    v_cvt_pk_bf16_f32 v40, v10, v11
    v_cvt_pk_bf16_f32 v41, v12, v13
    v_cvt_pk_bf16_f32 v42, v14, v15
    v_cvt_pk_bf16_f32 v43, v16, v17
    ds_write_b128 v5, v[40:43] offset:9360
    v_cvt_pk_bf16_f32 v44, v11, v12
    v_cvt_pk_bf16_f32 v45, v13, v14
    v_cvt_pk_bf16_f32 v46, v15, v16
    v_cvt_pk_bf16_f32 v47, v17, v18
    ds_write_b128 v5, v[44:47] offset:13904
    v_cvt_pk_bf16_f32 v32, v12, v13
    v_cvt_pk_bf16_f32 v33, v14, v15
    v_cvt_pk_bf16_f32 v34, v16, v17
    v_cvt_pk_bf16_f32 v35, v18, v19
    ds_write_b128 v5, v[32:35] offset:18448
    v_cvt_pk_bf16_f32 v36, v13, v14
    v_cvt_pk_bf16_f32 v37, v15, v16
    v_cvt_pk_bf16_f32 v38, v17, v18
    v_cvt_pk_bf16_f32 v39, v19, v20
    ds_write_b128 v5, v[36:39] offset:23248
    v_cvt_pk_bf16_f32 v40, v14, v15
    v_cvt_pk_bf16_f32 v41, v16, v17
    v_cvt_pk_bf16_f32 v42, v18, v19
    v_cvt_pk_bf16_f32 v43, v20, v21
    ds_write_b128 v5, v[40:43] offset:27792
    v_cvt_pk_bf16_f32 v44, v15, v16
    v_cvt_pk_bf16_f32 v45, v17, v18
    v_cvt_pk_bf16_f32 v46, v19, v20
    v_cvt_pk_bf16_f32 v47, v21, v22
    ds_write_b128 v5, v[44:47] offset:32336
    s_cmp_eq_u32 s17, 0
    s_cbranch_scc0 front_kernel_nb0
    v_mov_b32 v148, 0
    global_load_dwordx2 v[148:149], v148, s[58:59] offset:128 sc1
front_kernel_nb0:
    v_mov_b32 v48, 0
    v_mov_b32 v49, 0
    v_mov_b32 v50, 0
    v_mov_b32 v51, 0
    v_mov_b32 v6, 44544
    ds_read_b32 v52, v6
    v_lshrrev_b32 v7, 2, v0
    v_and_b32 v8, 3, v0
    v_sub_u32 v9, 8, v7
    v_and_b32 v9, 7, v9
    v_and_b32 v10, 3, v9
    v_lshlrev_b32 v10, 6, v10
    v_cmp_lt_u32 vcc, 0, v9
    v_mul_u32_u24 v11, 4608, v7
    v_add_u32 v10, v10, v11
    v_cndmask_b32 v11, 0, 16, vcc
    v_lshlrev_b32 v8, 4, v8
    v_add3_u32 v10, v10, v11, v8
    v_add_u32 v10, 4096, v10
    v_cmp_eq_u32 vcc, 0, v0
    s_waitcnt lgkmcnt(0)
    v_cvt_pk_bf16_f32 v52, v52, v48
    v_cndmask_b32 v48, 0, v52, vcc
    v_cmp_gt_u32 vcc, 32, v0
    s_and_saveexec_b64 s[44:45], vcc
    ds_write_b128 v10, v[48:51]
    s_mov_b64 exec, s[44:45]
    v_mov_b32 v48, 0
    v_cmp_gt_u32 vcc, 160, v0
    s_and_saveexec_b64 s[44:45], vcc
    ds_write_b128 v5, v[48:51] offset:36864
    s_mov_b64 exec, s[44:45]
    s_waitcnt lgkmcnt(0)
    s_barrier
    v_sub_u32 v7, 255, v0
    v_lshlrev_b32 v7, 5, v7
    v_add_u32 v7, 44544, v7
    ds_write_b128 v7, v[132:135]
    ds_write_b128 v7, v[136:139] offset:16
    s_waitcnt lgkmcnt(0)
    s_cmp_eq_u32 s17, 0
    s_cbranch_scc0 front_kernel_poll_ok
    s_waitcnt vmcnt(0)
    v_and_b32 v8, v148, v149
    s_nop 0
    v_readfirstlane_b32 s47, v8
    s_nop 3
    s_cmp_lg_u32 s47, 0
    s_cbranch_scc1 front_kernel_poll_ok
    s_cmp_eq_u32 s17, 0
    s_cbranch_scc0 front_kernel_poll_ok
    v_mov_b32 v9, 0
    s_mov_b32 s46, 0
front_kernel_poll:
    global_load_dwordx2 v[10:11], v9, s[58:59] offset:128 sc1
    s_waitcnt vmcnt(0)
    v_and_b32 v8, v10, v11
    s_nop 0
    v_readfirstlane_b32 s47, v8
    s_nop 3
    s_cmp_lg_u32 s47, 0
    s_cbranch_scc1 front_kernel_poll_ok
    s_add_u32 s46, s46, 1
    s_cmp_lt_u32 s46, 0x20000
    s_cbranch_scc0 front_kernel_poll_ok
    s_sleep 2
    s_branch front_kernel_poll
front_kernel_poll_ok:
    s_barrier
    v_mov_b32 v46, v2
    s_lshr_b32 s20, s3, 4
    s_lshl_b32 s20, s20, 16
    s_and_b32 s21, s3, 15
    s_lshl_b32 s21, s21, 4
    s_add_u32 s20, s20, s21
    s_add_u32 s20, s20, 1048576
    s_add_u32 s26, s6, s20
    s_addc_u32 s27, s7, 0
    s_mov_b32 s32, s26
    s_and_b32 s33, s27, 0xffff
    s_mov_b32 s34, 65536
    s_mov_b32 s35, 0x20000
    s_add_u32 s26, s6, 65536
    s_addc_u32 s27, s7, 0
    s_mov_b32 s36, s26
    s_and_b32 s37, s27, 0xffff
    s_mov_b32 s38, 16384
    s_mov_b32 s39, 0x20000
    s_add_u32 s26, s6, 0
    s_addc_u32 s27, s7, 0
    s_mov_b32 s48, s26
    s_and_b32 s49, s27, 0xffff
    s_mov_b32 s50, 13824
    s_mov_b32 s51, 0x20000
    v_lshlrev_b32 v4, 8, v0
    buffer_load_dwordx4 v[8:11], v4, s[32:35], 0 offen sc1
    v_lshlrev_b32 v6, 6, v0
    buffer_load_dwordx4 v[12:15], v6, s[36:39], 0 offen offset:0 sc1
    buffer_load_dwordx4 v[16:19], v6, s[36:39], 0 offen offset:16 sc1
    buffer_load_dwordx4 v[20:23], v6, s[36:39], 0 offen offset:32 sc1
    buffer_load_dwordx4 v[24:27], v6, s[36:39], 0 offen offset:48 sc1
    s_cmp_eq_u32 s17, 0
    s_cbranch_scc0 front_kernel_na2
    v_mov_b32 v147, 0
    global_load_dword v147, v147, s[58:59] offset:136 sc1
front_kernel_na2:
    v_lshlrev_b32 v4, 5, v0
    v_add_u32 v4, 44544, v4
    ds_read_b128 v[132:135], v4
    ds_read_b128 v[136:139], v4 offset:16
    v_lshrrev_b32 v7, 2, v0
    v_mul_u32_u24 v7, 80, v7
    v_and_b32 v48, 3, v0
    v_lshlrev_b32 v48, 4, v48
    v_add_u32 v7, v7, v48
    s_waitcnt lgkmcnt(0)
    v_mov_b32 v49, v139
    s_nop 1
    v_add_f32_dpp v49, v49, v49 row_shr:1 row_mask:0xf bank_mask:0xf bound_ctrl:0
    s_nop 1
    v_add_f32_dpp v49, v49, v49 row_shr:2 row_mask:0xf bank_mask:0xf bound_ctrl:0
    s_nop 1
    v_add_f32_dpp v49, v49, v49 row_shr:4 row_mask:0xf bank_mask:0xf bound_ctrl:0
    s_nop 1
    v_add_f32_dpp v49, v49, v49 row_shr:8 row_mask:0xf bank_mask:0xf bound_ctrl:0
    s_nop 1
    v_add_f32_dpp v49, v49, v49 row_bcast:15 row_mask:0xa bank_mask:0xf
    s_nop 1
    v_add_f32_dpp v49, v49, v49 row_bcast:31 row_mask:0xc bank_mask:0xf
    s_nop 1
    v_readlane_b32 s20, v49, 63
    v_sub_f32 v49, v49, v139
    s_lshl_b32 s21, s17, 2
    s_add_u32 s21, s21, 36928
    v_mov_b32 v50, s20
    v_mov_b32 v51, s21
    v_add_f32 v132, v132, v49
    v_add_f32 v133, v133, v49
    v_add_f32 v134, v134, v49
    v_add_f32 v135, v135, v49
    v_add_f32 v136, v136, v49
    v_add_f32 v137, v137, v49
    v_add_f32 v138, v138, v49
    v_add_f32 v139, v139, v49
    ds_write_b32 v51, v50
    v_and_b32 v48, 7, v46
    v_sub_u32 v49, 8, v48
    v_and_b32 v49, 7, v49
    v_mul_u32_u24 v50, 4608, v49
    v_and_b32 v51, 3, v48
    v_lshlrev_b32 v51, 6, v51
    v_add_u32 v50, v50, v51
    v_bfe_u32 v51, v46, 3, 2
    v_lshrrev_b32 v53, 5, v46
    v_sub_u32 v51, v53, v51
    v_lshlrev_b32 v51, 4, v51
    v_add_u32 v144, v50, v51
    v_add_u32 v144, 4096, v144
    v_and_b32 v48, 31, v46
    v_mul_u32_u24 v145, 80, v48
    v_lshlrev_b32 v53, 4, v53
    v_add_u32 v145, v145, v53
    v_add_u32 v145, 39424, v145
    v_mov_b32 v64, 0
    v_mov_b32 v65, 0
    v_mov_b32 v66, 0
    v_mov_b32 v67, 0
    v_mov_b32 v68, 0
    v_mov_b32 v69, 0
    v_mov_b32 v70, 0
    v_mov_b32 v71, 0
    v_mov_b32 v72, 0
    v_mov_b32 v73, 0
    v_mov_b32 v74, 0
    v_mov_b32 v75, 0
    v_mov_b32 v76, 0
    v_mov_b32 v77, 0
    v_mov_b32 v78, 0
    v_mov_b32 v79, 0
    v_mov_b32 v80, 0
    v_mov_b32 v81, 0
    v_mov_b32 v82, 0
    v_mov_b32 v83, 0
    v_mov_b32 v84, 0
    v_mov_b32 v85, 0
    v_mov_b32 v86, 0
    v_mov_b32 v87, 0
    v_mov_b32 v88, 0
    v_mov_b32 v89, 0
    v_mov_b32 v90, 0
    v_mov_b32 v91, 0
    v_mov_b32 v92, 0
    v_mov_b32 v93, 0
    v_mov_b32 v94, 0
    v_mov_b32 v95, 0
    s_waitcnt vmcnt(0)
    v_lshlrev_b32 v32, 16, v8
    v_and_b32 v33, 0xffff0000, v8
    v_lshlrev_b32 v34, 16, v9
    v_and_b32 v35, 0xffff0000, v9
    v_lshlrev_b32 v36, 16, v10
    v_and_b32 v37, 0xffff0000, v10
    v_lshlrev_b32 v38, 16, v11
    v_and_b32 v39, 0xffff0000, v11
    v_sub_f32 v56, v32, v12
    v_sub_f32 v57, v33, v14
    v_sub_f32 v58, v34, v16
    v_sub_f32 v59, v35, v18
    v_sub_f32 v60, v36, v20
    v_sub_f32 v61, v37, v22
    v_sub_f32 v62, v38, v24
    v_sub_f32 v63, v39, v26
    v_mul_f32 v56, v56, v13
    v_mul_f32 v57, v57, v15
    v_mul_f32 v58, v58, v17
    v_mul_f32 v59, v59, v19
    v_mul_f32 v60, v60, v21
    v_mul_f32 v61, v61, v23
    v_mul_f32 v62, v62, v25
    v_mul_f32 v63, v63, v27
    v_cvt_pk_bf16_f32 v28, v56, v57
    v_cvt_pk_bf16_f32 v29, v58, v59
    v_cvt_pk_bf16_f32 v30, v60, v61
    v_cvt_pk_bf16_f32 v31, v62, v63
    ds_write_b128 v7, v[28:31] offset:39424
    s_cmp_eq_u32 s17, 0
    s_cbranch_scc0 front_kernel_na0
    v_mov_b32 v4, 37008
    ds_write_b32 v4, v147
front_kernel_na0:
    s_waitcnt lgkmcnt(0)
    s_barrier
    v_mov_b32 v4, 37008
    ds_read_b32 v147, v4
    s_waitcnt lgkmcnt(0)
    v_readfirstlane_b32 s63, v147
    s_nop 3
    s_cmp_lg_u32 s63, 0
    s_cbranch_scc0 front_kernel_na1
    s_lshl_b32 s20, s3, 2
    v_mov_b32 v4, s20
    buffer_load_dword v40, v4, s[48:51], 0 offen sc1
    buffer_load_dword v41, v4, s[48:51], 0 offen offset:2304 sc1
    v_add_u32 v4, 4608, v4
    buffer_load_dword v42, v4, s[48:51], 0 offen sc1
front_kernel_na1:
front_kernel_w0:
    s_cmp_eq_u32 s17, 0
    s_cbranch_scc0 front_kernel_w1
    v_subrev_u32 v62, 704, v144
    v_subrev_u32 v63, 880, v145
    ds_read_b128 v[96:99], v62 offset:736
    ds_read_b128 v[100:103], v63 offset:912
    ds_read_b128 v[104:107], v63 offset:3472
    ds_read_b128 v[108:111], v62 offset:704
    ds_read_b128 v[112:115], v63 offset:880
    ds_read_b128 v[116:119], v63 offset:3440
    ds_read_b128 v[120:123], v62 offset:672
    ds_read_b128 v[124:127], v63 offset:832
    ds_read_b128 v[128:131], v63 offset:3392
    s_waitcnt lgkmcnt(7)
    v_mfma_f32_32x32x16_bf16 v[64:79], v[96:99], v[100:103], v[64:79]
    s_waitcnt lgkmcnt(6)
    v_mfma_f32_32x32x16_bf16 v[80:95], v[96:99], v[104:107], v[80:95]
    ds_read_b128 v[96:99], v62 offset:640
    ds_read_b128 v[100:103], v63 offset:800
    ds_read_b128 v[104:107], v63 offset:3360
    s_waitcnt lgkmcnt(7)
    v_mfma_f32_32x32x16_bf16 v[64:79], v[108:111], v[112:115], v[64:79]
    s_waitcnt lgkmcnt(6)
    v_mfma_f32_32x32x16_bf16 v[80:95], v[108:111], v[116:119], v[80:95]
    ds_read_b128 v[108:111], v62 offset:608
    ds_read_b128 v[112:115], v63 offset:752
    ds_read_b128 v[116:119], v63 offset:3312
    s_waitcnt lgkmcnt(7)
    v_mfma_f32_32x32x16_bf16 v[64:79], v[120:123], v[124:127], v[64:79]
    s_waitcnt lgkmcnt(6)
    v_mfma_f32_32x32x16_bf16 v[80:95], v[120:123], v[128:131], v[80:95]
    ds_read_b128 v[120:123], v62 offset:576
    ds_read_b128 v[124:127], v63 offset:720
    ds_read_b128 v[128:131], v63 offset:3280
    s_waitcnt lgkmcnt(7)
    v_mfma_f32_32x32x16_bf16 v[64:79], v[96:99], v[100:103], v[64:79]
    s_waitcnt lgkmcnt(6)
    v_mfma_f32_32x32x16_bf16 v[80:95], v[96:99], v[104:107], v[80:95]
    ds_read_b128 v[96:99], v62 offset:544
    ds_read_b128 v[100:103], v63 offset:672
    ds_read_b128 v[104:107], v63 offset:3232
    s_waitcnt lgkmcnt(7)
    v_mfma_f32_32x32x16_bf16 v[64:79], v[108:111], v[112:115], v[64:79]
    s_waitcnt lgkmcnt(6)
    v_mfma_f32_32x32x16_bf16 v[80:95], v[108:111], v[116:119], v[80:95]
    ds_read_b128 v[108:111], v62 offset:512
    ds_read_b128 v[112:115], v63 offset:640
    ds_read_b128 v[116:119], v63 offset:3200
    s_waitcnt lgkmcnt(7)
    v_mfma_f32_32x32x16_bf16 v[64:79], v[120:123], v[124:127], v[64:79]
    s_waitcnt lgkmcnt(6)
    v_mfma_f32_32x32x16_bf16 v[80:95], v[120:123], v[128:131], v[80:95]
    ds_read_b128 v[120:123], v62 offset:480
    ds_read_b128 v[124:127], v63 offset:592
    ds_read_b128 v[128:131], v63 offset:3152
    s_waitcnt lgkmcnt(7)
    v_mfma_f32_32x32x16_bf16 v[64:79], v[96:99], v[100:103], v[64:79]
    s_waitcnt lgkmcnt(6)
    v_mfma_f32_32x32x16_bf16 v[80:95], v[96:99], v[104:107], v[80:95]
    ds_read_b128 v[96:99], v62 offset:448
    ds_read_b128 v[100:103], v63 offset:560
    ds_read_b128 v[104:107], v63 offset:3120
    s_waitcnt lgkmcnt(7)
    v_mfma_f32_32x32x16_bf16 v[64:79], v[108:111], v[112:115], v[64:79]
    s_waitcnt lgkmcnt(6)
    v_mfma_f32_32x32x16_bf16 v[80:95], v[108:111], v[116:119], v[80:95]
    ds_read_b128 v[108:111], v62 offset:416
    ds_read_b128 v[112:115], v63 offset:512
    ds_read_b128 v[116:119], v63 offset:3072
    s_waitcnt lgkmcnt(7)
    v_mfma_f32_32x32x16_bf16 v[64:79], v[120:123], v[124:127], v[64:79]
    s_waitcnt lgkmcnt(6)
    v_mfma_f32_32x32x16_bf16 v[80:95], v[120:123], v[128:131], v[80:95]
    ds_read_b128 v[120:123], v62 offset:384
    ds_read_b128 v[124:127], v63 offset:480
    ds_read_b128 v[128:131], v63 offset:3040
    s_waitcnt lgkmcnt(7)
    v_mfma_f32_32x32x16_bf16 v[64:79], v[96:99], v[100:103], v[64:79]
    s_waitcnt lgkmcnt(6)
    v_mfma_f32_32x32x16_bf16 v[80:95], v[96:99], v[104:107], v[80:95]
    ds_read_b128 v[96:99], v62 offset:352
    ds_read_b128 v[100:103], v63 offset:432
    ds_read_b128 v[104:107], v63 offset:2992
    s_waitcnt lgkmcnt(7)
    v_mfma_f32_32x32x16_bf16 v[64:79], v[108:111], v[112:115], v[64:79]
    s_waitcnt lgkmcnt(6)
    v_mfma_f32_32x32x16_bf16 v[80:95], v[108:111], v[116:119], v[80:95]
    ds_read_b128 v[108:111], v62 offset:320
    ds_read_b128 v[112:115], v63 offset:400
    ds_read_b128 v[116:119], v63 offset:2960
    s_waitcnt lgkmcnt(7)
    v_mfma_f32_32x32x16_bf16 v[64:79], v[120:123], v[124:127], v[64:79]
    s_waitcnt lgkmcnt(6)
    v_mfma_f32_32x32x16_bf16 v[80:95], v[120:123], v[128:131], v[80:95]
    ds_read_b128 v[120:123], v62 offset:288
    ds_read_b128 v[124:127], v63 offset:352
    ds_read_b128 v[128:131], v63 offset:2912
    s_waitcnt lgkmcnt(7)
    v_mfma_f32_32x32x16_bf16 v[64:79], v[96:99], v[100:103], v[64:79]
    s_waitcnt lgkmcnt(6)
    v_mfma_f32_32x32x16_bf16 v[80:95], v[96:99], v[104:107], v[80:95]
    ds_read_b128 v[96:99], v62 offset:256
    ds_read_b128 v[100:103], v63 offset:320
    ds_read_b128 v[104:107], v63 offset:2880
    s_waitcnt lgkmcnt(7)
    v_mfma_f32_32x32x16_bf16 v[64:79], v[108:111], v[112:115], v[64:79]
    s_waitcnt lgkmcnt(6)
    v_mfma_f32_32x32x16_bf16 v[80:95], v[108:111], v[116:119], v[80:95]
    ds_read_b128 v[108:111], v62 offset:224
    ds_read_b128 v[112:115], v63 offset:272
    ds_read_b128 v[116:119], v63 offset:2832
    s_waitcnt lgkmcnt(7)
    v_mfma_f32_32x32x16_bf16 v[64:79], v[120:123], v[124:127], v[64:79]
    s_waitcnt lgkmcnt(6)
    v_mfma_f32_32x32x16_bf16 v[80:95], v[120:123], v[128:131], v[80:95]
    ds_read_b128 v[120:123], v62 offset:192
    ds_read_b128 v[124:127], v63 offset:240
    ds_read_b128 v[128:131], v63 offset:2800
    s_waitcnt lgkmcnt(7)
    v_mfma_f32_32x32x16_bf16 v[64:79], v[96:99], v[100:103], v[64:79]
    s_waitcnt lgkmcnt(6)
    v_mfma_f32_32x32x16_bf16 v[80:95], v[96:99], v[104:107], v[80:95]
    ds_read_b128 v[96:99], v62 offset:160
    ds_read_b128 v[100:103], v63 offset:192
    ds_read_b128 v[104:107], v63 offset:2752
    s_waitcnt lgkmcnt(7)
    v_mfma_f32_32x32x16_bf16 v[64:79], v[108:111], v[112:115], v[64:79]
    s_waitcnt lgkmcnt(6)
    v_mfma_f32_32x32x16_bf16 v[80:95], v[108:111], v[116:119], v[80:95]
    ds_read_b128 v[108:111], v62 offset:128
    ds_read_b128 v[112:115], v63 offset:160
    ds_read_b128 v[116:119], v63 offset:2720
    s_waitcnt lgkmcnt(7)
    v_mfma_f32_32x32x16_bf16 v[64:79], v[120:123], v[124:127], v[64:79]
    s_waitcnt lgkmcnt(6)
    v_mfma_f32_32x32x16_bf16 v[80:95], v[120:123], v[128:131], v[80:95]
    ds_read_b128 v[120:123], v62 offset:96
    ds_read_b128 v[124:127], v63 offset:112
    ds_read_b128 v[128:131], v63 offset:2672
    s_waitcnt lgkmcnt(7)
    v_mfma_f32_32x32x16_bf16 v[64:79], v[96:99], v[100:103], v[64:79]
    s_waitcnt lgkmcnt(6)
    v_mfma_f32_32x32x16_bf16 v[80:95], v[96:99], v[104:107], v[80:95]
    ds_read_b128 v[96:99], v62 offset:64
    ds_read_b128 v[100:103], v63 offset:80
    ds_read_b128 v[104:107], v63 offset:2640
    s_waitcnt lgkmcnt(7)
    v_mfma_f32_32x32x16_bf16 v[64:79], v[108:111], v[112:115], v[64:79]
    s_waitcnt lgkmcnt(6)
    v_mfma_f32_32x32x16_bf16 v[80:95], v[108:111], v[116:119], v[80:95]
    ds_read_b128 v[108:111], v62 offset:32
    ds_read_b128 v[112:115], v63 offset:32
    ds_read_b128 v[116:119], v63 offset:2592
    s_waitcnt lgkmcnt(7)
    v_mfma_f32_32x32x16_bf16 v[64:79], v[120:123], v[124:127], v[64:79]
    s_waitcnt lgkmcnt(6)
    v_mfma_f32_32x32x16_bf16 v[80:95], v[120:123], v[128:131], v[80:95]
    ds_read_b128 v[120:123], v62 offset:0
    ds_read_b128 v[124:127], v63 offset:0
    ds_read_b128 v[128:131], v63 offset:2560
    s_waitcnt lgkmcnt(7)
    v_mfma_f32_32x32x16_bf16 v[64:79], v[96:99], v[100:103], v[64:79]
    s_waitcnt lgkmcnt(6)
    v_mfma_f32_32x32x16_bf16 v[80:95], v[96:99], v[104:107], v[80:95]
    s_waitcnt lgkmcnt(4)
    v_mfma_f32_32x32x16_bf16 v[64:79], v[108:111], v[112:115], v[64:79]
    s_waitcnt lgkmcnt(3)
    v_mfma_f32_32x32x16_bf16 v[80:95], v[108:111], v[116:119], v[80:95]
    s_waitcnt lgkmcnt(1)
    v_mfma_f32_32x32x16_bf16 v[64:79], v[120:123], v[124:127], v[64:79]
    s_waitcnt lgkmcnt(0)
    v_mfma_f32_32x32x16_bf16 v[80:95], v[120:123], v[128:131], v[80:95]
    s_branch front_kernel_conv_done
front_kernel_w1:
    s_cmp_eq_u32 s17, 1
    s_cbranch_scc0 front_kernel_w2
    v_subrev_u32 v62, 1472, v144
    v_subrev_u32 v63, 1840, v145
    ds_read_b128 v[96:99], v62 offset:736
    ds_read_b128 v[100:103], v63 offset:912
    ds_read_b128 v[104:107], v63 offset:3472
    ds_read_b128 v[108:111], v62 offset:704
    ds_read_b128 v[112:115], v63 offset:880
    ds_read_b128 v[116:119], v63 offset:3440
    ds_read_b128 v[120:123], v62 offset:672
    ds_read_b128 v[124:127], v63 offset:832
    ds_read_b128 v[128:131], v63 offset:3392
    s_waitcnt lgkmcnt(7)
    v_mfma_f32_32x32x16_bf16 v[64:79], v[96:99], v[100:103], v[64:79]
    s_waitcnt lgkmcnt(6)
    v_mfma_f32_32x32x16_bf16 v[80:95], v[96:99], v[104:107], v[80:95]
    ds_read_b128 v[96:99], v62 offset:640
    ds_read_b128 v[100:103], v63 offset:800
    ds_read_b128 v[104:107], v63 offset:3360
    s_waitcnt lgkmcnt(7)
    v_mfma_f32_32x32x16_bf16 v[64:79], v[108:111], v[112:115], v[64:79]
    s_waitcnt lgkmcnt(6)
    v_mfma_f32_32x32x16_bf16 v[80:95], v[108:111], v[116:119], v[80:95]
    ds_read_b128 v[108:111], v62 offset:608
    ds_read_b128 v[112:115], v63 offset:752
    ds_read_b128 v[116:119], v63 offset:3312
    s_waitcnt lgkmcnt(7)
    v_mfma_f32_32x32x16_bf16 v[64:79], v[120:123], v[124:127], v[64:79]
    s_waitcnt lgkmcnt(6)
    v_mfma_f32_32x32x16_bf16 v[80:95], v[120:123], v[128:131], v[80:95]
    ds_read_b128 v[120:123], v62 offset:576
    ds_read_b128 v[124:127], v63 offset:720
    ds_read_b128 v[128:131], v63 offset:3280
    s_waitcnt lgkmcnt(7)
    v_mfma_f32_32x32x16_bf16 v[64:79], v[96:99], v[100:103], v[64:79]
    s_waitcnt lgkmcnt(6)
    v_mfma_f32_32x32x16_bf16 v[80:95], v[96:99], v[104:107], v[80:95]
    ds_read_b128 v[96:99], v62 offset:544
    ds_read_b128 v[100:103], v63 offset:672
    ds_read_b128 v[104:107], v63 offset:3232
    s_waitcnt lgkmcnt(7)
    v_mfma_f32_32x32x16_bf16 v[64:79], v[108:111], v[112:115], v[64:79]
    s_waitcnt lgkmcnt(6)
    v_mfma_f32_32x32x16_bf16 v[80:95], v[108:111], v[116:119], v[80:95]
    ds_read_b128 v[108:111], v62 offset:512
    ds_read_b128 v[112:115], v63 offset:640
    ds_read_b128 v[116:119], v63 offset:3200
    s_waitcnt lgkmcnt(7)
    v_mfma_f32_32x32x16_bf16 v[64:79], v[120:123], v[124:127], v[64:79]
    s_waitcnt lgkmcnt(6)
    v_mfma_f32_32x32x16_bf16 v[80:95], v[120:123], v[128:131], v[80:95]
    ds_read_b128 v[120:123], v62 offset:480
    ds_read_b128 v[124:127], v63 offset:592
    ds_read_b128 v[128:131], v63 offset:3152
    s_waitcnt lgkmcnt(7)
    v_mfma_f32_32x32x16_bf16 v[64:79], v[96:99], v[100:103], v[64:79]
    s_waitcnt lgkmcnt(6)
    v_mfma_f32_32x32x16_bf16 v[80:95], v[96:99], v[104:107], v[80:95]
    ds_read_b128 v[96:99], v62 offset:448
    ds_read_b128 v[100:103], v63 offset:560
    ds_read_b128 v[104:107], v63 offset:3120
    s_waitcnt lgkmcnt(7)
    v_mfma_f32_32x32x16_bf16 v[64:79], v[108:111], v[112:115], v[64:79]
    s_waitcnt lgkmcnt(6)
    v_mfma_f32_32x32x16_bf16 v[80:95], v[108:111], v[116:119], v[80:95]
    ds_read_b128 v[108:111], v62 offset:416
    ds_read_b128 v[112:115], v63 offset:512
    ds_read_b128 v[116:119], v63 offset:3072
    s_waitcnt lgkmcnt(7)
    v_mfma_f32_32x32x16_bf16 v[64:79], v[120:123], v[124:127], v[64:79]
    s_waitcnt lgkmcnt(6)
    v_mfma_f32_32x32x16_bf16 v[80:95], v[120:123], v[128:131], v[80:95]
    ds_read_b128 v[120:123], v62 offset:384
    ds_read_b128 v[124:127], v63 offset:480
    ds_read_b128 v[128:131], v63 offset:3040
    s_waitcnt lgkmcnt(7)
    v_mfma_f32_32x32x16_bf16 v[64:79], v[96:99], v[100:103], v[64:79]
    s_waitcnt lgkmcnt(6)
    v_mfma_f32_32x32x16_bf16 v[80:95], v[96:99], v[104:107], v[80:95]
    ds_read_b128 v[96:99], v62 offset:352
    ds_read_b128 v[100:103], v63 offset:432
    ds_read_b128 v[104:107], v63 offset:2992
    s_waitcnt lgkmcnt(7)
    v_mfma_f32_32x32x16_bf16 v[64:79], v[108:111], v[112:115], v[64:79]
    s_waitcnt lgkmcnt(6)
    v_mfma_f32_32x32x16_bf16 v[80:95], v[108:111], v[116:119], v[80:95]
    ds_read_b128 v[108:111], v62 offset:320
    ds_read_b128 v[112:115], v63 offset:400
    ds_read_b128 v[116:119], v63 offset:2960
    s_waitcnt lgkmcnt(7)
    v_mfma_f32_32x32x16_bf16 v[64:79], v[120:123], v[124:127], v[64:79]
    s_waitcnt lgkmcnt(6)
    v_mfma_f32_32x32x16_bf16 v[80:95], v[120:123], v[128:131], v[80:95]
    ds_read_b128 v[120:123], v62 offset:288
    ds_read_b128 v[124:127], v63 offset:352
    ds_read_b128 v[128:131], v63 offset:2912
    s_waitcnt lgkmcnt(7)
    v_mfma_f32_32x32x16_bf16 v[64:79], v[96:99], v[100:103], v[64:79]
    s_waitcnt lgkmcnt(6)
    v_mfma_f32_32x32x16_bf16 v[80:95], v[96:99], v[104:107], v[80:95]
    ds_read_b128 v[96:99], v62 offset:256
    ds_read_b128 v[100:103], v63 offset:320
    ds_read_b128 v[104:107], v63 offset:2880
    s_waitcnt lgkmcnt(7)
    v_mfma_f32_32x32x16_bf16 v[64:79], v[108:111], v[112:115], v[64:79]
    s_waitcnt lgkmcnt(6)
    v_mfma_f32_32x32x16_bf16 v[80:95], v[108:111], v[116:119], v[80:95]
    ds_read_b128 v[108:111], v62 offset:224
    ds_read_b128 v[112:115], v63 offset:272
    ds_read_b128 v[116:119], v63 offset:2832
    s_waitcnt lgkmcnt(7)
    v_mfma_f32_32x32x16_bf16 v[64:79], v[120:123], v[124:127], v[64:79]
    s_waitcnt lgkmcnt(6)
    v_mfma_f32_32x32x16_bf16 v[80:95], v[120:123], v[128:131], v[80:95]
    ds_read_b128 v[120:123], v62 offset:192
    ds_read_b128 v[124:127], v63 offset:240
    ds_read_b128 v[128:131], v63 offset:2800
    s_waitcnt lgkmcnt(7)
    v_mfma_f32_32x32x16_bf16 v[64:79], v[96:99], v[100:103], v[64:79]
    s_waitcnt lgkmcnt(6)
    v_mfma_f32_32x32x16_bf16 v[80:95], v[96:99], v[104:107], v[80:95]
    ds_read_b128 v[96:99], v62 offset:160
    ds_read_b128 v[100:103], v63 offset:192
    ds_read_b128 v[104:107], v63 offset:2752
    s_waitcnt lgkmcnt(7)
    v_mfma_f32_32x32x16_bf16 v[64:79], v[108:111], v[112:115], v[64:79]
    s_waitcnt lgkmcnt(6)
    v_mfma_f32_32x32x16_bf16 v[80:95], v[108:111], v[116:119], v[80:95]
    ds_read_b128 v[108:111], v62 offset:128
    ds_read_b128 v[112:115], v63 offset:160
    ds_read_b128 v[116:119], v63 offset:2720
    s_waitcnt lgkmcnt(7)
    v_mfma_f32_32x32x16_bf16 v[64:79], v[120:123], v[124:127], v[64:79]
    s_waitcnt lgkmcnt(6)
    v_mfma_f32_32x32x16_bf16 v[80:95], v[120:123], v[128:131], v[80:95]
    ds_read_b128 v[120:123], v62 offset:96
    ds_read_b128 v[124:127], v63 offset:112
    ds_read_b128 v[128:131], v63 offset:2672
    s_waitcnt lgkmcnt(7)
    v_mfma_f32_32x32x16_bf16 v[64:79], v[96:99], v[100:103], v[64:79]
    s_waitcnt lgkmcnt(6)
    v_mfma_f32_32x32x16_bf16 v[80:95], v[96:99], v[104:107], v[80:95]
    ds_read_b128 v[96:99], v62 offset:64
    ds_read_b128 v[100:103], v63 offset:80
    ds_read_b128 v[104:107], v63 offset:2640
    s_waitcnt lgkmcnt(7)
    v_mfma_f32_32x32x16_bf16 v[64:79], v[108:111], v[112:115], v[64:79]
    s_waitcnt lgkmcnt(6)
    v_mfma_f32_32x32x16_bf16 v[80:95], v[108:111], v[116:119], v[80:95]
    ds_read_b128 v[108:111], v62 offset:32
    ds_read_b128 v[112:115], v63 offset:32
    ds_read_b128 v[116:119], v63 offset:2592
    s_waitcnt lgkmcnt(7)
    v_mfma_f32_32x32x16_bf16 v[64:79], v[120:123], v[124:127], v[64:79]
    s_waitcnt lgkmcnt(6)
    v_mfma_f32_32x32x16_bf16 v[80:95], v[120:123], v[128:131], v[80:95]
    ds_read_b128 v[120:123], v62 offset:0
    ds_read_b128 v[124:127], v63 offset:0
    ds_read_b128 v[128:131], v63 offset:2560
    s_waitcnt lgkmcnt(7)
    v_mfma_f32_32x32x16_bf16 v[64:79], v[96:99], v[100:103], v[64:79]
    s_waitcnt lgkmcnt(6)
    v_mfma_f32_32x32x16_bf16 v[80:95], v[96:99], v[104:107], v[80:95]
    s_waitcnt lgkmcnt(4)
    v_mfma_f32_32x32x16_bf16 v[64:79], v[108:111], v[112:115], v[64:79]
    s_waitcnt lgkmcnt(3)
    v_mfma_f32_32x32x16_bf16 v[80:95], v[108:111], v[116:119], v[80:95]
    s_waitcnt lgkmcnt(1)
    v_mfma_f32_32x32x16_bf16 v[64:79], v[120:123], v[124:127], v[64:79]
    s_waitcnt lgkmcnt(0)
    v_mfma_f32_32x32x16_bf16 v[80:95], v[120:123], v[128:131], v[80:95]
    s_branch front_kernel_conv_done
front_kernel_w2:
    s_cmp_eq_u32 s17, 2
    s_cbranch_scc0 front_kernel_w3
    v_subrev_u32 v62, 2496, v144
    v_subrev_u32 v63, 3120, v145
    ds_read_b128 v[96:99], v62 offset:992
    ds_read_b128 v[100:103], v63 offset:1232
    ds_read_b128 v[104:107], v63 offset:3792
    ds_read_b128 v[108:111], v62 offset:960
    ds_read_b128 v[112:115], v63 offset:1200
    ds_read_b128 v[116:119], v63 offset:3760
    ds_read_b128 v[120:123], v62 offset:928
    ds_read_b128 v[124:127], v63 offset:1152
    ds_read_b128 v[128:131], v63 offset:3712
    s_waitcnt lgkmcnt(7)
    v_mfma_f32_32x32x16_bf16 v[64:79], v[96:99], v[100:103], v[64:79]
    s_waitcnt lgkmcnt(6)
    v_mfma_f32_32x32x16_bf16 v[80:95], v[96:99], v[104:107], v[80:95]
    ds_read_b128 v[96:99], v62 offset:896
    ds_read_b128 v[100:103], v63 offset:1120
    ds_read_b128 v[104:107], v63 offset:3680
    s_waitcnt lgkmcnt(7)
    v_mfma_f32_32x32x16_bf16 v[64:79], v[108:111], v[112:115], v[64:79]
    s_waitcnt lgkmcnt(6)
    v_mfma_f32_32x32x16_bf16 v[80:95], v[108:111], v[116:119], v[80:95]
    ds_read_b128 v[108:111], v62 offset:864
    ds_read_b128 v[112:115], v63 offset:1072
    ds_read_b128 v[116:119], v63 offset:3632
    s_waitcnt lgkmcnt(7)
    v_mfma_f32_32x32x16_bf16 v[64:79], v[120:123], v[124:127], v[64:79]
    s_waitcnt lgkmcnt(6)
    v_mfma_f32_32x32x16_bf16 v[80:95], v[120:123], v[128:131], v[80:95]
    ds_read_b128 v[120:123], v62 offset:832
    ds_read_b128 v[124:127], v63 offset:1040
    ds_read_b128 v[128:131], v63 offset:3600
    s_waitcnt lgkmcnt(7)
    v_mfma_f32_32x32x16_bf16 v[64:79], v[96:99], v[100:103], v[64:79]
    s_waitcnt lgkmcnt(6)
    v_mfma_f32_32x32x16_bf16 v[80:95], v[96:99], v[104:107], v[80:95]
    ds_read_b128 v[96:99], v62 offset:800
    ds_read_b128 v[100:103], v63 offset:992
    ds_read_b128 v[104:107], v63 offset:3552
    s_waitcnt lgkmcnt(7)
    v_mfma_f32_32x32x16_bf16 v[64:79], v[108:111], v[112:115], v[64:79]
    s_waitcnt lgkmcnt(6)
    v_mfma_f32_32x32x16_bf16 v[80:95], v[108:111], v[116:119], v[80:95]
    ds_read_b128 v[108:111], v62 offset:768
    ds_read_b128 v[112:115], v63 offset:960
    ds_read_b128 v[116:119], v63 offset:3520
    s_waitcnt lgkmcnt(7)
    v_mfma_f32_32x32x16_bf16 v[64:79], v[120:123], v[124:127], v[64:79]
    s_waitcnt lgkmcnt(6)
    v_mfma_f32_32x32x16_bf16 v[80:95], v[120:123], v[128:131], v[80:95]
    ds_read_b128 v[120:123], v62 offset:736
    ds_read_b128 v[124:127], v63 offset:912
    ds_read_b128 v[128:131], v63 offset:3472
    s_waitcnt lgkmcnt(7)
    v_mfma_f32_32x32x16_bf16 v[64:79], v[96:99], v[100:103], v[64:79]
    s_waitcnt lgkmcnt(6)
    v_mfma_f32_32x32x16_bf16 v[80:95], v[96:99], v[104:107], v[80:95]
    ds_read_b128 v[96:99], v62 offset:704
    ds_read_b128 v[100:103], v63 offset:880
    ds_read_b128 v[104:107], v63 offset:3440
    s_waitcnt lgkmcnt(7)
    v_mfma_f32_32x32x16_bf16 v[64:79], v[108:111], v[112:115], v[64:79]
    s_waitcnt lgkmcnt(6)
    v_mfma_f32_32x32x16_bf16 v[80:95], v[108:111], v[116:119], v[80:95]
    ds_read_b128 v[108:111], v62 offset:672
    ds_read_b128 v[112:115], v63 offset:832
    ds_read_b128 v[116:119], v63 offset:3392
    s_waitcnt lgkmcnt(7)
    v_mfma_f32_32x32x16_bf16 v[64:79], v[120:123], v[124:127], v[64:79]
    s_waitcnt lgkmcnt(6)
    v_mfma_f32_32x32x16_bf16 v[80:95], v[120:123], v[128:131], v[80:95]
    ds_read_b128 v[120:123], v62 offset:640
    ds_read_b128 v[124:127], v63 offset:800
    ds_read_b128 v[128:131], v63 offset:3360
    s_waitcnt lgkmcnt(7)
    v_mfma_f32_32x32x16_bf16 v[64:79], v[96:99], v[100:103], v[64:79]
    s_waitcnt lgkmcnt(6)
    v_mfma_f32_32x32x16_bf16 v[80:95], v[96:99], v[104:107], v[80:95]
    ds_read_b128 v[96:99], v62 offset:608
    ds_read_b128 v[100:103], v63 offset:752
    ds_read_b128 v[104:107], v63 offset:3312
    s_waitcnt lgkmcnt(7)
    v_mfma_f32_32x32x16_bf16 v[64:79], v[108:111], v[112:115], v[64:79]
    s_waitcnt lgkmcnt(6)
    v_mfma_f32_32x32x16_bf16 v[80:95], v[108:111], v[116:119], v[80:95]
    ds_read_b128 v[108:111], v62 offset:576
    ds_read_b128 v[112:115], v63 offset:720
    ds_read_b128 v[116:119], v63 offset:3280
    s_waitcnt lgkmcnt(7)
    v_mfma_f32_32x32x16_bf16 v[64:79], v[120:123], v[124:127], v[64:79]
    s_waitcnt lgkmcnt(6)
    v_mfma_f32_32x32x16_bf16 v[80:95], v[120:123], v[128:131], v[80:95]
    ds_read_b128 v[120:123], v62 offset:544
    ds_read_b128 v[124:127], v63 offset:672
    ds_read_b128 v[128:131], v63 offset:3232
    s_waitcnt lgkmcnt(7)
    v_mfma_f32_32x32x16_bf16 v[64:79], v[96:99], v[100:103], v[64:79]
    s_waitcnt lgkmcnt(6)
    v_mfma_f32_32x32x16_bf16 v[80:95], v[96:99], v[104:107], v[80:95]
    ds_read_b128 v[96:99], v62 offset:512
    ds_read_b128 v[100:103], v63 offset:640
    ds_read_b128 v[104:107], v63 offset:3200
    s_waitcnt lgkmcnt(7)
    v_mfma_f32_32x32x16_bf16 v[64:79], v[108:111], v[112:115], v[64:79]
    s_waitcnt lgkmcnt(6)
    v_mfma_f32_32x32x16_bf16 v[80:95], v[108:111], v[116:119], v[80:95]
    ds_read_b128 v[108:111], v62 offset:480
    ds_read_b128 v[116:119], v63 offset:3152
    s_waitcnt lgkmcnt(6)
    v_mfma_f32_32x32x16_bf16 v[64:79], v[120:123], v[124:127], v[64:79]
    s_waitcnt lgkmcnt(5)
    v_mfma_f32_32x32x16_bf16 v[80:95], v[120:123], v[128:131], v[80:95]
    ds_read_b128 v[120:123], v62 offset:448
    ds_read_b128 v[128:131], v63 offset:3120
    s_waitcnt lgkmcnt(5)
    v_mfma_f32_32x32x16_bf16 v[64:79], v[96:99], v[100:103], v[64:79]
    s_waitcnt lgkmcnt(4)
    v_mfma_f32_32x32x16_bf16 v[80:95], v[96:99], v[104:107], v[80:95]
    ds_read_b128 v[96:99], v62 offset:416
    ds_read_b128 v[104:107], v63 offset:3072
    s_waitcnt lgkmcnt(4)
    v_mfma_f32_32x32x16_bf16 v[80:95], v[108:111], v[116:119], v[80:95]
    ds_read_b128 v[108:111], v62 offset:384
    ds_read_b128 v[116:119], v63 offset:3040
    s_waitcnt lgkmcnt(4)
    v_mfma_f32_32x32x16_bf16 v[80:95], v[120:123], v[128:131], v[80:95]
    ds_read_b128 v[120:123], v62 offset:352
    ds_read_b128 v[128:131], v63 offset:2992
    s_waitcnt lgkmcnt(4)
    v_mfma_f32_32x32x16_bf16 v[80:95], v[96:99], v[104:107], v[80:95]
    ds_read_b128 v[96:99], v62 offset:320
    ds_read_b128 v[104:107], v63 offset:2960
    s_waitcnt lgkmcnt(4)
    v_mfma_f32_32x32x16_bf16 v[80:95], v[108:111], v[116:119], v[80:95]
    ds_read_b128 v[108:111], v62 offset:288
    ds_read_b128 v[116:119], v63 offset:2912
    s_waitcnt lgkmcnt(4)
    v_mfma_f32_32x32x16_bf16 v[80:95], v[120:123], v[128:131], v[80:95]
    ds_read_b128 v[120:123], v62 offset:256
    ds_read_b128 v[128:131], v63 offset:2880
    s_waitcnt lgkmcnt(4)
    v_mfma_f32_32x32x16_bf16 v[80:95], v[96:99], v[104:107], v[80:95]
    ds_read_b128 v[96:99], v62 offset:224
    ds_read_b128 v[104:107], v63 offset:2832
    s_waitcnt lgkmcnt(4)
    v_mfma_f32_32x32x16_bf16 v[80:95], v[108:111], v[116:119], v[80:95]
    ds_read_b128 v[108:111], v62 offset:192
    ds_read_b128 v[116:119], v63 offset:2800
    s_waitcnt lgkmcnt(4)
    v_mfma_f32_32x32x16_bf16 v[80:95], v[120:123], v[128:131], v[80:95]
    ds_read_b128 v[120:123], v62 offset:160
    ds_read_b128 v[128:131], v63 offset:2752
    s_waitcnt lgkmcnt(4)
    v_mfma_f32_32x32x16_bf16 v[80:95], v[96:99], v[104:107], v[80:95]
    ds_read_b128 v[96:99], v62 offset:128
    ds_read_b128 v[104:107], v63 offset:2720
    s_waitcnt lgkmcnt(4)
    v_mfma_f32_32x32x16_bf16 v[80:95], v[108:111], v[116:119], v[80:95]
    ds_read_b128 v[108:111], v62 offset:96
    ds_read_b128 v[116:119], v63 offset:2672
    s_waitcnt lgkmcnt(4)
    v_mfma_f32_32x32x16_bf16 v[80:95], v[120:123], v[128:131], v[80:95]
    ds_read_b128 v[120:123], v62 offset:64
    ds_read_b128 v[128:131], v63 offset:2640
    s_waitcnt lgkmcnt(4)
    v_mfma_f32_32x32x16_bf16 v[80:95], v[96:99], v[104:107], v[80:95]
    ds_read_b128 v[96:99], v62 offset:32
    ds_read_b128 v[104:107], v63 offset:2592
    s_waitcnt lgkmcnt(4)
    v_mfma_f32_32x32x16_bf16 v[80:95], v[108:111], v[116:119], v[80:95]
    ds_read_b128 v[108:111], v62 offset:0
    ds_read_b128 v[116:119], v63 offset:2560
    s_waitcnt lgkmcnt(4)
    v_mfma_f32_32x32x16_bf16 v[80:95], v[120:123], v[128:131], v[80:95]
    s_waitcnt lgkmcnt(2)
    v_mfma_f32_32x32x16_bf16 v[80:95], v[96:99], v[104:107], v[80:95]
    s_waitcnt lgkmcnt(0)
    v_mfma_f32_32x32x16_bf16 v[80:95], v[108:111], v[116:119], v[80:95]
    s_branch front_kernel_conv_done
front_kernel_w3:
    v_subrev_u32 v62, 4032, v144
    v_subrev_u32 v63, 5040, v145
    ds_read_b128 v[120:123], v62 offset:1504
    ds_read_b128 v[128:131], v63 offset:4432
    ds_read_b128 v[96:99], v62 offset:1472
    ds_read_b128 v[104:107], v63 offset:4400
    ds_read_b128 v[108:111], v62 offset:1440
    ds_read_b128 v[116:119], v63 offset:4352
    s_waitcnt lgkmcnt(4)
    v_mfma_f32_32x32x16_bf16 v[80:95], v[120:123], v[128:131], v[80:95]
    ds_read_b128 v[120:123], v62 offset:1408
    ds_read_b128 v[128:131], v63 offset:4320
    s_waitcnt lgkmcnt(4)
    v_mfma_f32_32x32x16_bf16 v[80:95], v[96:99], v[104:107], v[80:95]
    ds_read_b128 v[96:99], v62 offset:1376
    ds_read_b128 v[104:107], v63 offset:4272
    s_waitcnt lgkmcnt(4)
    v_mfma_f32_32x32x16_bf16 v[80:95], v[108:111], v[116:119], v[80:95]
    ds_read_b128 v[108:111], v62 offset:1344
    ds_read_b128 v[116:119], v63 offset:4240
    s_waitcnt lgkmcnt(4)
    v_mfma_f32_32x32x16_bf16 v[80:95], v[120:123], v[128:131], v[80:95]
    ds_read_b128 v[120:123], v62 offset:1312
    ds_read_b128 v[128:131], v63 offset:4192
    s_waitcnt lgkmcnt(4)
    v_mfma_f32_32x32x16_bf16 v[80:95], v[96:99], v[104:107], v[80:95]
    ds_read_b128 v[96:99], v62 offset:1280
    ds_read_b128 v[104:107], v63 offset:4160
    s_waitcnt lgkmcnt(4)
    v_mfma_f32_32x32x16_bf16 v[80:95], v[108:111], v[116:119], v[80:95]
    ds_read_b128 v[108:111], v62 offset:1248
    ds_read_b128 v[116:119], v63 offset:4112
    s_waitcnt lgkmcnt(4)
    v_mfma_f32_32x32x16_bf16 v[80:95], v[120:123], v[128:131], v[80:95]
    ds_read_b128 v[120:123], v62 offset:1216
    ds_read_b128 v[128:131], v63 offset:4080
    s_waitcnt lgkmcnt(4)
    v_mfma_f32_32x32x16_bf16 v[80:95], v[96:99], v[104:107], v[80:95]
    ds_read_b128 v[96:99], v62 offset:1184
    ds_read_b128 v[104:107], v63 offset:4032
    s_waitcnt lgkmcnt(4)
    v_mfma_f32_32x32x16_bf16 v[80:95], v[108:111], v[116:119], v[80:95]
    ds_read_b128 v[108:111], v62 offset:1152
    ds_read_b128 v[116:119], v63 offset:4000
    s_waitcnt lgkmcnt(4)
    v_mfma_f32_32x32x16_bf16 v[80:95], v[120:123], v[128:131], v[80:95]
    ds_read_b128 v[120:123], v62 offset:1120
    ds_read_b128 v[128:131], v63 offset:3952
    s_waitcnt lgkmcnt(4)
    v_mfma_f32_32x32x16_bf16 v[80:95], v[96:99], v[104:107], v[80:95]
    ds_read_b128 v[96:99], v62 offset:1088
    ds_read_b128 v[104:107], v63 offset:3920
    s_waitcnt lgkmcnt(4)
    v_mfma_f32_32x32x16_bf16 v[80:95], v[108:111], v[116:119], v[80:95]
    ds_read_b128 v[108:111], v62 offset:1056
    ds_read_b128 v[116:119], v63 offset:3872
    s_waitcnt lgkmcnt(4)
    v_mfma_f32_32x32x16_bf16 v[80:95], v[120:123], v[128:131], v[80:95]
    ds_read_b128 v[120:123], v62 offset:1024
    ds_read_b128 v[128:131], v63 offset:3840
    s_waitcnt lgkmcnt(4)
    v_mfma_f32_32x32x16_bf16 v[80:95], v[96:99], v[104:107], v[80:95]
    ds_read_b128 v[96:99], v62 offset:992
    ds_read_b128 v[104:107], v63 offset:3792
    s_waitcnt lgkmcnt(4)
    v_mfma_f32_32x32x16_bf16 v[80:95], v[108:111], v[116:119], v[80:95]
    ds_read_b128 v[108:111], v62 offset:960
    ds_read_b128 v[116:119], v63 offset:3760
    s_waitcnt lgkmcnt(4)
    v_mfma_f32_32x32x16_bf16 v[80:95], v[120:123], v[128:131], v[80:95]
    ds_read_b128 v[120:123], v62 offset:928
    ds_read_b128 v[128:131], v63 offset:3712
    s_waitcnt lgkmcnt(4)
    v_mfma_f32_32x32x16_bf16 v[80:95], v[96:99], v[104:107], v[80:95]
    ds_read_b128 v[96:99], v62 offset:896
    ds_read_b128 v[104:107], v63 offset:3680
    s_waitcnt lgkmcnt(4)
    v_mfma_f32_32x32x16_bf16 v[80:95], v[108:111], v[116:119], v[80:95]
    ds_read_b128 v[108:111], v62 offset:864
    ds_read_b128 v[116:119], v63 offset:3632
    s_waitcnt lgkmcnt(4)
    v_mfma_f32_32x32x16_bf16 v[80:95], v[120:123], v[128:131], v[80:95]
    ds_read_b128 v[120:123], v62 offset:832
    ds_read_b128 v[128:131], v63 offset:3600
    s_waitcnt lgkmcnt(4)
    v_mfma_f32_32x32x16_bf16 v[80:95], v[96:99], v[104:107], v[80:95]
    ds_read_b128 v[96:99], v62 offset:800
    ds_read_b128 v[104:107], v63 offset:3552
    s_waitcnt lgkmcnt(4)
    v_mfma_f32_32x32x16_bf16 v[80:95], v[108:111], v[116:119], v[80:95]
    ds_read_b128 v[108:111], v62 offset:768
    ds_read_b128 v[116:119], v63 offset:3520
    s_waitcnt lgkmcnt(4)
    v_mfma_f32_32x32x16_bf16 v[80:95], v[120:123], v[128:131], v[80:95]
    ds_read_b128 v[120:123], v62 offset:736
    ds_read_b128 v[128:131], v63 offset:3472
    s_waitcnt lgkmcnt(4)
    v_mfma_f32_32x32x16_bf16 v[80:95], v[96:99], v[104:107], v[80:95]
    ds_read_b128 v[96:99], v62 offset:704
    ds_read_b128 v[104:107], v63 offset:3440
    s_waitcnt lgkmcnt(4)
    v_mfma_f32_32x32x16_bf16 v[80:95], v[108:111], v[116:119], v[80:95]
    ds_read_b128 v[108:111], v62 offset:672
    ds_read_b128 v[116:119], v63 offset:3392
    s_waitcnt lgkmcnt(4)
    v_mfma_f32_32x32x16_bf16 v[80:95], v[120:123], v[128:131], v[80:95]
    ds_read_b128 v[120:123], v62 offset:640
    ds_read_b128 v[128:131], v63 offset:3360
    s_waitcnt lgkmcnt(4)
    v_mfma_f32_32x32x16_bf16 v[80:95], v[96:99], v[104:107], v[80:95]
    ds_read_b128 v[96:99], v62 offset:608
    ds_read_b128 v[104:107], v63 offset:3312
    s_waitcnt lgkmcnt(4)
    v_mfma_f32_32x32x16_bf16 v[80:95], v[108:111], v[116:119], v[80:95]
    ds_read_b128 v[108:111], v62 offset:576
    ds_read_b128 v[116:119], v63 offset:3280
    s_waitcnt lgkmcnt(4)
    v_mfma_f32_32x32x16_bf16 v[80:95], v[120:123], v[128:131], v[80:95]
    ds_read_b128 v[120:123], v62 offset:544
    ds_read_b128 v[128:131], v63 offset:3232
    s_waitcnt lgkmcnt(4)
    v_mfma_f32_32x32x16_bf16 v[80:95], v[96:99], v[104:107], v[80:95]
    ds_read_b128 v[96:99], v62 offset:512
    ds_read_b128 v[104:107], v63 offset:3200
    s_waitcnt lgkmcnt(4)
    v_mfma_f32_32x32x16_bf16 v[80:95], v[108:111], v[116:119], v[80:95]
    ds_read_b128 v[108:111], v62 offset:480
    ds_read_b128 v[116:119], v63 offset:3152
    s_waitcnt lgkmcnt(4)
    v_mfma_f32_32x32x16_bf16 v[80:95], v[120:123], v[128:131], v[80:95]
    ds_read_b128 v[120:123], v62 offset:448
    ds_read_b128 v[128:131], v63 offset:3120
    s_waitcnt lgkmcnt(4)
    v_mfma_f32_32x32x16_bf16 v[80:95], v[96:99], v[104:107], v[80:95]
    ds_read_b128 v[96:99], v62 offset:416
    ds_read_b128 v[104:107], v63 offset:3072
    s_waitcnt lgkmcnt(4)
    v_mfma_f32_32x32x16_bf16 v[80:95], v[108:111], v[116:119], v[80:95]
    ds_read_b128 v[108:111], v62 offset:384
    ds_read_b128 v[116:119], v63 offset:3040
    s_waitcnt lgkmcnt(4)
    v_mfma_f32_32x32x16_bf16 v[80:95], v[120:123], v[128:131], v[80:95]
    ds_read_b128 v[120:123], v62 offset:352
    ds_read_b128 v[128:131], v63 offset:2992
    s_waitcnt lgkmcnt(4)
    v_mfma_f32_32x32x16_bf16 v[80:95], v[96:99], v[104:107], v[80:95]
    ds_read_b128 v[96:99], v62 offset:320
    ds_read_b128 v[104:107], v63 offset:2960
    s_waitcnt lgkmcnt(4)
    v_mfma_f32_32x32x16_bf16 v[80:95], v[108:111], v[116:119], v[80:95]
    ds_read_b128 v[108:111], v62 offset:288
    ds_read_b128 v[116:119], v63 offset:2912
    s_waitcnt lgkmcnt(4)
    v_mfma_f32_32x32x16_bf16 v[80:95], v[120:123], v[128:131], v[80:95]
    ds_read_b128 v[120:123], v62 offset:256
    ds_read_b128 v[128:131], v63 offset:2880
    s_waitcnt lgkmcnt(4)
    v_mfma_f32_32x32x16_bf16 v[80:95], v[96:99], v[104:107], v[80:95]
    ds_read_b128 v[96:99], v62 offset:224
    ds_read_b128 v[104:107], v63 offset:2832
    s_waitcnt lgkmcnt(4)
    v_mfma_f32_32x32x16_bf16 v[80:95], v[108:111], v[116:119], v[80:95]
    ds_read_b128 v[108:111], v62 offset:192
    ds_read_b128 v[116:119], v63 offset:2800
    s_waitcnt lgkmcnt(4)
    v_mfma_f32_32x32x16_bf16 v[80:95], v[120:123], v[128:131], v[80:95]
    ds_read_b128 v[120:123], v62 offset:160
    ds_read_b128 v[128:131], v63 offset:2752
    s_waitcnt lgkmcnt(4)
    v_mfma_f32_32x32x16_bf16 v[80:95], v[96:99], v[104:107], v[80:95]
    ds_read_b128 v[96:99], v62 offset:128
    ds_read_b128 v[104:107], v63 offset:2720
    s_waitcnt lgkmcnt(4)
    v_mfma_f32_32x32x16_bf16 v[80:95], v[108:111], v[116:119], v[80:95]
    ds_read_b128 v[108:111], v62 offset:96
    ds_read_b128 v[116:119], v63 offset:2672
    s_waitcnt lgkmcnt(4)
    v_mfma_f32_32x32x16_bf16 v[80:95], v[120:123], v[128:131], v[80:95]
    ds_read_b128 v[120:123], v62 offset:64
    ds_read_b128 v[128:131], v63 offset:2640
    s_waitcnt lgkmcnt(4)
    v_mfma_f32_32x32x16_bf16 v[80:95], v[96:99], v[104:107], v[80:95]
    ds_read_b128 v[96:99], v62 offset:32
    ds_read_b128 v[104:107], v63 offset:2592
    s_waitcnt lgkmcnt(4)
    v_mfma_f32_32x32x16_bf16 v[80:95], v[108:111], v[116:119], v[80:95]
    ds_read_b128 v[108:111], v62 offset:0
    ds_read_b128 v[116:119], v63 offset:2560
    s_waitcnt lgkmcnt(4)
    v_mfma_f32_32x32x16_bf16 v[80:95], v[120:123], v[128:131], v[80:95]
    s_waitcnt lgkmcnt(2)
    v_mfma_f32_32x32x16_bf16 v[80:95], v[96:99], v[104:107], v[80:95]
    s_waitcnt lgkmcnt(0)
    v_mfma_f32_32x32x16_bf16 v[80:95], v[108:111], v[116:119], v[80:95]
front_kernel_conv_done:
    s_cmp_lg_u32 s63, 0
    s_cbranch_scc0 front_kernel_slowA
    s_barrier
    s_branch front_kernel_haveA
front_kernel_slowA:
    s_cmp_eq_u32 s17, 0
    s_cbranch_scc0 front_kernel_apoll_ok
    v_mov_b32 v9, 0
    s_mov_b32 s46, 0
front_kernel_apoll:
    global_load_dword v8, v9, s[58:59] offset:136 sc1
    s_waitcnt vmcnt(0)
    v_readfirstlane_b32 s47, v8
    s_nop 3
    s_cmp_lg_u32 s47, 0
    s_cbranch_scc1 front_kernel_apoll_ok
    s_add_u32 s46, s46, 1
    s_cmp_lt_u32 s46, 0x20000
    s_cbranch_scc0 front_kernel_apoll_ok
    s_sleep 2
    s_branch front_kernel_apoll
front_kernel_apoll_ok:
    s_barrier
    s_lshl_b32 s20, s3, 2
    v_mov_b32 v4, s20
    buffer_load_dword v40, v4, s[48:51], 0 offen sc1
    buffer_load_dword v41, v4, s[48:51], 0 offen offset:2304 sc1
    v_add_u32 v4, 4608, v4
    buffer_load_dword v42, v4, s[48:51], 0 offen sc1
front_kernel_haveA:
    s_nop 0
    v_mov_b32 v4, 36928
    ds_read_b128 v[140:143], v4
    v_and_b32 v48, 31, v46
    v_mul_u32_u24 v48, 144, v48
    v_lshrrev_b32 v49, 5, v46
    v_lshlrev_b32 v49, 4, v49
    v_add_u32 v48, v48, v49
    s_mul_i32 s20, s17, 9216
    v_add_u32 v48, s20, v48
    s_nop 7
    s_nop 3
    ds_write_b128 v48, v[64:67] offset:0
    ds_write_b128 v48, v[68:71] offset:32
    ds_write_b128 v48, v[72:75] offset:64
    ds_write_b128 v48, v[76:79] offset:96
    ds_write_b128 v48, v[80:83] offset:4608
    ds_write_b128 v48, v[84:87] offset:4640
    ds_write_b128 v48, v[88:91] offset:4672
    ds_write_b128 v48, v[92:95] offset:4704
    s_waitcnt lgkmcnt(0)
    s_barrier
    v_lshrrev_b32 v48, 2, v0
    v_mul_u32_u24 v48, 144, v48
    v_and_b32 v49, 3, v0
    v_lshlrev_b32 v49, 5, v49
    v_add_u32 v48, v48, v49
    ds_read_b128 v[64:67], v48 offset:0
    ds_read_b128 v[68:71], v48 offset:16
    ds_read_b128 v[72:75], v48 offset:9216
    ds_read_b128 v[76:79], v48 offset:9232
    ds_read_b128 v[80:83], v48 offset:18432
    ds_read_b128 v[84:87], v48 offset:18448
    ds_read_b128 v[88:91], v48 offset:27648
    ds_read_b128 v[92:95], v48 offset:27664
    v_lshlrev_b32 v100, 16, v28
    v_and_b32 v101, 0xffff0000, v28
    v_lshlrev_b32 v102, 16, v29
    v_and_b32 v103, 0xffff0000, v29
    v_lshlrev_b32 v104, 16, v30
    v_and_b32 v105, 0xffff0000, v30
    v_lshlrev_b32 v106, 16, v31
    v_and_b32 v107, 0xffff0000, v31
    v_mov_b32 v144, 0
    s_cmp_ge_u32 s17, 1
    s_cselect_b32 s20, 1.0, 0
    v_fmac_f32 v144, s20, v140
    s_cmp_ge_u32 s17, 2
    s_cselect_b32 s20, 1.0, 0
    v_fmac_f32 v144, s20, v141
    s_cmp_ge_u32 s17, 3
    s_cselect_b32 s20, 1.0, 0
    v_fmac_f32 v144, s20, v142
    v_add_f32 v132, v132, v144
    v_add_f32 v133, v133, v144
    v_add_f32 v134, v134, v144
    v_add_f32 v135, v135, v144
    v_add_f32 v136, v136, v144
    v_add_f32 v137, v137, v144
    v_add_f32 v138, v138, v144
    v_add_f32 v139, v139, v144
    s_waitcnt lgkmcnt(0)
    v_add_f32 v64, v64, v72
    v_add_f32 v80, v80, v88
    v_add_f32 v65, v65, v73
    v_add_f32 v81, v81, v89
    v_add_f32 v66, v66, v74
    v_add_f32 v82, v82, v90
    v_add_f32 v67, v67, v75
    v_add_f32 v83, v83, v91
    v_add_f32 v68, v68, v76
    v_add_f32 v84, v84, v92
    v_add_f32 v69, v69, v77
    v_add_f32 v85, v85, v93
    v_add_f32 v70, v70, v78
    v_add_f32 v86, v86, v94
    v_add_f32 v71, v71, v79
    v_add_f32 v87, v87, v95
    v_add_f32 v64, v64, v80
    v_add_f32 v65, v65, v81
    v_add_f32 v66, v66, v82
    v_add_f32 v67, v67, v83
    v_add_f32 v68, v68, v84
    v_add_f32 v69, v69, v85
    v_add_f32 v70, v70, v86
    v_add_f32 v71, v71, v87
    s_waitcnt vmcnt(0)
    v_add_f32 v52, 1.0, v41
    v_cvt_pk_bf16_f32 v52, v52, v52
    v_lshlrev_b32 v52, 16, v52
    v_pk_mul_f32 v[64:65], v[64:65], v[52:53] op_sel_hi:[1,0]
    v_pk_mul_f32 v[66:67], v[66:67], v[52:53] op_sel_hi:[1,0]
    v_pk_mul_f32 v[68:69], v[68:69], v[52:53] op_sel_hi:[1,0]
    v_pk_mul_f32 v[70:71], v[70:71], v[52:53] op_sel_hi:[1,0]
    v_pk_fma_f32 v[64:65], v[132:133], v[40:41], v[64:65] op_sel_hi:[1,0,1]
    v_pk_fma_f32 v[66:67], v[134:135], v[40:41], v[66:67] op_sel_hi:[1,0,1]
    v_pk_fma_f32 v[68:69], v[136:137], v[40:41], v[68:69] op_sel_hi:[1,0,1]
    v_pk_fma_f32 v[70:71], v[138:139], v[40:41], v[70:71] op_sel_hi:[1,0,1]
    v_mov_b32 v146, s62
    v_pk_fma_f32 v[100:101], v[100:101], v[52:53], v[40:41] op_sel_hi:[1,0,0]
    v_pk_fma_f32 v[102:103], v[102:103], v[52:53], v[40:41] op_sel_hi:[1,0,0]
    v_pk_fma_f32 v[104:105], v[104:105], v[52:53], v[40:41] op_sel_hi:[1,0,0]
    v_pk_fma_f32 v[106:107], v[106:107], v[52:53], v[40:41] op_sel_hi:[1,0,0]
    v_pk_fma_f32 v[64:65], v[100:101], v[146:147], v[64:65] op_sel_hi:[1,0,1]
    v_pk_fma_f32 v[66:67], v[102:103], v[146:147], v[66:67] op_sel_hi:[1,0,1]
    v_pk_fma_f32 v[68:69], v[104:105], v[146:147], v[68:69] op_sel_hi:[1,0,1]
    v_pk_fma_f32 v[70:71], v[106:107], v[146:147], v[70:71] op_sel_hi:[1,0,1]
    v_pk_mul_f32 v[64:65], v[64:65], v[42:43] op_sel_hi:[1,0]
    v_pk_mul_f32 v[66:67], v[66:67], v[42:43] op_sel_hi:[1,0]
    v_pk_mul_f32 v[68:69], v[68:69], v[42:43] op_sel_hi:[1,0]
    v_pk_mul_f32 v[70:71], v[70:71], v[42:43] op_sel_hi:[1,0]
    v_pk_add_f32 v[64:65], v[64:65], v[32:33]
    v_pk_add_f32 v[66:67], v[66:67], v[34:35]
    v_pk_add_f32 v[68:69], v[68:69], v[36:37]
    v_pk_add_f32 v[70:71], v[70:71], v[38:39]
    v_cvt_pk_bf16_f32 v56, v64, v65
    v_cvt_pk_bf16_f32 v57, v66, v67
    v_cvt_pk_bf16_f32 v58, v68, v69
    v_cvt_pk_bf16_f32 v59, v70, v71
    s_lshl_b32 s20, s3, 12
    s_add_u32 s20, s20, 9437184
    s_add_u32 s26, s6, s20
    s_addc_u32 s27, s7, 0
    s_mov_b32 s32, s26
    s_and_b32 s33, s27, 0xffff
    s_mov_b32 s34, 4096
    s_mov_b32 s35, 0x20000
    buffer_store_dwordx4 v[56:59], v5, s[32:35], 0 offen sc1
front_kernel_fin:
front_kernel_end:
    s_endpgm

.globl back_kernel
.p2align 8
.type back_kernel,@function
back_kernel:
    s_cmp_ge_u32 s2, 256
    s_cbranch_scc1 back_kernel_end
    s_load_dwordx2 s[6:7], s[0:1], 144
    s_load_dwordx2 s[4:5], s[0:1], 88
    s_load_dwordx2 s[8:9], s[0:1], 96
    s_load_dwordx2 s[56:57], s[0:1], 128
    s_load_dwordx2 s[60:61], s[0:1], 104
    s_and_b32 s10, s2, 7
    s_lshr_b32 s11, s2, 3
    s_and_b32 s12, s10, 1
    s_lshl_b32 s12, s12, 3
    s_and_b32 s13, s11, 7
    s_add_u32 s12, s12, s13
    s_lshr_b32 s14, s10, 1
    s_lshl_b32 s14, s14, 2
    s_lshr_b32 s15, s11, 3
    s_add_u32 s14, s14, s15
    v_lshrrev_b32 v1, 6, v0
    v_and_b32 v2, 63, v0
    v_mov_b32 v255, v0
    v_readfirstlane_b32 s17, v1
    s_nop 3
    s_and_b32 s18, s17, 3
    s_lshr_b32 s19, s17, 2
    v_mov_b32 v254, v2
    v_and_b32 v3, 15, v2
    v_lshrrev_b32 v4, 4, v2
    v_lshrrev_b32 v6, 1, v3
    v_and_b32 v7, 1, v3
    v_lshlrev_b32 v8, 12, v4
    s_lshl_b32 s20, s18, 16
    v_add_u32 v8, s20, v8
    v_or_b32 v5, 0, v4
    v_xor_b32 v5, v6, v5
    v_lshlrev_b32 v5, 1, v5
    v_or_b32 v5, v5, v7
    v_lshlrev_b32 v5, 4, v5
    v_add_u32 v5, v5, v8
    v_add_u32 v246, 0, v5
    v_or_b32 v5, 0, v4
    v_xor_b32 v5, v6, v5
    v_lshlrev_b32 v5, 1, v5
    v_or_b32 v5, v5, v7
    v_lshlrev_b32 v5, 4, v5
    v_add_u32 v5, v5, v8
    v_add_u32 v247, 15360, v5
    v_or_b32 v5, 4, v4
    v_xor_b32 v5, v6, v5
    v_lshlrev_b32 v5, 1, v5
    v_or_b32 v5, v5, v7
    v_lshlrev_b32 v5, 4, v5
    v_add_u32 v5, v5, v8
    v_add_u32 v248, 30720, v5
    v_or_b32 v5, 4, v4
    v_xor_b32 v5, v6, v5
    v_lshlrev_b32 v5, 1, v5
    v_or_b32 v5, v5, v7
    v_lshlrev_b32 v5, 4, v5
    v_add_u32 v5, v5, v8
    v_add_u32 v249, 46080, v5
    v_lshlrev_b32 v8, 4, v2
    s_lshl_b32 s20, s18, 12
    v_add_u32 v250, s20, v8
    s_lshl_b32 s21, s18, 9
    s_add_u32 s21, s21, 16384
    v_add_u32 v251, s21, v8
    s_lshl_b32 s23, s18, 12
    s_lshl_b32 s24, s18, 9
    s_waitcnt lgkmcnt(0)
    s_add_u32 s58, s6, 24641536
    s_addc_u32 s59, s7, 0
    s_lshl_b32 s20, s12, 8
    s_add_u32 s20, s20, 9437184
    s_add_u32 s26, s6, s20
    s_addc_u32 s27, s7, 0
    s_mov_b32 s28, s26
    s_and_b32 s29, s27, 0xffff
    s_mov_b32 s30, 2359296
    s_mov_b32 s31, 0x20000
    s_mul_i32 s20, s14, 331776
    s_add_u32 s20, s20, 16777216
    s_add_u32 s26, s6, s20
    s_addc_u32 s27, s7, 0
    s_mov_b32 s32, s26
    s_and_b32 s33, s27, 0xffff
    s_mov_b32 s34, 331776
    s_mov_b32 s35, 0x20000
    s_cmp_eq_u32 s19, 0
    s_cbranch_scc1 back_kernel_g0
    s_mov_b32 s40, 0
    s_add_u32 m0, s23, 0
    s_nop 0
    buffer_load_dwordx4 v246, s[28:31], s40 offen lds
    buffer_load_dwordx4 v247, s[28:31], s40 offen offset:1024 lds
    buffer_load_dwordx4 v248, s[28:31], s40 offen offset:2048 lds
    buffer_load_dwordx4 v249, s[28:31], s40 offen offset:3072 lds
    s_mov_b32 s41, 0
    s_add_u32 m0, s23, 16384
    s_nop 0
    buffer_load_dwordx4 v250, s[32:35], s41 offen lds
    buffer_load_dwordx4 v250, s[32:35], s41 offen offset:1024 lds
    buffer_load_dwordx4 v250, s[32:35], s41 offen offset:2048 lds
    buffer_load_dwordx4 v250, s[32:35], s41 offen offset:3072 lds
    s_add_u32 m0, s24, 32768
    s_mov_b32 exec_hi, 0
    buffer_load_dwordx4 v251, s[32:35], s41 offen lds
    s_mov_b32 exec_hi, -1
    s_add_u32 s26, s6, 23068672
    s_addc_u32 s27, s7, 0
    s_mov_b32 s36, s26
    s_and_b32 s37, s27, 0xffff
    s_mov_b32 s38, 36864
    s_mov_b32 s39, 0x20000
    s_lshl_b32 s20, s18, 6
    v_add_u32 v3, s20, v254
    v_subrev_u32 v4, 144, v3
    v_add_u32 v5, 2304, v3
    v_cmp_gt_u32 vcc, 144, v3
    s_mul_i32 s20, s14, 144
    s_nop 0
    v_cndmask_b32 v4, v4, v5, vcc
    v_add_u32 v4, s20, v4
    v_lshlrev_b32 v4, 2, v4
    buffer_load_dword v252, v4, s[36:39], 0 offen
    v_add_u32 v4, 18432, v4
    buffer_load_dword v253, v4, s[36:39], 0 offen
    v_add_u32 v3, 256, v3
    v_subrev_u32 v4, 144, v3
    v_add_u32 v4, s20, v4
    v_lshlrev_b32 v4, 2, v4
    buffer_load_dword v174, v4, s[36:39], 0 offen
    v_add_u32 v4, 18432, v4
    buffer_load_dword v175, v4, s[36:39], 0 offen
    s_mov_b32 s40, 262144
    s_add_u32 m0, s23, 34816
    s_nop 0
    buffer_load_dwordx4 v246, s[28:31], s40 offen lds
    buffer_load_dwordx4 v247, s[28:31], s40 offen offset:1024 lds
    buffer_load_dwordx4 v248, s[28:31], s40 offen offset:2048 lds
    buffer_load_dwordx4 v249, s[28:31], s40 offen offset:3072 lds
    s_mov_b32 s41, 36864
    s_add_u32 m0, s23, 51200
    s_nop 0
    buffer_load_dwordx4 v250, s[32:35], s41 offen lds
    buffer_load_dwordx4 v250, s[32:35], s41 offen offset:1024 lds
    buffer_load_dwordx4 v250, s[32:35], s41 offen offset:2048 lds
    buffer_load_dwordx4 v250, s[32:35], s41 offen offset:3072 lds
    s_add_u32 m0, s24, 67584
    s_mov_b32 exec_hi, 0
    buffer_load_dwordx4 v251, s[32:35], s41 offen lds
    s_mov_b32 exec_hi, -1
    v_lshrrev_b32 v3, 4, v254
    v_bfe_u32 v4, v254, 2, 2
    v_and_b32 v5, 3, v254
    v_and_b32 v6, 1, v3
    v_lshlrev_b32 v6, 2, v6
    v_or_b32 v6, v6, v4
    v_lshlrev_b32 v3, 3, v3
    v_add_u32 v3, v3, v4
    v_lshlrev_b32 v3, 8, v3
    v_lshlrev_b32 v5, 3, v5
    v_add_u32 v3, v3, v5
    s_lshl_b32 s20, s18, 1
    s_add_u32 s21, s20, 0
    v_xor_b32 v7, s21, v6
    v_lshlrev_b32 v7, 5, v7
    v_add_u32 v244, v7, v3
    s_add_u32 s21, s20, 1
    v_xor_b32 v7, s21, v6
    v_lshlrev_b32 v7, 5, v7
    v_add_u32 v245, v7, v3
    v_lshlrev_b32 v8, 4, v254
    v_add_u32 v240, 16384, v8
    v_add_u32 v241, 51200, v8
    v_add_u32 v242, 86016, v8
    v_add_u32 v243, 120832, v8
    v_mov_b32 v144, 0
    v_mov_b32 v145, 0
    v_mov_b32 v146, 0
    v_mov_b32 v147, 0
    v_mov_b32 v148, 0
    v_mov_b32 v149, 0
    v_mov_b32 v150, 0
    v_mov_b32 v151, 0
    v_mov_b32 v152, 0
    v_mov_b32 v153, 0
    v_mov_b32 v154, 0
    v_mov_b32 v155, 0
    v_mov_b32 v156, 0
    v_mov_b32 v157, 0
    v_mov_b32 v158, 0
    v_mov_b32 v159, 0
    v_mov_b32 v160, 0x3f803f80
    v_mov_b32 v161, 0x3f803f80
    v_mov_b32 v162, 0x3f803f80
    v_mov_b32 v163, 0x3f803f80
    s_waitcnt vmcnt(13)
    s_barrier
    s_mov_b32 s40, 524288
    s_add_u32 m0, s23, 69632
    s_nop 0
    buffer_load_dwordx4 v246, s[28:31], s40 offen lds
    buffer_load_dwordx4 v247, s[28:31], s40 offen offset:1024 lds
    buffer_load_dwordx4 v248, s[28:31], s40 offen offset:2048 lds
    buffer_load_dwordx4 v249, s[28:31], s40 offen offset:3072 lds
    s_mov_b32 s41, 73728
    s_add_u32 m0, s23, 86016
    s_nop 0
    buffer_load_dwordx4 v250, s[32:35], s41 offen lds
    buffer_load_dwordx4 v250, s[32:35], s41 offen offset:1024 lds
    buffer_load_dwordx4 v250, s[32:35], s41 offen offset:2048 lds
    buffer_load_dwordx4 v250, s[32:35], s41 offen offset:3072 lds
    s_add_u32 m0, s24, 102400
    s_mov_b32 exec_hi, 0
    buffer_load_dwordx4 v251, s[32:35], s41 offen lds
    s_mov_b32 exec_hi, -1
    s_mov_b32 s40, 786432
    s_add_u32 m0, s23, 104448
    s_nop 0
    buffer_load_dwordx4 v246, s[28:31], s40 offen lds
    buffer_load_dwordx4 v247, s[28:31], s40 offen offset:1024 lds
    buffer_load_dwordx4 v248, s[28:31], s40 offen offset:2048 lds
    buffer_load_dwordx4 v249, s[28:31], s40 offen offset:3072 lds
    s_mov_b32 s41, 110592
    s_add_u32 m0, s23, 120832
    s_nop 0
    buffer_load_dwordx4 v250, s[32:35], s41 offen lds
    buffer_load_dwordx4 v250, s[32:35], s41 offen offset:1024 lds
    buffer_load_dwordx4 v250, s[32:35], s41 offen offset:2048 lds
    buffer_load_dwordx4 v250, s[32:35], s41 offen offset:3072 lds
    s_add_u32 m0, s24, 137216
    s_mov_b32 exec_hi, 0
    buffer_load_dwordx4 v251, s[32:35], s41 offen lds
    s_mov_b32 exec_hi, -1
    v_add_u32 v166, 0, v244
    v_add_u32 v167, 0, v245
    ds_read_b64_tr_b16 v[0:1], v166 offset:0
    ds_read_b64_tr_b16 v[2:3], v166 offset:1024
    ds_read_b64_tr_b16 v[4:5], v167 offset:0
    ds_read_b64_tr_b16 v[6:7], v167 offset:1024
    ds_read_b64_tr_b16 v[8:9], v166 offset:8192
    ds_read_b64_tr_b16 v[10:11], v166 offset:9216
    ds_read_b64_tr_b16 v[12:13], v167 offset:8192
    ds_read_b64_tr_b16 v[14:15], v167 offset:9216
    s_waitcnt lgkmcnt(0)
    s_waitcnt vmcnt(18)
    s_barrier
    v_add_u32 v166, 34816, v244
    v_add_u32 v167, 34816, v245
    s_mov_b32 s40, 1048576
    s_add_u32 m0, s23, 0
    s_nop 0
    buffer_load_dwordx4 v246, s[28:31], s40 offen lds
    ds_read_b64_tr_b16 v[16:17], v166 offset:0
    ds_read_b64_tr_b16 v[18:19], v166 offset:1024
    buffer_load_dwordx4 v247, s[28:31], s40 offen offset:1024 lds
    ds_read_b64_tr_b16 v[20:21], v167 offset:0
    ds_read_b64_tr_b16 v[22:23], v167 offset:1024
    buffer_load_dwordx4 v248, s[28:31], s40 offen offset:2048 lds
    ds_read_b64_tr_b16 v[24:25], v166 offset:8192
    ds_read_b64_tr_b16 v[26:27], v166 offset:9216
    buffer_load_dwordx4 v249, s[28:31], s40 offen offset:3072 lds
    ds_read_b64_tr_b16 v[28:29], v167 offset:8192
    ds_read_b64_tr_b16 v[30:31], v167 offset:9216
    s_mov_b32 s41, 147456
    s_add_u32 m0, s23, 16384
    s_nop 0
    buffer_load_dwordx4 v250, s[32:35], s41 offen lds
    v_mfma_f32_16x16x32_bf16 v[144:147], v[0:3], v[0:3], v[144:147]
    v_mfma_f32_16x16x32_bf16 v[148:151], v[0:3], v[160:163], v[148:151]
    buffer_load_dwordx4 v250, s[32:35], s41 offen offset:1024 lds
    v_mfma_f32_16x16x32_bf16 v[152:155], v[4:7], v[4:7], v[152:155]
    v_mfma_f32_16x16x32_bf16 v[156:159], v[4:7], v[160:163], v[156:159]
    buffer_load_dwordx4 v250, s[32:35], s41 offen offset:2048 lds
    v_mfma_f32_16x16x32_bf16 v[144:147], v[8:11], v[8:11], v[144:147]
    v_mfma_f32_16x16x32_bf16 v[148:151], v[8:11], v[160:163], v[148:151]
    buffer_load_dwordx4 v250, s[32:35], s41 offen offset:3072 lds
    v_mfma_f32_16x16x32_bf16 v[152:155], v[12:15], v[12:15], v[152:155]
    v_mfma_f32_16x16x32_bf16 v[156:159], v[12:15], v[160:163], v[156:159]
    s_add_u32 m0, s24, 32768
    s_mov_b32 exec_hi, 0
    buffer_load_dwordx4 v251, s[32:35], s41 offen lds
    s_mov_b32 exec_hi, -1
    s_waitcnt lgkmcnt(0)
    s_waitcnt vmcnt(18)
    s_barrier
    v_add_u32 v166, 69632, v244
    v_add_u32 v167, 69632, v245
    s_mov_b32 s40, 1310720
    s_add_u32 m0, s23, 34816
    s_nop 0
    buffer_load_dwordx4 v246, s[28:31], s40 offen lds
    ds_read_b64_tr_b16 v[32:33], v166 offset:0
    ds_read_b64_tr_b16 v[34:35], v166 offset:1024
    buffer_load_dwordx4 v247, s[28:31], s40 offen offset:1024 lds
    ds_read_b64_tr_b16 v[36:37], v167 offset:0
    ds_read_b64_tr_b16 v[38:39], v167 offset:1024
    buffer_load_dwordx4 v248, s[28:31], s40 offen offset:2048 lds
    ds_read_b64_tr_b16 v[40:41], v166 offset:8192
    ds_read_b64_tr_b16 v[42:43], v166 offset:9216
    buffer_load_dwordx4 v249, s[28:31], s40 offen offset:3072 lds
    ds_read_b64_tr_b16 v[44:45], v167 offset:8192
    ds_read_b64_tr_b16 v[46:47], v167 offset:9216
    s_mov_b32 s41, 184320
    s_add_u32 m0, s23, 51200
    s_nop 0
    buffer_load_dwordx4 v250, s[32:35], s41 offen lds
    v_mfma_f32_16x16x32_bf16 v[144:147], v[16:19], v[16:19], v[144:147]
    v_mfma_f32_16x16x32_bf16 v[148:151], v[16:19], v[160:163], v[148:151]
    buffer_load_dwordx4 v250, s[32:35], s41 offen offset:1024 lds
    v_mfma_f32_16x16x32_bf16 v[152:155], v[20:23], v[20:23], v[152:155]
    v_mfma_f32_16x16x32_bf16 v[156:159], v[20:23], v[160:163], v[156:159]
    buffer_load_dwordx4 v250, s[32:35], s41 offen offset:2048 lds
    v_mfma_f32_16x16x32_bf16 v[144:147], v[24:27], v[24:27], v[144:147]
    v_mfma_f32_16x16x32_bf16 v[148:151], v[24:27], v[160:163], v[148:151]
    buffer_load_dwordx4 v250, s[32:35], s41 offen offset:3072 lds
    v_mfma_f32_16x16x32_bf16 v[152:155], v[28:31], v[28:31], v[152:155]
    v_mfma_f32_16x16x32_bf16 v[156:159], v[28:31], v[160:163], v[156:159]
    s_add_u32 m0, s24, 67584
    s_mov_b32 exec_hi, 0
    buffer_load_dwordx4 v251, s[32:35], s41 offen lds
    s_mov_b32 exec_hi, -1
    s_waitcnt lgkmcnt(0)
    s_waitcnt vmcnt(18)
    s_barrier
    v_add_u32 v166, 104448, v244
    v_add_u32 v167, 104448, v245
    s_mov_b32 s40, 1572864
    s_add_u32 m0, s23, 69632
    s_nop 0
    buffer_load_dwordx4 v246, s[28:31], s40 offen lds
    ds_read_b64_tr_b16 v[48:49], v166 offset:0
    ds_read_b64_tr_b16 v[50:51], v166 offset:1024
    buffer_load_dwordx4 v247, s[28:31], s40 offen offset:1024 lds
    ds_read_b64_tr_b16 v[52:53], v167 offset:0
    ds_read_b64_tr_b16 v[54:55], v167 offset:1024
    buffer_load_dwordx4 v248, s[28:31], s40 offen offset:2048 lds
    ds_read_b64_tr_b16 v[56:57], v166 offset:8192
    ds_read_b64_tr_b16 v[58:59], v166 offset:9216
    buffer_load_dwordx4 v249, s[28:31], s40 offen offset:3072 lds
    ds_read_b64_tr_b16 v[60:61], v167 offset:8192
    ds_read_b64_tr_b16 v[62:63], v167 offset:9216
    s_mov_b32 s41, 221184
    s_add_u32 m0, s23, 86016
    s_nop 0
    buffer_load_dwordx4 v250, s[32:35], s41 offen lds
    v_mfma_f32_16x16x32_bf16 v[144:147], v[32:35], v[32:35], v[144:147]
    v_mfma_f32_16x16x32_bf16 v[148:151], v[32:35], v[160:163], v[148:151]
    buffer_load_dwordx4 v250, s[32:35], s41 offen offset:1024 lds
    v_mfma_f32_16x16x32_bf16 v[152:155], v[36:39], v[36:39], v[152:155]
    v_mfma_f32_16x16x32_bf16 v[156:159], v[36:39], v[160:163], v[156:159]
    buffer_load_dwordx4 v250, s[32:35], s41 offen offset:2048 lds
    v_mfma_f32_16x16x32_bf16 v[144:147], v[40:43], v[40:43], v[144:147]
    v_mfma_f32_16x16x32_bf16 v[148:151], v[40:43], v[160:163], v[148:151]
    buffer_load_dwordx4 v250, s[32:35], s41 offen offset:3072 lds
    v_mfma_f32_16x16x32_bf16 v[152:155], v[44:47], v[44:47], v[152:155]
    v_mfma_f32_16x16x32_bf16 v[156:159], v[44:47], v[160:163], v[156:159]
    s_add_u32 m0, s24, 102400
    s_mov_b32 exec_hi, 0
    buffer_load_dwordx4 v251, s[32:35], s41 offen lds
    s_mov_b32 exec_hi, -1
    s_waitcnt lgkmcnt(0)
    s_waitcnt vmcnt(18)
    s_barrier
    v_add_u32 v166, 0, v244
    v_add_u32 v167, 0, v245
    s_mov_b32 s40, 1835008
    s_add_u32 m0, s23, 104448
    s_nop 0
    buffer_load_dwordx4 v246, s[28:31], s40 offen lds
    ds_read_b64_tr_b16 v[64:65], v166 offset:0
    ds_read_b64_tr_b16 v[66:67], v166 offset:1024
    buffer_load_dwordx4 v247, s[28:31], s40 offen offset:1024 lds
    ds_read_b64_tr_b16 v[68:69], v167 offset:0
    ds_read_b64_tr_b16 v[70:71], v167 offset:1024
    buffer_load_dwordx4 v248, s[28:31], s40 offen offset:2048 lds
    ds_read_b64_tr_b16 v[72:73], v166 offset:8192
    ds_read_b64_tr_b16 v[74:75], v166 offset:9216
    buffer_load_dwordx4 v249, s[28:31], s40 offen offset:3072 lds
    ds_read_b64_tr_b16 v[76:77], v167 offset:8192
    ds_read_b64_tr_b16 v[78:79], v167 offset:9216
    s_mov_b32 s41, 258048
    s_add_u32 m0, s23, 120832
    s_nop 0
    buffer_load_dwordx4 v250, s[32:35], s41 offen lds
    v_mfma_f32_16x16x32_bf16 v[144:147], v[48:51], v[48:51], v[144:147]
    v_mfma_f32_16x16x32_bf16 v[148:151], v[48:51], v[160:163], v[148:151]
    buffer_load_dwordx4 v250, s[32:35], s41 offen offset:1024 lds
    v_mfma_f32_16x16x32_bf16 v[152:155], v[52:55], v[52:55], v[152:155]
    v_mfma_f32_16x16x32_bf16 v[156:159], v[52:55], v[160:163], v[156:159]
    buffer_load_dwordx4 v250, s[32:35], s41 offen offset:2048 lds
    v_mfma_f32_16x16x32_bf16 v[144:147], v[56:59], v[56:59], v[144:147]
    v_mfma_f32_16x16x32_bf16 v[148:151], v[56:59], v[160:163], v[148:151]
    buffer_load_dwordx4 v250, s[32:35], s41 offen offset:3072 lds
    v_mfma_f32_16x16x32_bf16 v[152:155], v[60:63], v[60:63], v[152:155]
    v_mfma_f32_16x16x32_bf16 v[156:159], v[60:63], v[160:163], v[156:159]
    s_add_u32 m0, s24, 137216
    s_mov_b32 exec_hi, 0
    buffer_load_dwordx4 v251, s[32:35], s41 offen lds
    s_mov_b32 exec_hi, -1
    s_waitcnt lgkmcnt(0)
    s_lshl_b32 s20, s18, 6
    v_add_u32 v168, s20, v254
    v_lshlrev_b32 v169, 2, v168
    v_add_u32 v170, 576, v169
    v_cmp_gt_u32 vcc, 144, v168
    s_nop 1
    v_cndmask_b32 v169, v170, v169, vcc
    v_add_u32 v169, 140288, v169
    ds_write_b32 v169, v252
    ds_write_b32 v169, v253 offset:576
    v_add_u32 v168, 256, v168
    v_lshlrev_b32 v169, 2, v168
    v_add_u32 v169, 140864, v169
    v_cmp_gt_u32 vcc, 288, v168
    s_and_saveexec_b64 s[44:45], vcc
    ds_write_b32 v169, v174
    ds_write_b32 v169, v175 offset:576
    s_mov_b64 exec, s[44:45]
    s_waitcnt lgkmcnt(0)
    s_waitcnt vmcnt(18)
    s_barrier
    v_add_u32 v166, 34816, v244
    v_add_u32 v167, 34816, v245
    s_mov_b32 s40, 2097152
    s_add_u32 m0, s23, 0
    s_nop 0
    buffer_load_dwordx4 v246, s[28:31], s40 offen lds
    ds_read_b64_tr_b16 v[80:81], v166 offset:0
    ds_read_b64_tr_b16 v[82:83], v166 offset:1024
    buffer_load_dwordx4 v247, s[28:31], s40 offen offset:1024 lds
    ds_read_b64_tr_b16 v[84:85], v167 offset:0
    ds_read_b64_tr_b16 v[86:87], v167 offset:1024
    buffer_load_dwordx4 v248, s[28:31], s40 offen offset:2048 lds
    ds_read_b64_tr_b16 v[88:89], v166 offset:8192
    ds_read_b64_tr_b16 v[90:91], v166 offset:9216
    buffer_load_dwordx4 v249, s[28:31], s40 offen offset:3072 lds
    ds_read_b64_tr_b16 v[92:93], v167 offset:8192
    ds_read_b64_tr_b16 v[94:95], v167 offset:9216
    s_mov_b32 s41, 294912
    s_add_u32 m0, s23, 16384
    s_nop 0
    buffer_load_dwordx4 v250, s[32:35], s41 offen lds
    v_mfma_f32_16x16x32_bf16 v[144:147], v[64:67], v[64:67], v[144:147]
    v_mfma_f32_16x16x32_bf16 v[148:151], v[64:67], v[160:163], v[148:151]
    buffer_load_dwordx4 v250, s[32:35], s41 offen offset:1024 lds
    v_mfma_f32_16x16x32_bf16 v[152:155], v[68:71], v[68:71], v[152:155]
    v_mfma_f32_16x16x32_bf16 v[156:159], v[68:71], v[160:163], v[156:159]
    buffer_load_dwordx4 v250, s[32:35], s41 offen offset:2048 lds
    v_mfma_f32_16x16x32_bf16 v[144:147], v[72:75], v[72:75], v[144:147]
    v_mfma_f32_16x16x32_bf16 v[148:151], v[72:75], v[160:163], v[148:151]
    buffer_load_dwordx4 v250, s[32:35], s41 offen offset:3072 lds
    v_mfma_f32_16x16x32_bf16 v[152:155], v[76:79], v[76:79], v[152:155]
    v_mfma_f32_16x16x32_bf16 v[156:159], v[76:79], v[160:163], v[156:159]
    s_add_u32 m0, s24, 32768
    s_mov_b32 exec_hi, 0
    buffer_load_dwordx4 v251, s[32:35], s41 offen lds
    s_mov_b32 exec_hi, -1
    s_waitcnt lgkmcnt(0)
    s_waitcnt vmcnt(18)
    s_barrier
    v_add_u32 v166, 69632, v244
    v_add_u32 v167, 69632, v245
    s_mov_b32 s41, 18432
    s_add_u32 m0, s23, 51200
    s_nop 0
    buffer_load_dwordx4 v250, s[32:35], s41 offen lds
    ds_read_b64_tr_b16 v[96:97], v166 offset:0
    ds_read_b64_tr_b16 v[98:99], v166 offset:1024
    ds_read_b64_tr_b16 v[100:101], v167 offset:0
    ds_read_b64_tr_b16 v[102:103], v167 offset:1024
    buffer_load_dwordx4 v250, s[32:35], s41 offen offset:1024 lds
    ds_read_b64_tr_b16 v[104:105], v166 offset:8192
    ds_read_b64_tr_b16 v[106:107], v166 offset:9216
    ds_read_b64_tr_b16 v[108:109], v167 offset:8192
    ds_read_b64_tr_b16 v[110:111], v167 offset:9216
    buffer_load_dwordx4 v250, s[32:35], s41 offen offset:2048 lds
    v_mfma_f32_16x16x32_bf16 v[144:147], v[80:83], v[80:83], v[144:147]
    v_mfma_f32_16x16x32_bf16 v[148:151], v[80:83], v[160:163], v[148:151]
    v_mfma_f32_16x16x32_bf16 v[152:155], v[84:87], v[84:87], v[152:155]
    v_mfma_f32_16x16x32_bf16 v[156:159], v[84:87], v[160:163], v[156:159]
    buffer_load_dwordx4 v250, s[32:35], s41 offen offset:3072 lds
    v_mfma_f32_16x16x32_bf16 v[144:147], v[88:91], v[88:91], v[144:147]
    v_mfma_f32_16x16x32_bf16 v[148:151], v[88:91], v[160:163], v[148:151]
    v_mfma_f32_16x16x32_bf16 v[152:155], v[92:95], v[92:95], v[152:155]
    v_mfma_f32_16x16x32_bf16 v[156:159], v[92:95], v[160:163], v[156:159]
    s_add_u32 m0, s24, 67584
    s_mov_b32 exec_hi, 0
    buffer_load_dwordx4 v251, s[32:35], s41 offen lds
    s_mov_b32 exec_hi, -1
    s_waitcnt lgkmcnt(0)
    s_waitcnt vmcnt(14)
    s_barrier
    v_add_u32 v166, 104448, v244
    v_add_u32 v167, 104448, v245
    s_mov_b32 s41, 55296
    s_add_u32 m0, s23, 86016
    s_nop 0
    buffer_load_dwordx4 v250, s[32:35], s41 offen lds
    ds_read_b64_tr_b16 v[112:113], v166 offset:0
    ds_read_b64_tr_b16 v[114:115], v166 offset:1024
    ds_read_b64_tr_b16 v[116:117], v167 offset:0
    ds_read_b64_tr_b16 v[118:119], v167 offset:1024
    buffer_load_dwordx4 v250, s[32:35], s41 offen offset:1024 lds
    ds_read_b64_tr_b16 v[120:121], v166 offset:8192
    ds_read_b64_tr_b16 v[122:123], v166 offset:9216
    ds_read_b64_tr_b16 v[124:125], v167 offset:8192
    ds_read_b64_tr_b16 v[126:127], v167 offset:9216
    buffer_load_dwordx4 v250, s[32:35], s41 offen offset:2048 lds
    v_mfma_f32_16x16x32_bf16 v[144:147], v[96:99], v[96:99], v[144:147]
    v_mfma_f32_16x16x32_bf16 v[148:151], v[96:99], v[160:163], v[148:151]
    v_mfma_f32_16x16x32_bf16 v[152:155], v[100:103], v[100:103], v[152:155]
    v_mfma_f32_16x16x32_bf16 v[156:159], v[100:103], v[160:163], v[156:159]
    buffer_load_dwordx4 v250, s[32:35], s41 offen offset:3072 lds
    v_mfma_f32_16x16x32_bf16 v[144:147], v[104:107], v[104:107], v[144:147]
    v_mfma_f32_16x16x32_bf16 v[148:151], v[104:107], v[160:163], v[148:151]
    v_mfma_f32_16x16x32_bf16 v[152:155], v[108:111], v[108:111], v[152:155]
    v_mfma_f32_16x16x32_bf16 v[156:159], v[108:111], v[160:163], v[156:159]
    s_add_u32 m0, s24, 102400
    s_mov_b32 exec_hi, 0
    buffer_load_dwordx4 v251, s[32:35], s41 offen lds
    s_mov_b32 exec_hi, -1
    s_waitcnt lgkmcnt(0)
    s_waitcnt vmcnt(10)
    s_barrier
    v_add_u32 v166, 0, v244
    v_add_u32 v167, 0, v245
    s_mov_b32 s41, 92160
    s_add_u32 m0, s23, 120832
    s_nop 0
    buffer_load_dwordx4 v250, s[32:35], s41 offen lds
    ds_read_b64_tr_b16 v[128:129], v166 offset:0
    ds_read_b64_tr_b16 v[130:131], v166 offset:1024
    ds_read_b64_tr_b16 v[132:133], v167 offset:0
    ds_read_b64_tr_b16 v[134:135], v167 offset:1024
    buffer_load_dwordx4 v250, s[32:35], s41 offen offset:1024 lds
    ds_read_b64_tr_b16 v[136:137], v166 offset:8192
    ds_read_b64_tr_b16 v[138:139], v166 offset:9216
    ds_read_b64_tr_b16 v[140:141], v167 offset:8192
    ds_read_b64_tr_b16 v[142:143], v167 offset:9216
    buffer_load_dwordx4 v250, s[32:35], s41 offen offset:2048 lds
    v_mfma_f32_16x16x32_bf16 v[144:147], v[112:115], v[112:115], v[144:147]
    v_mfma_f32_16x16x32_bf16 v[148:151], v[112:115], v[160:163], v[148:151]
    v_mfma_f32_16x16x32_bf16 v[152:155], v[116:119], v[116:119], v[152:155]
    v_mfma_f32_16x16x32_bf16 v[156:159], v[116:119], v[160:163], v[156:159]
    buffer_load_dwordx4 v250, s[32:35], s41 offen offset:3072 lds
    v_mfma_f32_16x16x32_bf16 v[144:147], v[120:123], v[120:123], v[144:147]
    v_mfma_f32_16x16x32_bf16 v[148:151], v[120:123], v[160:163], v[148:151]
    v_mfma_f32_16x16x32_bf16 v[152:155], v[124:127], v[124:127], v[152:155]
    v_mfma_f32_16x16x32_bf16 v[156:159], v[124:127], v[160:163], v[156:159]
    s_add_u32 m0, s24, 137216
    s_mov_b32 exec_hi, 0
    buffer_load_dwordx4 v251, s[32:35], s41 offen lds
    s_mov_b32 exec_hi, -1
    s_waitcnt lgkmcnt(0)
    v_mfma_f32_16x16x32_bf16 v[144:147], v[128:131], v[128:131], v[144:147]
    v_mfma_f32_16x16x32_bf16 v[148:151], v[128:131], v[160:163], v[148:151]
    v_mfma_f32_16x16x32_bf16 v[152:155], v[132:135], v[132:135], v[152:155]
    v_mfma_f32_16x16x32_bf16 v[156:159], v[132:135], v[160:163], v[156:159]
    v_mfma_f32_16x16x32_bf16 v[144:147], v[136:139], v[136:139], v[144:147]
    v_mfma_f32_16x16x32_bf16 v[148:151], v[136:139], v[160:163], v[148:151]
    v_mfma_f32_16x16x32_bf16 v[152:155], v[140:143], v[140:143], v[152:155]
    v_mfma_f32_16x16x32_bf16 v[156:159], v[140:143], v[160:163], v[156:159]
    s_nop 7
    v_and_b32 v168, 3, v254
    v_cmp_eq_u32 vcc, 1, v168
    v_cmp_eq_u32 s[50:51], 2, v168
    v_cmp_eq_u32 s[52:53], 3, v168
    v_bfe_u32 v168, v254, 2, 2
    v_lshrrev_b32 v169, 4, v254
    v_cmp_eq_u32 s[54:55], v168, v169
    v_cndmask_b32 v170, v144, v145, vcc
    v_cndmask_b32 v170, v170, v146, s[50:51]
    v_cndmask_b32 v170, v170, v147, s[52:53]
    v_cndmask_b32 v170, 0, v170, s[54:55]
    v_cndmask_b32 v171, v148, v149, vcc
    v_cndmask_b32 v171, v171, v150, s[50:51]
    v_cndmask_b32 v171, v171, v151, s[52:53]
    v_cndmask_b32 v171, 0, v171, s[54:55]
    v_cndmask_b32 v172, v152, v153, vcc
    v_cndmask_b32 v172, v172, v154, s[50:51]
    v_cndmask_b32 v172, v172, v155, s[52:53]
    v_cndmask_b32 v172, 0, v172, s[54:55]
    v_cndmask_b32 v173, v156, v157, vcc
    v_cndmask_b32 v173, v173, v158, s[50:51]
    v_cndmask_b32 v173, v173, v159, s[52:53]
    v_cndmask_b32 v173, 0, v173, s[54:55]
    v_mov_b32 v144, v170
    v_mov_b32 v145, v171
    v_mov_b32 v146, v172
    v_mov_b32 v147, v173
    s_nop 1
    v_permlane32_swap_b32 v170, v144
    v_permlane32_swap_b32 v171, v145
    v_permlane32_swap_b32 v172, v146
    v_permlane32_swap_b32 v173, v147
    s_nop 1
    v_add_f32 v170, v170, v144
    v_add_f32 v171, v171, v145
    v_add_f32 v172, v172, v146
    v_add_f32 v173, v173, v147
    v_mov_b32 v144, v170
    v_mov_b32 v145, v171
    v_mov_b32 v146, v172
    v_mov_b32 v147, v173
    s_nop 1
    v_permlane16_swap_b32 v170, v144
    v_permlane16_swap_b32 v171, v145
    v_permlane16_swap_b32 v172, v146
    v_permlane16_swap_b32 v173, v147
    s_nop 1
    v_add_f32 v170, v170, v144
    v_add_f32 v171, v171, v145
    v_add_f32 v172, v172, v146
    v_add_f32 v173, v173, v147
    v_mul_f32 v171, 0x3ae38e39, v171
    v_mul_f32 v170, 0x3ae38e39, v170
    v_fma_f32 v170, -v171, v171, v170
    v_max_f32 v170, 0, v170
    v_add_f32 v170, 0x3727c5ac, v170
    v_rsq_f32 v244, v170
    s_nop 0
    v_mul_f32 v244, 0x3eeff558, v244
    v_mul_f32 v245, v244, v171
    v_sub_f32 v245, 0, v245
    v_mul_f32 v173, 0x3ae38e39, v173
    v_mul_f32 v172, 0x3ae38e39, v172
    v_fma_f32 v172, -v173, v173, v172
    v_max_f32 v172, 0, v172
    v_add_f32 v172, 0x3727c5ac, v172
    v_rsq_f32 v246, v172
    s_nop 0
    v_mul_f32 v246, 0x3eeff558, v246
    v_mul_f32 v247, v246, v173
    v_sub_f32 v247, 0, v247
    v_and_b32 v168, 15, v254
    s_lshl_b32 s20, s18, 5
    v_add_u32 v168, s20, v168
    v_lshlrev_b32 v168, 2, v168
    v_add_u32 v168, 139264, v168
    v_cmp_gt_u32 vcc, 16, v254
    s_and_saveexec_b64 s[44:45], vcc
    ds_write_b32 v168, v244
    ds_write_b32 v168, v245 offset:512
    ds_write_b32 v168, v246 offset:64
    ds_write_b32 v168, v247 offset:576
    s_mov_b64 exec, s[44:45]
    v_mov_b32 v144, 0
    v_mov_b32 v145, 0
    v_mov_b32 v146, 0
    v_mov_b32 v147, 0
    v_mov_b32 v148, 0
    v_mov_b32 v149, 0
    v_mov_b32 v150, 0
    v_mov_b32 v151, 0
    v_mov_b32 v152, 0
    v_mov_b32 v153, 0
    v_mov_b32 v154, 0
    v_mov_b32 v155, 0
    v_mov_b32 v156, 0
    v_mov_b32 v157, 0
    v_mov_b32 v158, 0
    v_mov_b32 v159, 0
    v_mov_b32 v160, 0
    v_mov_b32 v161, 0
    v_mov_b32 v162, 0
    v_mov_b32 v163, 0
    v_mov_b32 v164, 0
    v_mov_b32 v165, 0
    v_mov_b32 v166, 0
    v_mov_b32 v167, 0
    v_mov_b32 v168, 0
    v_mov_b32 v169, 0
    v_mov_b32 v170, 0
    v_mov_b32 v171, 0
    v_mov_b32 v172, 0
    v_mov_b32 v173, 0
    v_mov_b32 v174, 0
    v_mov_b32 v175, 0
    v_mov_b32 v176, 0
    v_mov_b32 v177, 0
    v_mov_b32 v178, 0
    v_mov_b32 v179, 0
    v_mov_b32 v180, 0
    v_mov_b32 v181, 0
    v_mov_b32 v182, 0
    v_mov_b32 v183, 0
    v_mov_b32 v184, 0
    v_mov_b32 v185, 0
    v_mov_b32 v186, 0
    v_mov_b32 v187, 0
    v_mov_b32 v188, 0
    v_mov_b32 v189, 0
    v_mov_b32 v190, 0
    v_mov_b32 v191, 0
    v_mov_b32 v192, 0
    v_mov_b32 v193, 0
    v_mov_b32 v194, 0
    v_mov_b32 v195, 0
    v_mov_b32 v196, 0
    v_mov_b32 v197, 0
    v_mov_b32 v198, 0
    v_mov_b32 v199, 0
    v_mov_b32 v200, 0
    v_mov_b32 v201, 0
    v_mov_b32 v202, 0
    v_mov_b32 v203, 0
    v_mov_b32 v204, 0
    v_mov_b32 v205, 0
    v_mov_b32 v206, 0
    v_mov_b32 v207, 0
    v_mov_b32 v208, 0
    v_mov_b32 v209, 0
    v_mov_b32 v210, 0
    v_mov_b32 v211, 0
    v_mov_b32 v212, 0
    v_mov_b32 v213, 0
    v_mov_b32 v214, 0
    v_mov_b32 v215, 0
    s_waitcnt lgkmcnt(0)
    s_waitcnt vmcnt(10)
    s_barrier
    s_mov_b32 s41, 129024
    s_add_u32 m0, s23, 16384
    s_nop 0
    buffer_load_dwordx4 v250, s[32:35], s41 offen lds
    buffer_load_dwordx4 v250, s[32:35], s41 offen offset:1024 lds
    buffer_load_dwordx4 v250, s[32:35], s41 offen offset:2048 lds
    buffer_load_dwordx4 v250, s[32:35], s41 offen offset:3072 lds
    s_add_u32 m0, s24, 32768
    s_mov_b32 exec_hi, 0
    buffer_load_dwordx4 v251, s[32:35], s41 offen lds
    s_mov_b32 exec_hi, -1
    ds_read_b128 v[216:219], v241 offset:0
    ds_read_b128 v[220:223], v241 offset:1024
    ds_read_b128 v[224:227], v241 offset:2048
    ds_read_b128 v[228:231], v241 offset:3072
    ds_read_b128 v[232:235], v241 offset:4096
    s_waitcnt lgkmcnt(4)
    v_mfma_f32_16x16x32_bf16 v[144:147], v[216:219], v[0:3], v[144:147]
    v_mfma_f32_16x16x32_bf16 v[148:151], v[216:219], v[4:7], v[148:151]
    ds_read_b128 v[236:239], v241 offset:5120
    s_waitcnt lgkmcnt(4)
    v_mfma_f32_16x16x32_bf16 v[152:155], v[220:223], v[0:3], v[152:155]
    v_mfma_f32_16x16x32_bf16 v[156:159], v[220:223], v[4:7], v[156:159]
    ds_read_b128 v[216:219], v241 offset:6144
    s_waitcnt lgkmcnt(4)
    v_mfma_f32_16x16x32_bf16 v[160:163], v[224:227], v[0:3], v[160:163]
    v_mfma_f32_16x16x32_bf16 v[164:167], v[224:227], v[4:7], v[164:167]
    ds_read_b128 v[220:223], v241 offset:7168
    s_waitcnt lgkmcnt(4)
    v_mfma_f32_16x16x32_bf16 v[168:171], v[228:231], v[0:3], v[168:171]
    v_mfma_f32_16x16x32_bf16 v[172:175], v[228:231], v[4:7], v[172:175]
    ds_read_b128 v[224:227], v241 offset:8192
    s_waitcnt lgkmcnt(4)
    v_mfma_f32_16x16x32_bf16 v[176:179], v[232:235], v[0:3], v[176:179]
    v_mfma_f32_16x16x32_bf16 v[180:183], v[232:235], v[4:7], v[180:183]
    ds_read_b128 v[228:231], v241 offset:9216
    s_waitcnt lgkmcnt(4)
    v_mfma_f32_16x16x32_bf16 v[184:187], v[236:239], v[0:3], v[184:187]
    v_mfma_f32_16x16x32_bf16 v[188:191], v[236:239], v[4:7], v[188:191]
    ds_read_b128 v[232:235], v241 offset:10240
    s_waitcnt lgkmcnt(4)
    v_mfma_f32_16x16x32_bf16 v[192:195], v[216:219], v[0:3], v[192:195]
    v_mfma_f32_16x16x32_bf16 v[196:199], v[216:219], v[4:7], v[196:199]
    ds_read_b128 v[236:239], v241 offset:11264
    s_waitcnt lgkmcnt(4)
    v_mfma_f32_16x16x32_bf16 v[200:203], v[220:223], v[0:3], v[200:203]
    v_mfma_f32_16x16x32_bf16 v[204:207], v[220:223], v[4:7], v[204:207]
    ds_read_b128 v[216:219], v241 offset:12288
    s_waitcnt lgkmcnt(4)
    v_mfma_f32_16x16x32_bf16 v[208:211], v[224:227], v[0:3], v[208:211]
    v_mfma_f32_16x16x32_bf16 v[212:215], v[224:227], v[4:7], v[212:215]
    ds_read_b128 v[220:223], v241 offset:13312
    s_waitcnt vmcnt(10)
    s_barrier
    s_waitcnt lgkmcnt(4)
    v_mfma_f32_16x16x32_bf16 v[144:147], v[228:231], v[8:11], v[144:147]
    v_mfma_f32_16x16x32_bf16 v[148:151], v[228:231], v[12:15], v[148:151]
    ds_read_b128 v[224:227], v241 offset:14336
    s_waitcnt lgkmcnt(4)
    v_mfma_f32_16x16x32_bf16 v[152:155], v[232:235], v[8:11], v[152:155]
    v_mfma_f32_16x16x32_bf16 v[156:159], v[232:235], v[12:15], v[156:159]
    ds_read_b128 v[228:231], v241 offset:15360
    s_waitcnt lgkmcnt(4)
    v_mfma_f32_16x16x32_bf16 v[160:163], v[236:239], v[8:11], v[160:163]
    v_mfma_f32_16x16x32_bf16 v[164:167], v[236:239], v[12:15], v[164:167]
    ds_read_b128 v[232:235], v241 offset:16384
    s_waitcnt lgkmcnt(4)
    v_mfma_f32_16x16x32_bf16 v[168:171], v[216:219], v[8:11], v[168:171]
    v_mfma_f32_16x16x32_bf16 v[172:175], v[216:219], v[12:15], v[172:175]
    ds_read_b128 v[236:239], v241 offset:17408
    s_waitcnt lgkmcnt(4)
    v_mfma_f32_16x16x32_bf16 v[176:179], v[220:223], v[8:11], v[176:179]
    v_mfma_f32_16x16x32_bf16 v[180:183], v[220:223], v[12:15], v[180:183]
    ds_read_b128 v[216:219], v242 offset:0
    s_waitcnt lgkmcnt(4)
    v_mfma_f32_16x16x32_bf16 v[184:187], v[224:227], v[8:11], v[184:187]
    v_mfma_f32_16x16x32_bf16 v[188:191], v[224:227], v[12:15], v[188:191]
    ds_read_b128 v[220:223], v242 offset:1024
    s_waitcnt lgkmcnt(4)
    v_mfma_f32_16x16x32_bf16 v[192:195], v[228:231], v[8:11], v[192:195]
    v_mfma_f32_16x16x32_bf16 v[196:199], v[228:231], v[12:15], v[196:199]
    ds_read_b128 v[224:227], v242 offset:2048
    s_waitcnt lgkmcnt(4)
    v_mfma_f32_16x16x32_bf16 v[200:203], v[232:235], v[8:11], v[200:203]
    v_mfma_f32_16x16x32_bf16 v[204:207], v[232:235], v[12:15], v[204:207]
    ds_read_b128 v[228:231], v242 offset:3072
    s_waitcnt lgkmcnt(4)
    v_mfma_f32_16x16x32_bf16 v[208:211], v[236:239], v[8:11], v[208:211]
    v_mfma_f32_16x16x32_bf16 v[212:215], v[236:239], v[12:15], v[212:215]
    ds_read_b128 v[232:235], v242 offset:4096
    s_waitcnt lgkmcnt(4)
    v_mfma_f32_16x16x32_bf16 v[144:147], v[216:219], v[16:19], v[144:147]
    v_mfma_f32_16x16x32_bf16 v[148:151], v[216:219], v[20:23], v[148:151]
    ds_read_b128 v[236:239], v242 offset:5120
    s_waitcnt lgkmcnt(4)
    v_mfma_f32_16x16x32_bf16 v[152:155], v[220:223], v[16:19], v[152:155]
    v_mfma_f32_16x16x32_bf16 v[156:159], v[220:223], v[20:23], v[156:159]
    ds_read_b128 v[216:219], v242 offset:6144
    s_waitcnt lgkmcnt(4)
    v_mfma_f32_16x16x32_bf16 v[160:163], v[224:227], v[16:19], v[160:163]
    v_mfma_f32_16x16x32_bf16 v[164:167], v[224:227], v[20:23], v[164:167]
    ds_read_b128 v[220:223], v242 offset:7168
    s_waitcnt lgkmcnt(4)
    v_mfma_f32_16x16x32_bf16 v[168:171], v[228:231], v[16:19], v[168:171]
    v_mfma_f32_16x16x32_bf16 v[172:175], v[228:231], v[20:23], v[172:175]
    ds_read_b128 v[224:227], v242 offset:8192
    s_waitcnt lgkmcnt(4)
    v_mfma_f32_16x16x32_bf16 v[176:179], v[232:235], v[16:19], v[176:179]
    v_mfma_f32_16x16x32_bf16 v[180:183], v[232:235], v[20:23], v[180:183]
    ds_read_b128 v[228:231], v242 offset:9216
    s_waitcnt lgkmcnt(4)
    v_mfma_f32_16x16x32_bf16 v[184:187], v[236:239], v[16:19], v[184:187]
    v_mfma_f32_16x16x32_bf16 v[188:191], v[236:239], v[20:23], v[188:191]
    ds_read_b128 v[232:235], v242 offset:10240
    s_waitcnt lgkmcnt(4)
    v_mfma_f32_16x16x32_bf16 v[192:195], v[216:219], v[16:19], v[192:195]
    v_mfma_f32_16x16x32_bf16 v[196:199], v[216:219], v[20:23], v[196:199]
    ds_read_b128 v[236:239], v242 offset:11264
    s_waitcnt lgkmcnt(4)
    v_mfma_f32_16x16x32_bf16 v[200:203], v[220:223], v[16:19], v[200:203]
    v_mfma_f32_16x16x32_bf16 v[204:207], v[220:223], v[20:23], v[204:207]
    ds_read_b128 v[216:219], v242 offset:12288
    s_waitcnt lgkmcnt(4)
    v_mfma_f32_16x16x32_bf16 v[208:211], v[224:227], v[16:19], v[208:211]
    v_mfma_f32_16x16x32_bf16 v[212:215], v[224:227], v[20:23], v[212:215]
    ds_read_b128 v[220:223], v242 offset:13312
    s_waitcnt vmcnt(5)
    s_barrier
    s_waitcnt lgkmcnt(4)
    v_mfma_f32_16x16x32_bf16 v[144:147], v[228:231], v[24:27], v[144:147]
    v_mfma_f32_16x16x32_bf16 v[148:151], v[228:231], v[28:31], v[148:151]
    ds_read_b128 v[224:227], v242 offset:14336
    s_waitcnt lgkmcnt(4)
    v_mfma_f32_16x16x32_bf16 v[152:155], v[232:235], v[24:27], v[152:155]
    v_mfma_f32_16x16x32_bf16 v[156:159], v[232:235], v[28:31], v[156:159]
    ds_read_b128 v[228:231], v242 offset:15360
    s_waitcnt lgkmcnt(4)
    v_mfma_f32_16x16x32_bf16 v[160:163], v[236:239], v[24:27], v[160:163]
    v_mfma_f32_16x16x32_bf16 v[164:167], v[236:239], v[28:31], v[164:167]
    ds_read_b128 v[232:235], v242 offset:16384
    s_waitcnt lgkmcnt(4)
    v_mfma_f32_16x16x32_bf16 v[168:171], v[216:219], v[24:27], v[168:171]
    v_mfma_f32_16x16x32_bf16 v[172:175], v[216:219], v[28:31], v[172:175]
    ds_read_b128 v[236:239], v242 offset:17408
    s_waitcnt lgkmcnt(4)
    v_mfma_f32_16x16x32_bf16 v[176:179], v[220:223], v[24:27], v[176:179]
    v_mfma_f32_16x16x32_bf16 v[180:183], v[220:223], v[28:31], v[180:183]
    ds_read_b128 v[216:219], v243 offset:0
    s_waitcnt lgkmcnt(4)
    v_mfma_f32_16x16x32_bf16 v[184:187], v[224:227], v[24:27], v[184:187]
    v_mfma_f32_16x16x32_bf16 v[188:191], v[224:227], v[28:31], v[188:191]
    ds_read_b128 v[220:223], v243 offset:1024
    s_waitcnt lgkmcnt(4)
    v_mfma_f32_16x16x32_bf16 v[192:195], v[228:231], v[24:27], v[192:195]
    v_mfma_f32_16x16x32_bf16 v[196:199], v[228:231], v[28:31], v[196:199]
    ds_read_b128 v[224:227], v243 offset:2048
    s_waitcnt lgkmcnt(4)
    v_mfma_f32_16x16x32_bf16 v[200:203], v[232:235], v[24:27], v[200:203]
    v_mfma_f32_16x16x32_bf16 v[204:207], v[232:235], v[28:31], v[204:207]
    ds_read_b128 v[228:231], v243 offset:3072
    s_waitcnt lgkmcnt(4)
    v_mfma_f32_16x16x32_bf16 v[208:211], v[236:239], v[24:27], v[208:211]
    v_mfma_f32_16x16x32_bf16 v[212:215], v[236:239], v[28:31], v[212:215]
    ds_read_b128 v[232:235], v243 offset:4096
    s_waitcnt lgkmcnt(4)
    v_mfma_f32_16x16x32_bf16 v[144:147], v[216:219], v[32:35], v[144:147]
    v_mfma_f32_16x16x32_bf16 v[148:151], v[216:219], v[36:39], v[148:151]
    ds_read_b128 v[236:239], v243 offset:5120
    s_waitcnt lgkmcnt(4)
    v_mfma_f32_16x16x32_bf16 v[152:155], v[220:223], v[32:35], v[152:155]
    v_mfma_f32_16x16x32_bf16 v[156:159], v[220:223], v[36:39], v[156:159]
    ds_read_b128 v[216:219], v243 offset:6144
    s_waitcnt lgkmcnt(4)
    v_mfma_f32_16x16x32_bf16 v[160:163], v[224:227], v[32:35], v[160:163]
    v_mfma_f32_16x16x32_bf16 v[164:167], v[224:227], v[36:39], v[164:167]
    ds_read_b128 v[220:223], v243 offset:7168
    s_waitcnt lgkmcnt(4)
    v_mfma_f32_16x16x32_bf16 v[168:171], v[228:231], v[32:35], v[168:171]
    v_mfma_f32_16x16x32_bf16 v[172:175], v[228:231], v[36:39], v[172:175]
    ds_read_b128 v[224:227], v243 offset:8192
    s_waitcnt lgkmcnt(4)
    v_mfma_f32_16x16x32_bf16 v[176:179], v[232:235], v[32:35], v[176:179]
    v_mfma_f32_16x16x32_bf16 v[180:183], v[232:235], v[36:39], v[180:183]
    ds_read_b128 v[228:231], v243 offset:9216
    s_waitcnt lgkmcnt(4)
    v_mfma_f32_16x16x32_bf16 v[184:187], v[236:239], v[32:35], v[184:187]
    v_mfma_f32_16x16x32_bf16 v[188:191], v[236:239], v[36:39], v[188:191]
    ds_read_b128 v[232:235], v243 offset:10240
    s_waitcnt lgkmcnt(4)
    v_mfma_f32_16x16x32_bf16 v[192:195], v[216:219], v[32:35], v[192:195]
    v_mfma_f32_16x16x32_bf16 v[196:199], v[216:219], v[36:39], v[196:199]
    ds_read_b128 v[236:239], v243 offset:11264
    s_waitcnt lgkmcnt(4)
    v_mfma_f32_16x16x32_bf16 v[200:203], v[220:223], v[32:35], v[200:203]
    v_mfma_f32_16x16x32_bf16 v[204:207], v[220:223], v[36:39], v[204:207]
    ds_read_b128 v[216:219], v243 offset:12288
    s_waitcnt lgkmcnt(4)
    v_mfma_f32_16x16x32_bf16 v[208:211], v[224:227], v[32:35], v[208:211]
    v_mfma_f32_16x16x32_bf16 v[212:215], v[224:227], v[36:39], v[212:215]
    ds_read_b128 v[220:223], v243 offset:13312
    s_waitcnt vmcnt(0)
    s_barrier
    s_waitcnt lgkmcnt(4)
    v_mfma_f32_16x16x32_bf16 v[144:147], v[228:231], v[40:43], v[144:147]
    v_mfma_f32_16x16x32_bf16 v[148:151], v[228:231], v[44:47], v[148:151]
    ds_read_b128 v[224:227], v243 offset:14336
    s_waitcnt lgkmcnt(4)
    v_mfma_f32_16x16x32_bf16 v[152:155], v[232:235], v[40:43], v[152:155]
    v_mfma_f32_16x16x32_bf16 v[156:159], v[232:235], v[44:47], v[156:159]
    ds_read_b128 v[228:231], v243 offset:15360
    s_waitcnt lgkmcnt(4)
    v_mfma_f32_16x16x32_bf16 v[160:163], v[236:239], v[40:43], v[160:163]
    v_mfma_f32_16x16x32_bf16 v[164:167], v[236:239], v[44:47], v[164:167]
    ds_read_b128 v[232:235], v243 offset:16384
    s_waitcnt lgkmcnt(4)
    v_mfma_f32_16x16x32_bf16 v[168:171], v[216:219], v[40:43], v[168:171]
    v_mfma_f32_16x16x32_bf16 v[172:175], v[216:219], v[44:47], v[172:175]
    ds_read_b128 v[236:239], v243 offset:17408
    s_waitcnt lgkmcnt(4)
    v_mfma_f32_16x16x32_bf16 v[176:179], v[220:223], v[40:43], v[176:179]
    v_mfma_f32_16x16x32_bf16 v[180:183], v[220:223], v[44:47], v[180:183]
    ds_read_b128 v[216:219], v240 offset:0
    s_waitcnt lgkmcnt(4)
    v_mfma_f32_16x16x32_bf16 v[184:187], v[224:227], v[40:43], v[184:187]
    v_mfma_f32_16x16x32_bf16 v[188:191], v[224:227], v[44:47], v[188:191]
    ds_read_b128 v[220:223], v240 offset:1024
    s_waitcnt lgkmcnt(4)
    v_mfma_f32_16x16x32_bf16 v[192:195], v[228:231], v[40:43], v[192:195]
    v_mfma_f32_16x16x32_bf16 v[196:199], v[228:231], v[44:47], v[196:199]
    ds_read_b128 v[224:227], v240 offset:2048
    s_waitcnt lgkmcnt(4)
    v_mfma_f32_16x16x32_bf16 v[200:203], v[232:235], v[40:43], v[200:203]
    v_mfma_f32_16x16x32_bf16 v[204:207], v[232:235], v[44:47], v[204:207]
    ds_read_b128 v[228:231], v240 offset:3072
    s_waitcnt lgkmcnt(4)
    v_mfma_f32_16x16x32_bf16 v[208:211], v[236:239], v[40:43], v[208:211]
    v_mfma_f32_16x16x32_bf16 v[212:215], v[236:239], v[44:47], v[212:215]
    ds_read_b128 v[232:235], v240 offset:4096
    s_waitcnt lgkmcnt(4)
    v_mfma_f32_16x16x32_bf16 v[144:147], v[216:219], v[48:51], v[144:147]
    v_mfma_f32_16x16x32_bf16 v[148:151], v[216:219], v[52:55], v[148:151]
    ds_read_b128 v[236:239], v240 offset:5120
    s_waitcnt lgkmcnt(4)
    v_mfma_f32_16x16x32_bf16 v[152:155], v[220:223], v[48:51], v[152:155]
    v_mfma_f32_16x16x32_bf16 v[156:159], v[220:223], v[52:55], v[156:159]
    ds_read_b128 v[216:219], v240 offset:6144
    s_waitcnt lgkmcnt(4)
    v_mfma_f32_16x16x32_bf16 v[160:163], v[224:227], v[48:51], v[160:163]
    v_mfma_f32_16x16x32_bf16 v[164:167], v[224:227], v[52:55], v[164:167]
    ds_read_b128 v[220:223], v240 offset:7168
    s_waitcnt lgkmcnt(4)
    v_mfma_f32_16x16x32_bf16 v[168:171], v[228:231], v[48:51], v[168:171]
    v_mfma_f32_16x16x32_bf16 v[172:175], v[228:231], v[52:55], v[172:175]
    ds_read_b128 v[224:227], v240 offset:8192
    s_waitcnt lgkmcnt(4)
    v_mfma_f32_16x16x32_bf16 v[176:179], v[232:235], v[48:51], v[176:179]
    v_mfma_f32_16x16x32_bf16 v[180:183], v[232:235], v[52:55], v[180:183]
    ds_read_b128 v[228:231], v240 offset:9216
    s_waitcnt lgkmcnt(4)
    v_mfma_f32_16x16x32_bf16 v[184:187], v[236:239], v[48:51], v[184:187]
    v_mfma_f32_16x16x32_bf16 v[188:191], v[236:239], v[52:55], v[188:191]
    ds_read_b128 v[232:235], v240 offset:10240
    s_waitcnt lgkmcnt(4)
    v_mfma_f32_16x16x32_bf16 v[192:195], v[216:219], v[48:51], v[192:195]
    v_mfma_f32_16x16x32_bf16 v[196:199], v[216:219], v[52:55], v[196:199]
    ds_read_b128 v[236:239], v240 offset:11264
    s_waitcnt lgkmcnt(4)
    v_mfma_f32_16x16x32_bf16 v[200:203], v[220:223], v[48:51], v[200:203]
    v_mfma_f32_16x16x32_bf16 v[204:207], v[220:223], v[52:55], v[204:207]
    ds_read_b128 v[216:219], v240 offset:12288
    s_waitcnt lgkmcnt(4)
    v_mfma_f32_16x16x32_bf16 v[208:211], v[224:227], v[48:51], v[208:211]
    v_mfma_f32_16x16x32_bf16 v[212:215], v[224:227], v[52:55], v[212:215]
    ds_read_b128 v[220:223], v240 offset:13312
    s_barrier
    s_waitcnt lgkmcnt(4)
    v_mfma_f32_16x16x32_bf16 v[144:147], v[228:231], v[56:59], v[144:147]
    v_mfma_f32_16x16x32_bf16 v[148:151], v[228:231], v[60:63], v[148:151]
    ds_read_b128 v[224:227], v240 offset:14336
    s_waitcnt lgkmcnt(4)
    v_mfma_f32_16x16x32_bf16 v[152:155], v[232:235], v[56:59], v[152:155]
    v_mfma_f32_16x16x32_bf16 v[156:159], v[232:235], v[60:63], v[156:159]
    ds_read_b128 v[228:231], v240 offset:15360
    s_waitcnt lgkmcnt(4)
    v_mfma_f32_16x16x32_bf16 v[160:163], v[236:239], v[56:59], v[160:163]
    v_mfma_f32_16x16x32_bf16 v[164:167], v[236:239], v[60:63], v[164:167]
    ds_read_b128 v[232:235], v240 offset:16384
    s_waitcnt lgkmcnt(4)
    v_mfma_f32_16x16x32_bf16 v[168:171], v[216:219], v[56:59], v[168:171]
    v_mfma_f32_16x16x32_bf16 v[172:175], v[216:219], v[60:63], v[172:175]
    ds_read_b128 v[236:239], v240 offset:17408
    s_waitcnt lgkmcnt(4)
    v_mfma_f32_16x16x32_bf16 v[176:179], v[220:223], v[56:59], v[176:179]
    v_mfma_f32_16x16x32_bf16 v[180:183], v[220:223], v[60:63], v[180:183]
    ds_read_b128 v[216:219], v241 offset:0
    s_waitcnt lgkmcnt(4)
    v_mfma_f32_16x16x32_bf16 v[184:187], v[224:227], v[56:59], v[184:187]
    v_mfma_f32_16x16x32_bf16 v[188:191], v[224:227], v[60:63], v[188:191]
    ds_read_b128 v[220:223], v241 offset:1024
    s_waitcnt lgkmcnt(4)
    v_mfma_f32_16x16x32_bf16 v[192:195], v[228:231], v[56:59], v[192:195]
    v_mfma_f32_16x16x32_bf16 v[196:199], v[228:231], v[60:63], v[196:199]
    ds_read_b128 v[224:227], v241 offset:2048
    s_waitcnt lgkmcnt(4)
    v_mfma_f32_16x16x32_bf16 v[200:203], v[232:235], v[56:59], v[200:203]
    v_mfma_f32_16x16x32_bf16 v[204:207], v[232:235], v[60:63], v[204:207]
    ds_read_b128 v[228:231], v241 offset:3072
    s_waitcnt lgkmcnt(4)
    v_mfma_f32_16x16x32_bf16 v[208:211], v[236:239], v[56:59], v[208:211]
    v_mfma_f32_16x16x32_bf16 v[212:215], v[236:239], v[60:63], v[212:215]
    ds_read_b128 v[232:235], v241 offset:4096
    s_waitcnt lgkmcnt(4)
    v_mfma_f32_16x16x32_bf16 v[144:147], v[216:219], v[64:67], v[144:147]
    v_mfma_f32_16x16x32_bf16 v[148:151], v[216:219], v[68:71], v[148:151]
    ds_read_b128 v[236:239], v241 offset:5120
    s_waitcnt lgkmcnt(4)
    v_mfma_f32_16x16x32_bf16 v[152:155], v[220:223], v[64:67], v[152:155]
    v_mfma_f32_16x16x32_bf16 v[156:159], v[220:223], v[68:71], v[156:159]
    ds_read_b128 v[216:219], v241 offset:6144
    s_waitcnt lgkmcnt(4)
    v_mfma_f32_16x16x32_bf16 v[160:163], v[224:227], v[64:67], v[160:163]
    v_mfma_f32_16x16x32_bf16 v[164:167], v[224:227], v[68:71], v[164:167]
    ds_read_b128 v[220:223], v241 offset:7168
    s_waitcnt lgkmcnt(4)
    v_mfma_f32_16x16x32_bf16 v[168:171], v[228:231], v[64:67], v[168:171]
    v_mfma_f32_16x16x32_bf16 v[172:175], v[228:231], v[68:71], v[172:175]
    ds_read_b128 v[224:227], v241 offset:8192
    s_waitcnt lgkmcnt(4)
    v_mfma_f32_16x16x32_bf16 v[176:179], v[232:235], v[64:67], v[176:179]
    v_mfma_f32_16x16x32_bf16 v[180:183], v[232:235], v[68:71], v[180:183]
    ds_read_b128 v[228:231], v241 offset:9216
    s_waitcnt lgkmcnt(4)
    v_mfma_f32_16x16x32_bf16 v[184:187], v[236:239], v[64:67], v[184:187]
    v_mfma_f32_16x16x32_bf16 v[188:191], v[236:239], v[68:71], v[188:191]
    ds_read_b128 v[232:235], v241 offset:10240
    s_waitcnt lgkmcnt(4)
    v_mfma_f32_16x16x32_bf16 v[192:195], v[216:219], v[64:67], v[192:195]
    v_mfma_f32_16x16x32_bf16 v[196:199], v[216:219], v[68:71], v[196:199]
    ds_read_b128 v[236:239], v241 offset:11264
    s_waitcnt lgkmcnt(4)
    v_mfma_f32_16x16x32_bf16 v[200:203], v[220:223], v[64:67], v[200:203]
    v_mfma_f32_16x16x32_bf16 v[204:207], v[220:223], v[68:71], v[204:207]
    ds_read_b128 v[216:219], v241 offset:12288
    s_waitcnt lgkmcnt(4)
    v_mfma_f32_16x16x32_bf16 v[208:211], v[224:227], v[64:67], v[208:211]
    v_mfma_f32_16x16x32_bf16 v[212:215], v[224:227], v[68:71], v[212:215]
    ds_read_b128 v[220:223], v241 offset:13312
    s_barrier
    s_waitcnt lgkmcnt(4)
    v_mfma_f32_16x16x32_bf16 v[144:147], v[228:231], v[72:75], v[144:147]
    v_mfma_f32_16x16x32_bf16 v[148:151], v[228:231], v[76:79], v[148:151]
    ds_read_b128 v[224:227], v241 offset:14336
    s_waitcnt lgkmcnt(4)
    v_mfma_f32_16x16x32_bf16 v[152:155], v[232:235], v[72:75], v[152:155]
    v_mfma_f32_16x16x32_bf16 v[156:159], v[232:235], v[76:79], v[156:159]
    ds_read_b128 v[228:231], v241 offset:15360
    s_waitcnt lgkmcnt(4)
    v_mfma_f32_16x16x32_bf16 v[160:163], v[236:239], v[72:75], v[160:163]
    v_mfma_f32_16x16x32_bf16 v[164:167], v[236:239], v[76:79], v[164:167]
    ds_read_b128 v[232:235], v241 offset:16384
    s_waitcnt lgkmcnt(4)
    v_mfma_f32_16x16x32_bf16 v[168:171], v[216:219], v[72:75], v[168:171]
    v_mfma_f32_16x16x32_bf16 v[172:175], v[216:219], v[76:79], v[172:175]
    ds_read_b128 v[236:239], v241 offset:17408
    s_waitcnt lgkmcnt(4)
    v_mfma_f32_16x16x32_bf16 v[176:179], v[220:223], v[72:75], v[176:179]
    v_mfma_f32_16x16x32_bf16 v[180:183], v[220:223], v[76:79], v[180:183]
    ds_read_b128 v[216:219], v242 offset:0
    s_waitcnt lgkmcnt(4)
    v_mfma_f32_16x16x32_bf16 v[184:187], v[224:227], v[72:75], v[184:187]
    v_mfma_f32_16x16x32_bf16 v[188:191], v[224:227], v[76:79], v[188:191]
    ds_read_b128 v[220:223], v242 offset:1024
    s_waitcnt lgkmcnt(4)
    v_mfma_f32_16x16x32_bf16 v[192:195], v[228:231], v[72:75], v[192:195]
    v_mfma_f32_16x16x32_bf16 v[196:199], v[228:231], v[76:79], v[196:199]
    ds_read_b128 v[224:227], v242 offset:2048
    s_waitcnt lgkmcnt(4)
    v_mfma_f32_16x16x32_bf16 v[200:203], v[232:235], v[72:75], v[200:203]
    v_mfma_f32_16x16x32_bf16 v[204:207], v[232:235], v[76:79], v[204:207]
    ds_read_b128 v[228:231], v242 offset:3072
    s_waitcnt lgkmcnt(4)
    v_mfma_f32_16x16x32_bf16 v[208:211], v[236:239], v[72:75], v[208:211]
    v_mfma_f32_16x16x32_bf16 v[212:215], v[236:239], v[76:79], v[212:215]
    ds_read_b128 v[232:235], v242 offset:4096
    s_waitcnt lgkmcnt(4)
    v_mfma_f32_16x16x32_bf16 v[144:147], v[216:219], v[80:83], v[144:147]
    v_mfma_f32_16x16x32_bf16 v[148:151], v[216:219], v[84:87], v[148:151]
    ds_read_b128 v[236:239], v242 offset:5120
    s_waitcnt lgkmcnt(4)
    v_mfma_f32_16x16x32_bf16 v[152:155], v[220:223], v[80:83], v[152:155]
    v_mfma_f32_16x16x32_bf16 v[156:159], v[220:223], v[84:87], v[156:159]
    ds_read_b128 v[216:219], v242 offset:6144
    s_waitcnt lgkmcnt(4)
    v_mfma_f32_16x16x32_bf16 v[160:163], v[224:227], v[80:83], v[160:163]
    v_mfma_f32_16x16x32_bf16 v[164:167], v[224:227], v[84:87], v[164:167]
    ds_read_b128 v[220:223], v242 offset:7168
    s_waitcnt lgkmcnt(4)
    v_mfma_f32_16x16x32_bf16 v[168:171], v[228:231], v[80:83], v[168:171]
    v_mfma_f32_16x16x32_bf16 v[172:175], v[228:231], v[84:87], v[172:175]
    ds_read_b128 v[224:227], v242 offset:8192
    s_waitcnt lgkmcnt(4)
    v_mfma_f32_16x16x32_bf16 v[176:179], v[232:235], v[80:83], v[176:179]
    v_mfma_f32_16x16x32_bf16 v[180:183], v[232:235], v[84:87], v[180:183]
    ds_read_b128 v[228:231], v242 offset:9216
    s_waitcnt lgkmcnt(4)
    v_mfma_f32_16x16x32_bf16 v[184:187], v[236:239], v[80:83], v[184:187]
    v_mfma_f32_16x16x32_bf16 v[188:191], v[236:239], v[84:87], v[188:191]
    ds_read_b128 v[232:235], v242 offset:10240
    s_waitcnt lgkmcnt(4)
    v_mfma_f32_16x16x32_bf16 v[192:195], v[216:219], v[80:83], v[192:195]
    v_mfma_f32_16x16x32_bf16 v[196:199], v[216:219], v[84:87], v[196:199]
    ds_read_b128 v[236:239], v242 offset:11264
    s_waitcnt lgkmcnt(4)
    v_mfma_f32_16x16x32_bf16 v[200:203], v[220:223], v[80:83], v[200:203]
    v_mfma_f32_16x16x32_bf16 v[204:207], v[220:223], v[84:87], v[204:207]
    ds_read_b128 v[216:219], v242 offset:12288
    s_waitcnt lgkmcnt(4)
    v_mfma_f32_16x16x32_bf16 v[208:211], v[224:227], v[80:83], v[208:211]
    v_mfma_f32_16x16x32_bf16 v[212:215], v[224:227], v[84:87], v[212:215]
    ds_read_b128 v[220:223], v242 offset:13312
    s_barrier
    s_waitcnt lgkmcnt(4)
    v_mfma_f32_16x16x32_bf16 v[144:147], v[228:231], v[88:91], v[144:147]
    v_mfma_f32_16x16x32_bf16 v[148:151], v[228:231], v[92:95], v[148:151]
    ds_read_b128 v[224:227], v242 offset:14336
    s_waitcnt lgkmcnt(4)
    v_mfma_f32_16x16x32_bf16 v[152:155], v[232:235], v[88:91], v[152:155]
    v_mfma_f32_16x16x32_bf16 v[156:159], v[232:235], v[92:95], v[156:159]
    ds_read_b128 v[228:231], v242 offset:15360
    s_waitcnt lgkmcnt(4)
    v_mfma_f32_16x16x32_bf16 v[160:163], v[236:239], v[88:91], v[160:163]
    v_mfma_f32_16x16x32_bf16 v[164:167], v[236:239], v[92:95], v[164:167]
    ds_read_b128 v[232:235], v242 offset:16384
    s_waitcnt lgkmcnt(4)
    v_mfma_f32_16x16x32_bf16 v[168:171], v[216:219], v[88:91], v[168:171]
    v_mfma_f32_16x16x32_bf16 v[172:175], v[216:219], v[92:95], v[172:175]
    ds_read_b128 v[236:239], v242 offset:17408
    s_waitcnt lgkmcnt(4)
    v_mfma_f32_16x16x32_bf16 v[176:179], v[220:223], v[88:91], v[176:179]
    v_mfma_f32_16x16x32_bf16 v[180:183], v[220:223], v[92:95], v[180:183]
    ds_read_b128 v[216:219], v243 offset:0
    s_waitcnt lgkmcnt(4)
    v_mfma_f32_16x16x32_bf16 v[184:187], v[224:227], v[88:91], v[184:187]
    v_mfma_f32_16x16x32_bf16 v[188:191], v[224:227], v[92:95], v[188:191]
    ds_read_b128 v[220:223], v243 offset:1024
    s_waitcnt lgkmcnt(4)
    v_mfma_f32_16x16x32_bf16 v[192:195], v[228:231], v[88:91], v[192:195]
    v_mfma_f32_16x16x32_bf16 v[196:199], v[228:231], v[92:95], v[196:199]
    ds_read_b128 v[224:227], v243 offset:2048
    s_waitcnt lgkmcnt(4)
    v_mfma_f32_16x16x32_bf16 v[200:203], v[232:235], v[88:91], v[200:203]
    v_mfma_f32_16x16x32_bf16 v[204:207], v[232:235], v[92:95], v[204:207]
    ds_read_b128 v[228:231], v243 offset:3072
    s_waitcnt lgkmcnt(4)
    v_mfma_f32_16x16x32_bf16 v[208:211], v[236:239], v[88:91], v[208:211]
    v_mfma_f32_16x16x32_bf16 v[212:215], v[236:239], v[92:95], v[212:215]
    ds_read_b128 v[232:235], v243 offset:4096
    s_waitcnt lgkmcnt(4)
    v_mfma_f32_16x16x32_bf16 v[144:147], v[216:219], v[96:99], v[144:147]
    v_mfma_f32_16x16x32_bf16 v[148:151], v[216:219], v[100:103], v[148:151]
    ds_read_b128 v[236:239], v243 offset:5120
    s_waitcnt lgkmcnt(4)
    v_mfma_f32_16x16x32_bf16 v[152:155], v[220:223], v[96:99], v[152:155]
    v_mfma_f32_16x16x32_bf16 v[156:159], v[220:223], v[100:103], v[156:159]
    ds_read_b128 v[216:219], v243 offset:6144
    s_waitcnt lgkmcnt(4)
    v_mfma_f32_16x16x32_bf16 v[160:163], v[224:227], v[96:99], v[160:163]
    v_mfma_f32_16x16x32_bf16 v[164:167], v[224:227], v[100:103], v[164:167]
    ds_read_b128 v[220:223], v243 offset:7168
    s_waitcnt lgkmcnt(4)
    v_mfma_f32_16x16x32_bf16 v[168:171], v[228:231], v[96:99], v[168:171]
    v_mfma_f32_16x16x32_bf16 v[172:175], v[228:231], v[100:103], v[172:175]
    ds_read_b128 v[224:227], v243 offset:8192
    s_waitcnt lgkmcnt(4)
    v_mfma_f32_16x16x32_bf16 v[176:179], v[232:235], v[96:99], v[176:179]
    v_mfma_f32_16x16x32_bf16 v[180:183], v[232:235], v[100:103], v[180:183]
    ds_read_b128 v[228:231], v243 offset:9216
    s_waitcnt lgkmcnt(4)
    v_mfma_f32_16x16x32_bf16 v[184:187], v[236:239], v[96:99], v[184:187]
    v_mfma_f32_16x16x32_bf16 v[188:191], v[236:239], v[100:103], v[188:191]
    ds_read_b128 v[232:235], v243 offset:10240
    s_waitcnt lgkmcnt(4)
    v_mfma_f32_16x16x32_bf16 v[192:195], v[216:219], v[96:99], v[192:195]
    v_mfma_f32_16x16x32_bf16 v[196:199], v[216:219], v[100:103], v[196:199]
    ds_read_b128 v[236:239], v243 offset:11264
    s_waitcnt lgkmcnt(4)
    v_mfma_f32_16x16x32_bf16 v[200:203], v[220:223], v[96:99], v[200:203]
    v_mfma_f32_16x16x32_bf16 v[204:207], v[220:223], v[100:103], v[204:207]
    ds_read_b128 v[216:219], v243 offset:12288
    s_waitcnt lgkmcnt(4)
    v_mfma_f32_16x16x32_bf16 v[208:211], v[224:227], v[96:99], v[208:211]
    v_mfma_f32_16x16x32_bf16 v[212:215], v[224:227], v[100:103], v[212:215]
    ds_read_b128 v[220:223], v243 offset:13312
    s_barrier
    s_waitcnt lgkmcnt(4)
    v_mfma_f32_16x16x32_bf16 v[144:147], v[228:231], v[104:107], v[144:147]
    v_mfma_f32_16x16x32_bf16 v[148:151], v[228:231], v[108:111], v[148:151]
    ds_read_b128 v[224:227], v243 offset:14336
    s_waitcnt lgkmcnt(4)
    v_mfma_f32_16x16x32_bf16 v[152:155], v[232:235], v[104:107], v[152:155]
    v_mfma_f32_16x16x32_bf16 v[156:159], v[232:235], v[108:111], v[156:159]
    ds_read_b128 v[228:231], v243 offset:15360
    s_waitcnt lgkmcnt(4)
    v_mfma_f32_16x16x32_bf16 v[160:163], v[236:239], v[104:107], v[160:163]
    v_mfma_f32_16x16x32_bf16 v[164:167], v[236:239], v[108:111], v[164:167]
    ds_read_b128 v[232:235], v243 offset:16384
    s_waitcnt lgkmcnt(4)
    v_mfma_f32_16x16x32_bf16 v[168:171], v[216:219], v[104:107], v[168:171]
    v_mfma_f32_16x16x32_bf16 v[172:175], v[216:219], v[108:111], v[172:175]
    ds_read_b128 v[236:239], v243 offset:17408
    s_waitcnt lgkmcnt(4)
    v_mfma_f32_16x16x32_bf16 v[176:179], v[220:223], v[104:107], v[176:179]
    v_mfma_f32_16x16x32_bf16 v[180:183], v[220:223], v[108:111], v[180:183]
    ds_read_b128 v[216:219], v240 offset:0
    s_waitcnt lgkmcnt(4)
    v_mfma_f32_16x16x32_bf16 v[184:187], v[224:227], v[104:107], v[184:187]
    v_mfma_f32_16x16x32_bf16 v[188:191], v[224:227], v[108:111], v[188:191]
    ds_read_b128 v[220:223], v240 offset:1024
    s_waitcnt lgkmcnt(4)
    v_mfma_f32_16x16x32_bf16 v[192:195], v[228:231], v[104:107], v[192:195]
    v_mfma_f32_16x16x32_bf16 v[196:199], v[228:231], v[108:111], v[196:199]
    ds_read_b128 v[224:227], v240 offset:2048
    s_waitcnt lgkmcnt(4)
    v_mfma_f32_16x16x32_bf16 v[200:203], v[232:235], v[104:107], v[200:203]
    v_mfma_f32_16x16x32_bf16 v[204:207], v[232:235], v[108:111], v[204:207]
    ds_read_b128 v[228:231], v240 offset:3072
    s_waitcnt lgkmcnt(4)
    v_mfma_f32_16x16x32_bf16 v[208:211], v[236:239], v[104:107], v[208:211]
    v_mfma_f32_16x16x32_bf16 v[212:215], v[236:239], v[108:111], v[212:215]
    ds_read_b128 v[232:235], v240 offset:4096
    s_waitcnt lgkmcnt(4)
    v_mfma_f32_16x16x32_bf16 v[144:147], v[216:219], v[112:115], v[144:147]
    v_mfma_f32_16x16x32_bf16 v[148:151], v[216:219], v[116:119], v[148:151]
    ds_read_b128 v[236:239], v240 offset:5120
    s_waitcnt lgkmcnt(4)
    v_mfma_f32_16x16x32_bf16 v[152:155], v[220:223], v[112:115], v[152:155]
    v_mfma_f32_16x16x32_bf16 v[156:159], v[220:223], v[116:119], v[156:159]
    ds_read_b128 v[216:219], v240 offset:6144
    s_waitcnt lgkmcnt(4)
    v_mfma_f32_16x16x32_bf16 v[160:163], v[224:227], v[112:115], v[160:163]
    v_mfma_f32_16x16x32_bf16 v[164:167], v[224:227], v[116:119], v[164:167]
    ds_read_b128 v[220:223], v240 offset:7168
    s_waitcnt lgkmcnt(4)
    v_mfma_f32_16x16x32_bf16 v[168:171], v[228:231], v[112:115], v[168:171]
    v_mfma_f32_16x16x32_bf16 v[172:175], v[228:231], v[116:119], v[172:175]
    ds_read_b128 v[224:227], v240 offset:8192
    s_waitcnt lgkmcnt(4)
    v_mfma_f32_16x16x32_bf16 v[176:179], v[232:235], v[112:115], v[176:179]
    v_mfma_f32_16x16x32_bf16 v[180:183], v[232:235], v[116:119], v[180:183]
    ds_read_b128 v[228:231], v240 offset:9216
    s_waitcnt lgkmcnt(4)
    v_mfma_f32_16x16x32_bf16 v[184:187], v[236:239], v[112:115], v[184:187]
    v_mfma_f32_16x16x32_bf16 v[188:191], v[236:239], v[116:119], v[188:191]
    ds_read_b128 v[232:235], v240 offset:10240
    s_waitcnt lgkmcnt(4)
    v_mfma_f32_16x16x32_bf16 v[192:195], v[216:219], v[112:115], v[192:195]
    v_mfma_f32_16x16x32_bf16 v[196:199], v[216:219], v[116:119], v[196:199]
    ds_read_b128 v[236:239], v240 offset:11264
    s_waitcnt lgkmcnt(4)
    v_mfma_f32_16x16x32_bf16 v[200:203], v[220:223], v[112:115], v[200:203]
    v_mfma_f32_16x16x32_bf16 v[204:207], v[220:223], v[116:119], v[204:207]
    ds_read_b128 v[216:219], v240 offset:12288
    s_waitcnt lgkmcnt(4)
    v_mfma_f32_16x16x32_bf16 v[208:211], v[224:227], v[112:115], v[208:211]
    v_mfma_f32_16x16x32_bf16 v[212:215], v[224:227], v[116:119], v[212:215]
    ds_read_b128 v[220:223], v240 offset:13312
    s_barrier
    s_waitcnt lgkmcnt(4)
    v_mfma_f32_16x16x32_bf16 v[144:147], v[228:231], v[120:123], v[144:147]
    v_mfma_f32_16x16x32_bf16 v[148:151], v[228:231], v[124:127], v[148:151]
    ds_read_b128 v[224:227], v240 offset:14336
    s_waitcnt lgkmcnt(4)
    v_mfma_f32_16x16x32_bf16 v[152:155], v[232:235], v[120:123], v[152:155]
    v_mfma_f32_16x16x32_bf16 v[156:159], v[232:235], v[124:127], v[156:159]
    ds_read_b128 v[228:231], v240 offset:15360
    s_waitcnt lgkmcnt(4)
    v_mfma_f32_16x16x32_bf16 v[160:163], v[236:239], v[120:123], v[160:163]
    v_mfma_f32_16x16x32_bf16 v[164:167], v[236:239], v[124:127], v[164:167]
    ds_read_b128 v[232:235], v240 offset:16384
    s_waitcnt lgkmcnt(4)
    v_mfma_f32_16x16x32_bf16 v[168:171], v[216:219], v[120:123], v[168:171]
    v_mfma_f32_16x16x32_bf16 v[172:175], v[216:219], v[124:127], v[172:175]
    ds_read_b128 v[236:239], v240 offset:17408
    s_waitcnt lgkmcnt(4)
    v_mfma_f32_16x16x32_bf16 v[176:179], v[220:223], v[120:123], v[176:179]
    v_mfma_f32_16x16x32_bf16 v[180:183], v[220:223], v[124:127], v[180:183]
    ds_read_b128 v[216:219], v241 offset:0
    s_waitcnt lgkmcnt(4)
    v_mfma_f32_16x16x32_bf16 v[184:187], v[224:227], v[120:123], v[184:187]
    v_mfma_f32_16x16x32_bf16 v[188:191], v[224:227], v[124:127], v[188:191]
    ds_read_b128 v[220:223], v241 offset:1024
    s_waitcnt lgkmcnt(4)
    v_mfma_f32_16x16x32_bf16 v[192:195], v[228:231], v[120:123], v[192:195]
    v_mfma_f32_16x16x32_bf16 v[196:199], v[228:231], v[124:127], v[196:199]
    ds_read_b128 v[224:227], v241 offset:2048
    s_waitcnt lgkmcnt(4)
    v_mfma_f32_16x16x32_bf16 v[200:203], v[232:235], v[120:123], v[200:203]
    v_mfma_f32_16x16x32_bf16 v[204:207], v[232:235], v[124:127], v[204:207]
    ds_read_b128 v[228:231], v241 offset:3072
    s_waitcnt lgkmcnt(4)
    v_mfma_f32_16x16x32_bf16 v[208:211], v[236:239], v[120:123], v[208:211]
    v_mfma_f32_16x16x32_bf16 v[212:215], v[236:239], v[124:127], v[212:215]
    ds_read_b128 v[232:235], v241 offset:4096
    s_waitcnt lgkmcnt(4)
    v_mfma_f32_16x16x32_bf16 v[144:147], v[216:219], v[128:131], v[144:147]
    v_mfma_f32_16x16x32_bf16 v[148:151], v[216:219], v[132:135], v[148:151]
    ds_read_b128 v[236:239], v241 offset:5120
    s_waitcnt lgkmcnt(4)
    v_mfma_f32_16x16x32_bf16 v[152:155], v[220:223], v[128:131], v[152:155]
    v_mfma_f32_16x16x32_bf16 v[156:159], v[220:223], v[132:135], v[156:159]
    ds_read_b128 v[216:219], v241 offset:6144
    s_waitcnt lgkmcnt(4)
    v_mfma_f32_16x16x32_bf16 v[160:163], v[224:227], v[128:131], v[160:163]
    v_mfma_f32_16x16x32_bf16 v[164:167], v[224:227], v[132:135], v[164:167]
    ds_read_b128 v[220:223], v241 offset:7168
    s_waitcnt lgkmcnt(4)
    v_mfma_f32_16x16x32_bf16 v[168:171], v[228:231], v[128:131], v[168:171]
    v_mfma_f32_16x16x32_bf16 v[172:175], v[228:231], v[132:135], v[172:175]
    ds_read_b128 v[224:227], v241 offset:8192
    s_waitcnt lgkmcnt(4)
    v_mfma_f32_16x16x32_bf16 v[176:179], v[232:235], v[128:131], v[176:179]
    v_mfma_f32_16x16x32_bf16 v[180:183], v[232:235], v[132:135], v[180:183]
    ds_read_b128 v[228:231], v241 offset:9216
    s_waitcnt lgkmcnt(4)
    v_mfma_f32_16x16x32_bf16 v[184:187], v[236:239], v[128:131], v[184:187]
    v_mfma_f32_16x16x32_bf16 v[188:191], v[236:239], v[132:135], v[188:191]
    ds_read_b128 v[232:235], v241 offset:10240
    s_waitcnt lgkmcnt(4)
    v_mfma_f32_16x16x32_bf16 v[192:195], v[216:219], v[128:131], v[192:195]
    v_mfma_f32_16x16x32_bf16 v[196:199], v[216:219], v[132:135], v[196:199]
    ds_read_b128 v[236:239], v241 offset:11264
    s_waitcnt lgkmcnt(4)
    v_mfma_f32_16x16x32_bf16 v[200:203], v[220:223], v[128:131], v[200:203]
    v_mfma_f32_16x16x32_bf16 v[204:207], v[220:223], v[132:135], v[204:207]
    ds_read_b128 v[216:219], v241 offset:12288
    s_waitcnt lgkmcnt(4)
    v_mfma_f32_16x16x32_bf16 v[208:211], v[224:227], v[128:131], v[208:211]
    v_mfma_f32_16x16x32_bf16 v[212:215], v[224:227], v[132:135], v[212:215]
    ds_read_b128 v[220:223], v241 offset:13312
    s_barrier
    s_waitcnt lgkmcnt(4)
    v_mfma_f32_16x16x32_bf16 v[144:147], v[228:231], v[136:139], v[144:147]
    v_mfma_f32_16x16x32_bf16 v[148:151], v[228:231], v[140:143], v[148:151]
    ds_read_b128 v[224:227], v241 offset:14336
    s_waitcnt lgkmcnt(4)
    v_mfma_f32_16x16x32_bf16 v[152:155], v[232:235], v[136:139], v[152:155]
    v_mfma_f32_16x16x32_bf16 v[156:159], v[232:235], v[140:143], v[156:159]
    ds_read_b128 v[228:231], v241 offset:15360
    s_waitcnt lgkmcnt(4)
    v_mfma_f32_16x16x32_bf16 v[160:163], v[236:239], v[136:139], v[160:163]
    v_mfma_f32_16x16x32_bf16 v[164:167], v[236:239], v[140:143], v[164:167]
    ds_read_b128 v[232:235], v241 offset:16384
    s_waitcnt lgkmcnt(4)
    v_mfma_f32_16x16x32_bf16 v[168:171], v[216:219], v[136:139], v[168:171]
    v_mfma_f32_16x16x32_bf16 v[172:175], v[216:219], v[140:143], v[172:175]
    ds_read_b128 v[236:239], v241 offset:17408
    s_waitcnt lgkmcnt(4)
    v_mfma_f32_16x16x32_bf16 v[176:179], v[220:223], v[136:139], v[176:179]
    v_mfma_f32_16x16x32_bf16 v[180:183], v[220:223], v[140:143], v[180:183]
    s_waitcnt lgkmcnt(3)
    v_mfma_f32_16x16x32_bf16 v[184:187], v[224:227], v[136:139], v[184:187]
    v_mfma_f32_16x16x32_bf16 v[188:191], v[224:227], v[140:143], v[188:191]
    s_waitcnt lgkmcnt(2)
    v_mfma_f32_16x16x32_bf16 v[192:195], v[228:231], v[136:139], v[192:195]
    v_mfma_f32_16x16x32_bf16 v[196:199], v[228:231], v[140:143], v[196:199]
    s_waitcnt lgkmcnt(1)
    v_mfma_f32_16x16x32_bf16 v[200:203], v[232:235], v[136:139], v[200:203]
    v_mfma_f32_16x16x32_bf16 v[204:207], v[232:235], v[140:143], v[204:207]
    s_waitcnt lgkmcnt(0)
    v_mfma_f32_16x16x32_bf16 v[208:211], v[236:239], v[136:139], v[208:211]
    v_mfma_f32_16x16x32_bf16 v[212:215], v[236:239], v[140:143], v[212:215]
    s_mov_b32 s46, 0xbdd2d3e8
    s_mov_b32 s47, 0xbdd2d3e8
    v_mov_b32 v8, 0xc09d30fc
    v_mov_b32 v9, 0xc09d30fc
    v_mov_b32 v10, 1.0
    v_mov_b32 v11, 1.0
    v_lshrrev_b32 v12, 4, v254
    v_lshlrev_b32 v12, 4, v12
    v_add_u32 v12, 141440, v12
    ds_read_b128 v[16:19], v12
    ds_read_b128 v[20:23], v12 offset:576
    ds_read_b128 v[24:27], v12 offset:64
    ds_read_b128 v[28:31], v12 offset:640
    s_waitcnt lgkmcnt(2)
    v_pk_fma_f32 v[0:1], v[244:245], v[16:17], v[20:21] op_sel:[1,0,0]
    v_pk_fma_f32 v[2:3], v[244:245], v[18:19], v[22:23] op_sel:[1,0,0]
    v_pk_fma_f32 v[4:5], v[246:247], v[16:17], v[20:21] op_sel:[1,0,0]
    v_pk_fma_f32 v[6:7], v[246:247], v[18:19], v[22:23] op_sel:[1,0,0]
    v_pk_fma_f32 v[144:145], v[244:245], v[144:145], v[0:1] op_sel_hi:[0,1,1]
    v_pk_fma_f32 v[146:147], v[244:245], v[146:147], v[2:3] op_sel_hi:[0,1,1]
    v_pk_fma_f32 v[148:149], v[246:247], v[148:149], v[4:5] op_sel_hi:[0,1,1]
    v_pk_fma_f32 v[150:151], v[246:247], v[150:151], v[6:7] op_sel_hi:[0,1,1]
    v_pk_fma_f32 v[0:1], v[144:145], v[144:145], v[8:9] neg_lo:[1,0,0] neg_hi:[1,0,0]
    v_pk_fma_f32 v[2:3], v[146:147], v[146:147], v[8:9] neg_lo:[1,0,0] neg_hi:[1,0,0]
    v_pk_fma_f32 v[4:5], v[148:149], v[148:149], v[8:9] neg_lo:[1,0,0] neg_hi:[1,0,0]
    v_pk_fma_f32 v[6:7], v[150:151], v[150:151], v[8:9] neg_lo:[1,0,0] neg_hi:[1,0,0]
    v_pk_mul_f32 v[0:1], v[0:1], v[144:145]
    v_pk_mul_f32 v[2:3], v[2:3], v[146:147]
    v_pk_mul_f32 v[4:5], v[4:5], v[148:149]
    v_pk_mul_f32 v[6:7], v[6:7], v[150:151]
    v_exp_f32 v0, v0
    v_exp_f32 v1, v1
    v_exp_f32 v2, v2
    v_exp_f32 v3, v3
    v_exp_f32 v4, v4
    v_exp_f32 v5, v5
    v_exp_f32 v6, v6
    v_exp_f32 v7, v7
    v_pk_add_f32 v[0:1], v[0:1], v[10:11]
    v_pk_add_f32 v[2:3], v[2:3], v[10:11]
    v_pk_add_f32 v[4:5], v[4:5], v[10:11]
    v_pk_add_f32 v[6:7], v[6:7], v[10:11]
    v_rcp_f32 v0, v0
    v_rcp_f32 v1, v1
    v_rcp_f32 v2, v2
    v_rcp_f32 v3, v3
    v_rcp_f32 v4, v4
    v_rcp_f32 v5, v5
    v_rcp_f32 v6, v6
    v_rcp_f32 v7, v7
    v_pk_mul_f32 v[144:145], v[144:145], v[0:1]
    v_pk_mul_f32 v[146:147], v[146:147], v[2:3]
    v_pk_mul_f32 v[148:149], v[148:149], v[4:5]
    v_pk_mul_f32 v[150:151], v[150:151], v[6:7]
    v_cvt_pk_bf16_f32 v32, v144, v145
    v_cvt_pk_bf16_f32 v33, v146, v147
    v_cvt_pk_bf16_f32 v50, v148, v149
    v_cvt_pk_bf16_f32 v51, v150, v151
    ds_read_b128 v[16:19], v12 offset:128
    ds_read_b128 v[20:23], v12 offset:704
    s_waitcnt lgkmcnt(2)
    v_pk_fma_f32 v[0:1], v[244:245], v[24:25], v[28:29] op_sel:[1,0,0]
    v_pk_fma_f32 v[2:3], v[244:245], v[26:27], v[30:31] op_sel:[1,0,0]
    v_pk_fma_f32 v[4:5], v[246:247], v[24:25], v[28:29] op_sel:[1,0,0]
    v_pk_fma_f32 v[6:7], v[246:247], v[26:27], v[30:31] op_sel:[1,0,0]
    v_pk_fma_f32 v[152:153], v[244:245], v[152:153], v[0:1] op_sel_hi:[0,1,1]
    v_pk_fma_f32 v[154:155], v[244:245], v[154:155], v[2:3] op_sel_hi:[0,1,1]
    v_pk_fma_f32 v[156:157], v[246:247], v[156:157], v[4:5] op_sel_hi:[0,1,1]
    v_pk_fma_f32 v[158:159], v[246:247], v[158:159], v[6:7] op_sel_hi:[0,1,1]
    v_pk_fma_f32 v[0:1], v[152:153], v[152:153], v[8:9] neg_lo:[1,0,0] neg_hi:[1,0,0]
    v_pk_fma_f32 v[2:3], v[154:155], v[154:155], v[8:9] neg_lo:[1,0,0] neg_hi:[1,0,0]
    v_pk_fma_f32 v[4:5], v[156:157], v[156:157], v[8:9] neg_lo:[1,0,0] neg_hi:[1,0,0]
    v_pk_fma_f32 v[6:7], v[158:159], v[158:159], v[8:9] neg_lo:[1,0,0] neg_hi:[1,0,0]
    v_pk_mul_f32 v[0:1], v[0:1], v[152:153]
    v_pk_mul_f32 v[2:3], v[2:3], v[154:155]
    v_pk_mul_f32 v[4:5], v[4:5], v[156:157]
    v_pk_mul_f32 v[6:7], v[6:7], v[158:159]
    v_exp_f32 v0, v0
    v_exp_f32 v1, v1
    v_exp_f32 v2, v2
    v_exp_f32 v3, v3
    v_exp_f32 v4, v4
    v_exp_f32 v5, v5
    v_exp_f32 v6, v6
    v_exp_f32 v7, v7
    v_pk_add_f32 v[0:1], v[0:1], v[10:11]
    v_pk_add_f32 v[2:3], v[2:3], v[10:11]
    v_pk_add_f32 v[4:5], v[4:5], v[10:11]
    v_pk_add_f32 v[6:7], v[6:7], v[10:11]
    v_rcp_f32 v0, v0
    v_rcp_f32 v1, v1
    v_rcp_f32 v2, v2
    v_rcp_f32 v3, v3
    v_rcp_f32 v4, v4
    v_rcp_f32 v5, v5
    v_rcp_f32 v6, v6
    v_rcp_f32 v7, v7
    v_pk_mul_f32 v[152:153], v[152:153], v[0:1]
    v_pk_mul_f32 v[154:155], v[154:155], v[2:3]
    v_pk_mul_f32 v[156:157], v[156:157], v[4:5]
    v_pk_mul_f32 v[158:159], v[158:159], v[6:7]
    v_cvt_pk_bf16_f32 v34, v152, v153
    v_cvt_pk_bf16_f32 v35, v154, v155
    v_cvt_pk_bf16_f32 v52, v156, v157
    v_cvt_pk_bf16_f32 v53, v158, v159
    ds_read_b128 v[24:27], v12 offset:192
    ds_read_b128 v[28:31], v12 offset:768
    s_waitcnt lgkmcnt(2)
    v_pk_fma_f32 v[0:1], v[244:245], v[16:17], v[20:21] op_sel:[1,0,0]
    v_pk_fma_f32 v[2:3], v[244:245], v[18:19], v[22:23] op_sel:[1,0,0]
    v_pk_fma_f32 v[4:5], v[246:247], v[16:17], v[20:21] op_sel:[1,0,0]
    v_pk_fma_f32 v[6:7], v[246:247], v[18:19], v[22:23] op_sel:[1,0,0]
    v_pk_fma_f32 v[160:161], v[244:245], v[160:161], v[0:1] op_sel_hi:[0,1,1]
    v_pk_fma_f32 v[162:163], v[244:245], v[162:163], v[2:3] op_sel_hi:[0,1,1]
    v_pk_fma_f32 v[164:165], v[246:247], v[164:165], v[4:5] op_sel_hi:[0,1,1]
    v_pk_fma_f32 v[166:167], v[246:247], v[166:167], v[6:7] op_sel_hi:[0,1,1]
    v_pk_fma_f32 v[0:1], v[160:161], v[160:161], v[8:9] neg_lo:[1,0,0] neg_hi:[1,0,0]
    v_pk_fma_f32 v[2:3], v[162:163], v[162:163], v[8:9] neg_lo:[1,0,0] neg_hi:[1,0,0]
    v_pk_fma_f32 v[4:5], v[164:165], v[164:165], v[8:9] neg_lo:[1,0,0] neg_hi:[1,0,0]
    v_pk_fma_f32 v[6:7], v[166:167], v[166:167], v[8:9] neg_lo:[1,0,0] neg_hi:[1,0,0]
    v_pk_mul_f32 v[0:1], v[0:1], v[160:161]
    v_pk_mul_f32 v[2:3], v[2:3], v[162:163]
    v_pk_mul_f32 v[4:5], v[4:5], v[164:165]
    v_pk_mul_f32 v[6:7], v[6:7], v[166:167]
    v_exp_f32 v0, v0
    v_exp_f32 v1, v1
    v_exp_f32 v2, v2
    v_exp_f32 v3, v3
    v_exp_f32 v4, v4
    v_exp_f32 v5, v5
    v_exp_f32 v6, v6
    v_exp_f32 v7, v7
    v_pk_add_f32 v[0:1], v[0:1], v[10:11]
    v_pk_add_f32 v[2:3], v[2:3], v[10:11]
    v_pk_add_f32 v[4:5], v[4:5], v[10:11]
    v_pk_add_f32 v[6:7], v[6:7], v[10:11]
    v_rcp_f32 v0, v0
    v_rcp_f32 v1, v1
    v_rcp_f32 v2, v2
    v_rcp_f32 v3, v3
    v_rcp_f32 v4, v4
    v_rcp_f32 v5, v5
    v_rcp_f32 v6, v6
    v_rcp_f32 v7, v7
    v_pk_mul_f32 v[160:161], v[160:161], v[0:1]
    v_pk_mul_f32 v[162:163], v[162:163], v[2:3]
    v_pk_mul_f32 v[164:165], v[164:165], v[4:5]
    v_pk_mul_f32 v[166:167], v[166:167], v[6:7]
    v_cvt_pk_bf16_f32 v36, v160, v161
    v_cvt_pk_bf16_f32 v37, v162, v163
    v_cvt_pk_bf16_f32 v54, v164, v165
    v_cvt_pk_bf16_f32 v55, v166, v167
    ds_read_b128 v[16:19], v12 offset:256
    ds_read_b128 v[20:23], v12 offset:832
    s_waitcnt lgkmcnt(2)
    v_pk_fma_f32 v[0:1], v[244:245], v[24:25], v[28:29] op_sel:[1,0,0]
    v_pk_fma_f32 v[2:3], v[244:245], v[26:27], v[30:31] op_sel:[1,0,0]
    v_pk_fma_f32 v[4:5], v[246:247], v[24:25], v[28:29] op_sel:[1,0,0]
    v_pk_fma_f32 v[6:7], v[246:247], v[26:27], v[30:31] op_sel:[1,0,0]
    v_pk_fma_f32 v[168:169], v[244:245], v[168:169], v[0:1] op_sel_hi:[0,1,1]
    v_pk_fma_f32 v[170:171], v[244:245], v[170:171], v[2:3] op_sel_hi:[0,1,1]
    v_pk_fma_f32 v[172:173], v[246:247], v[172:173], v[4:5] op_sel_hi:[0,1,1]
    v_pk_fma_f32 v[174:175], v[246:247], v[174:175], v[6:7] op_sel_hi:[0,1,1]
    v_pk_fma_f32 v[0:1], v[168:169], v[168:169], v[8:9] neg_lo:[1,0,0] neg_hi:[1,0,0]
    v_pk_fma_f32 v[2:3], v[170:171], v[170:171], v[8:9] neg_lo:[1,0,0] neg_hi:[1,0,0]
    v_pk_fma_f32 v[4:5], v[172:173], v[172:173], v[8:9] neg_lo:[1,0,0] neg_hi:[1,0,0]
    v_pk_fma_f32 v[6:7], v[174:175], v[174:175], v[8:9] neg_lo:[1,0,0] neg_hi:[1,0,0]
    v_pk_mul_f32 v[0:1], v[0:1], v[168:169]
    v_pk_mul_f32 v[2:3], v[2:3], v[170:171]
    v_pk_mul_f32 v[4:5], v[4:5], v[172:173]
    v_pk_mul_f32 v[6:7], v[6:7], v[174:175]
    v_exp_f32 v0, v0
    v_exp_f32 v1, v1
    v_exp_f32 v2, v2
    v_exp_f32 v3, v3
    v_exp_f32 v4, v4
    v_exp_f32 v5, v5
    v_exp_f32 v6, v6
    v_exp_f32 v7, v7
    v_pk_add_f32 v[0:1], v[0:1], v[10:11]
    v_pk_add_f32 v[2:3], v[2:3], v[10:11]
    v_pk_add_f32 v[4:5], v[4:5], v[10:11]
    v_pk_add_f32 v[6:7], v[6:7], v[10:11]
    v_rcp_f32 v0, v0
    v_rcp_f32 v1, v1
    v_rcp_f32 v2, v2
    v_rcp_f32 v3, v3
    v_rcp_f32 v4, v4
    v_rcp_f32 v5, v5
    v_rcp_f32 v6, v6
    v_rcp_f32 v7, v7
    v_pk_mul_f32 v[168:169], v[168:169], v[0:1]
    v_pk_mul_f32 v[170:171], v[170:171], v[2:3]
    v_pk_mul_f32 v[172:173], v[172:173], v[4:5]
    v_pk_mul_f32 v[174:175], v[174:175], v[6:7]
    v_cvt_pk_bf16_f32 v38, v168, v169
    v_cvt_pk_bf16_f32 v39, v170, v171
    v_cvt_pk_bf16_f32 v56, v172, v173
    v_cvt_pk_bf16_f32 v57, v174, v175
    ds_read_b128 v[24:27], v12 offset:320
    ds_read_b128 v[28:31], v12 offset:896
    s_waitcnt lgkmcnt(2)
    v_pk_fma_f32 v[0:1], v[244:245], v[16:17], v[20:21] op_sel:[1,0,0]
    v_pk_fma_f32 v[2:3], v[244:245], v[18:19], v[22:23] op_sel:[1,0,0]
    v_pk_fma_f32 v[4:5], v[246:247], v[16:17], v[20:21] op_sel:[1,0,0]
    v_pk_fma_f32 v[6:7], v[246:247], v[18:19], v[22:23] op_sel:[1,0,0]
    v_pk_fma_f32 v[176:177], v[244:245], v[176:177], v[0:1] op_sel_hi:[0,1,1]
    v_pk_fma_f32 v[178:179], v[244:245], v[178:179], v[2:3] op_sel_hi:[0,1,1]
    v_pk_fma_f32 v[180:181], v[246:247], v[180:181], v[4:5] op_sel_hi:[0,1,1]
    v_pk_fma_f32 v[182:183], v[246:247], v[182:183], v[6:7] op_sel_hi:[0,1,1]
    v_pk_fma_f32 v[0:1], v[176:177], v[176:177], v[8:9] neg_lo:[1,0,0] neg_hi:[1,0,0]
    v_pk_fma_f32 v[2:3], v[178:179], v[178:179], v[8:9] neg_lo:[1,0,0] neg_hi:[1,0,0]
    v_pk_fma_f32 v[4:5], v[180:181], v[180:181], v[8:9] neg_lo:[1,0,0] neg_hi:[1,0,0]
    v_pk_fma_f32 v[6:7], v[182:183], v[182:183], v[8:9] neg_lo:[1,0,0] neg_hi:[1,0,0]
    v_pk_mul_f32 v[0:1], v[0:1], v[176:177]
    v_pk_mul_f32 v[2:3], v[2:3], v[178:179]
    v_pk_mul_f32 v[4:5], v[4:5], v[180:181]
    v_pk_mul_f32 v[6:7], v[6:7], v[182:183]
    v_exp_f32 v0, v0
    v_exp_f32 v1, v1
    v_exp_f32 v2, v2
    v_exp_f32 v3, v3
    v_exp_f32 v4, v4
    v_exp_f32 v5, v5
    v_exp_f32 v6, v6
    v_exp_f32 v7, v7
    v_pk_add_f32 v[0:1], v[0:1], v[10:11]
    v_pk_add_f32 v[2:3], v[2:3], v[10:11]
    v_pk_add_f32 v[4:5], v[4:5], v[10:11]
    v_pk_add_f32 v[6:7], v[6:7], v[10:11]
    v_rcp_f32 v0, v0
    v_rcp_f32 v1, v1
    v_rcp_f32 v2, v2
    v_rcp_f32 v3, v3
    v_rcp_f32 v4, v4
    v_rcp_f32 v5, v5
    v_rcp_f32 v6, v6
    v_rcp_f32 v7, v7
    v_pk_mul_f32 v[176:177], v[176:177], v[0:1]
    v_pk_mul_f32 v[178:179], v[178:179], v[2:3]
    v_pk_mul_f32 v[180:181], v[180:181], v[4:5]
    v_pk_mul_f32 v[182:183], v[182:183], v[6:7]
    v_cvt_pk_bf16_f32 v40, v176, v177
    v_cvt_pk_bf16_f32 v41, v178, v179
    v_cvt_pk_bf16_f32 v58, v180, v181
    v_cvt_pk_bf16_f32 v59, v182, v183
    ds_read_b128 v[16:19], v12 offset:384
    ds_read_b128 v[20:23], v12 offset:960
    s_waitcnt lgkmcnt(2)
    v_pk_fma_f32 v[0:1], v[244:245], v[24:25], v[28:29] op_sel:[1,0,0]
    v_pk_fma_f32 v[2:3], v[244:245], v[26:27], v[30:31] op_sel:[1,0,0]
    v_pk_fma_f32 v[4:5], v[246:247], v[24:25], v[28:29] op_sel:[1,0,0]
    v_pk_fma_f32 v[6:7], v[246:247], v[26:27], v[30:31] op_sel:[1,0,0]
    v_pk_fma_f32 v[184:185], v[244:245], v[184:185], v[0:1] op_sel_hi:[0,1,1]
    v_pk_fma_f32 v[186:187], v[244:245], v[186:187], v[2:3] op_sel_hi:[0,1,1]
    v_pk_fma_f32 v[188:189], v[246:247], v[188:189], v[4:5] op_sel_hi:[0,1,1]
    v_pk_fma_f32 v[190:191], v[246:247], v[190:191], v[6:7] op_sel_hi:[0,1,1]
    v_pk_fma_f32 v[0:1], v[184:185], v[184:185], v[8:9] neg_lo:[1,0,0] neg_hi:[1,0,0]
    v_pk_fma_f32 v[2:3], v[186:187], v[186:187], v[8:9] neg_lo:[1,0,0] neg_hi:[1,0,0]
    v_pk_fma_f32 v[4:5], v[188:189], v[188:189], v[8:9] neg_lo:[1,0,0] neg_hi:[1,0,0]
    v_pk_fma_f32 v[6:7], v[190:191], v[190:191], v[8:9] neg_lo:[1,0,0] neg_hi:[1,0,0]
    v_pk_mul_f32 v[0:1], v[0:1], v[184:185]
    v_pk_mul_f32 v[2:3], v[2:3], v[186:187]
    v_pk_mul_f32 v[4:5], v[4:5], v[188:189]
    v_pk_mul_f32 v[6:7], v[6:7], v[190:191]
    v_exp_f32 v0, v0
    v_exp_f32 v1, v1
    v_exp_f32 v2, v2
    v_exp_f32 v3, v3
    v_exp_f32 v4, v4
    v_exp_f32 v5, v5
    v_exp_f32 v6, v6
    v_exp_f32 v7, v7
    v_pk_add_f32 v[0:1], v[0:1], v[10:11]
    v_pk_add_f32 v[2:3], v[2:3], v[10:11]
    v_pk_add_f32 v[4:5], v[4:5], v[10:11]
    v_pk_add_f32 v[6:7], v[6:7], v[10:11]
    v_rcp_f32 v0, v0
    v_rcp_f32 v1, v1
    v_rcp_f32 v2, v2
    v_rcp_f32 v3, v3
    v_rcp_f32 v4, v4
    v_rcp_f32 v5, v5
    v_rcp_f32 v6, v6
    v_rcp_f32 v7, v7
    v_pk_mul_f32 v[184:185], v[184:185], v[0:1]
    v_pk_mul_f32 v[186:187], v[186:187], v[2:3]
    v_pk_mul_f32 v[188:189], v[188:189], v[4:5]
    v_pk_mul_f32 v[190:191], v[190:191], v[6:7]
    v_cvt_pk_bf16_f32 v42, v184, v185
    v_cvt_pk_bf16_f32 v43, v186, v187
    v_cvt_pk_bf16_f32 v60, v188, v189
    v_cvt_pk_bf16_f32 v61, v190, v191
    ds_read_b128 v[24:27], v12 offset:448
    ds_read_b128 v[28:31], v12 offset:1024
    s_waitcnt lgkmcnt(2)
    v_pk_fma_f32 v[0:1], v[244:245], v[16:17], v[20:21] op_sel:[1,0,0]
    v_pk_fma_f32 v[2:3], v[244:245], v[18:19], v[22:23] op_sel:[1,0,0]
    v_pk_fma_f32 v[4:5], v[246:247], v[16:17], v[20:21] op_sel:[1,0,0]
    v_pk_fma_f32 v[6:7], v[246:247], v[18:19], v[22:23] op_sel:[1,0,0]
    v_pk_fma_f32 v[192:193], v[244:245], v[192:193], v[0:1] op_sel_hi:[0,1,1]
    v_pk_fma_f32 v[194:195], v[244:245], v[194:195], v[2:3] op_sel_hi:[0,1,1]
    v_pk_fma_f32 v[196:197], v[246:247], v[196:197], v[4:5] op_sel_hi:[0,1,1]
    v_pk_fma_f32 v[198:199], v[246:247], v[198:199], v[6:7] op_sel_hi:[0,1,1]
    v_pk_fma_f32 v[0:1], v[192:193], v[192:193], v[8:9] neg_lo:[1,0,0] neg_hi:[1,0,0]
    v_pk_fma_f32 v[2:3], v[194:195], v[194:195], v[8:9] neg_lo:[1,0,0] neg_hi:[1,0,0]
    v_pk_fma_f32 v[4:5], v[196:197], v[196:197], v[8:9] neg_lo:[1,0,0] neg_hi:[1,0,0]
    v_pk_fma_f32 v[6:7], v[198:199], v[198:199], v[8:9] neg_lo:[1,0,0] neg_hi:[1,0,0]
    v_pk_mul_f32 v[0:1], v[0:1], v[192:193]
    v_pk_mul_f32 v[2:3], v[2:3], v[194:195]
    v_pk_mul_f32 v[4:5], v[4:5], v[196:197]
    v_pk_mul_f32 v[6:7], v[6:7], v[198:199]
    v_exp_f32 v0, v0
    v_exp_f32 v1, v1
    v_exp_f32 v2, v2
    v_exp_f32 v3, v3
    v_exp_f32 v4, v4
    v_exp_f32 v5, v5
    v_exp_f32 v6, v6
    v_exp_f32 v7, v7
    v_pk_add_f32 v[0:1], v[0:1], v[10:11]
    v_pk_add_f32 v[2:3], v[2:3], v[10:11]
    v_pk_add_f32 v[4:5], v[4:5], v[10:11]
    v_pk_add_f32 v[6:7], v[6:7], v[10:11]
    v_rcp_f32 v0, v0
    v_rcp_f32 v1, v1
    v_rcp_f32 v2, v2
    v_rcp_f32 v3, v3
    v_rcp_f32 v4, v4
    v_rcp_f32 v5, v5
    v_rcp_f32 v6, v6
    v_rcp_f32 v7, v7
    v_pk_mul_f32 v[192:193], v[192:193], v[0:1]
    v_pk_mul_f32 v[194:195], v[194:195], v[2:3]
    v_pk_mul_f32 v[196:197], v[196:197], v[4:5]
    v_pk_mul_f32 v[198:199], v[198:199], v[6:7]
    v_cvt_pk_bf16_f32 v44, v192, v193
    v_cvt_pk_bf16_f32 v45, v194, v195
    v_cvt_pk_bf16_f32 v62, v196, v197
    v_cvt_pk_bf16_f32 v63, v198, v199
    ds_read_b128 v[16:19], v12 offset:512
    ds_read_b128 v[20:23], v12 offset:1088
    s_waitcnt lgkmcnt(2)
    v_pk_fma_f32 v[0:1], v[244:245], v[24:25], v[28:29] op_sel:[1,0,0]
    v_pk_fma_f32 v[2:3], v[244:245], v[26:27], v[30:31] op_sel:[1,0,0]
    v_pk_fma_f32 v[4:5], v[246:247], v[24:25], v[28:29] op_sel:[1,0,0]
    v_pk_fma_f32 v[6:7], v[246:247], v[26:27], v[30:31] op_sel:[1,0,0]
    v_pk_fma_f32 v[200:201], v[244:245], v[200:201], v[0:1] op_sel_hi:[0,1,1]
    v_pk_fma_f32 v[202:203], v[244:245], v[202:203], v[2:3] op_sel_hi:[0,1,1]
    v_pk_fma_f32 v[204:205], v[246:247], v[204:205], v[4:5] op_sel_hi:[0,1,1]
    v_pk_fma_f32 v[206:207], v[246:247], v[206:207], v[6:7] op_sel_hi:[0,1,1]
    v_pk_fma_f32 v[0:1], v[200:201], v[200:201], v[8:9] neg_lo:[1,0,0] neg_hi:[1,0,0]
    v_pk_fma_f32 v[2:3], v[202:203], v[202:203], v[8:9] neg_lo:[1,0,0] neg_hi:[1,0,0]
    v_pk_fma_f32 v[4:5], v[204:205], v[204:205], v[8:9] neg_lo:[1,0,0] neg_hi:[1,0,0]
    v_pk_fma_f32 v[6:7], v[206:207], v[206:207], v[8:9] neg_lo:[1,0,0] neg_hi:[1,0,0]
    v_pk_mul_f32 v[0:1], v[0:1], v[200:201]
    v_pk_mul_f32 v[2:3], v[2:3], v[202:203]
    v_pk_mul_f32 v[4:5], v[4:5], v[204:205]
    v_pk_mul_f32 v[6:7], v[6:7], v[206:207]
    v_exp_f32 v0, v0
    v_exp_f32 v1, v1
    v_exp_f32 v2, v2
    v_exp_f32 v3, v3
    v_exp_f32 v4, v4
    v_exp_f32 v5, v5
    v_exp_f32 v6, v6
    v_exp_f32 v7, v7
    v_pk_add_f32 v[0:1], v[0:1], v[10:11]
    v_pk_add_f32 v[2:3], v[2:3], v[10:11]
    v_pk_add_f32 v[4:5], v[4:5], v[10:11]
    v_pk_add_f32 v[6:7], v[6:7], v[10:11]
    v_rcp_f32 v0, v0
    v_rcp_f32 v1, v1
    v_rcp_f32 v2, v2
    v_rcp_f32 v3, v3
    v_rcp_f32 v4, v4
    v_rcp_f32 v5, v5
    v_rcp_f32 v6, v6
    v_rcp_f32 v7, v7
    v_pk_mul_f32 v[200:201], v[200:201], v[0:1]
    v_pk_mul_f32 v[202:203], v[202:203], v[2:3]
    v_pk_mul_f32 v[204:205], v[204:205], v[4:5]
    v_pk_mul_f32 v[206:207], v[206:207], v[6:7]
    v_cvt_pk_bf16_f32 v46, v200, v201
    v_cvt_pk_bf16_f32 v47, v202, v203
    v_cvt_pk_bf16_f32 v64, v204, v205
    v_cvt_pk_bf16_f32 v65, v206, v207
    s_waitcnt lgkmcnt(0)
    v_pk_fma_f32 v[0:1], v[244:245], v[16:17], v[20:21] op_sel:[1,0,0]
    v_pk_fma_f32 v[2:3], v[244:245], v[18:19], v[22:23] op_sel:[1,0,0]
    v_pk_fma_f32 v[4:5], v[246:247], v[16:17], v[20:21] op_sel:[1,0,0]
    v_pk_fma_f32 v[6:7], v[246:247], v[18:19], v[22:23] op_sel:[1,0,0]
    v_pk_fma_f32 v[208:209], v[244:245], v[208:209], v[0:1] op_sel_hi:[0,1,1]
    v_pk_fma_f32 v[210:211], v[244:245], v[210:211], v[2:3] op_sel_hi:[0,1,1]
    v_pk_fma_f32 v[212:213], v[246:247], v[212:213], v[4:5] op_sel_hi:[0,1,1]
    v_pk_fma_f32 v[214:215], v[246:247], v[214:215], v[6:7] op_sel_hi:[0,1,1]
    v_pk_fma_f32 v[0:1], v[208:209], v[208:209], v[8:9] neg_lo:[1,0,0] neg_hi:[1,0,0]
    v_pk_fma_f32 v[2:3], v[210:211], v[210:211], v[8:9] neg_lo:[1,0,0] neg_hi:[1,0,0]
    v_pk_fma_f32 v[4:5], v[212:213], v[212:213], v[8:9] neg_lo:[1,0,0] neg_hi:[1,0,0]
    v_pk_fma_f32 v[6:7], v[214:215], v[214:215], v[8:9] neg_lo:[1,0,0] neg_hi:[1,0,0]
    v_pk_mul_f32 v[0:1], v[0:1], v[208:209]
    v_pk_mul_f32 v[2:3], v[2:3], v[210:211]
    v_pk_mul_f32 v[4:5], v[4:5], v[212:213]
    v_pk_mul_f32 v[6:7], v[6:7], v[214:215]
    v_exp_f32 v0, v0
    v_exp_f32 v1, v1
    v_exp_f32 v2, v2
    v_exp_f32 v3, v3
    v_exp_f32 v4, v4
    v_exp_f32 v5, v5
    v_exp_f32 v6, v6
    v_exp_f32 v7, v7
    v_pk_add_f32 v[0:1], v[0:1], v[10:11]
    v_pk_add_f32 v[2:3], v[2:3], v[10:11]
    v_pk_add_f32 v[4:5], v[4:5], v[10:11]
    v_pk_add_f32 v[6:7], v[6:7], v[10:11]
    v_rcp_f32 v0, v0
    v_rcp_f32 v1, v1
    v_rcp_f32 v2, v2
    v_rcp_f32 v3, v3
    v_rcp_f32 v4, v4
    v_rcp_f32 v5, v5
    v_rcp_f32 v6, v6
    v_rcp_f32 v7, v7
    v_pk_mul_f32 v[208:209], v[208:209], v[0:1]
    v_pk_mul_f32 v[210:211], v[210:211], v[2:3]
    v_pk_mul_f32 v[212:213], v[212:213], v[4:5]
    v_pk_mul_f32 v[214:215], v[214:215], v[6:7]
    v_cvt_pk_bf16_f32 v48, v208, v209
    v_cvt_pk_bf16_f32 v49, v210, v211
    v_cvt_pk_bf16_f32 v66, v212, v213
    v_cvt_pk_bf16_f32 v67, v214, v215
    v_mov_b32 v172, v32
    v_mov_b32 v173, v33
    v_mov_b32 v174, v34
    v_mov_b32 v175, v35
    v_mov_b32 v176, v36
    v_mov_b32 v177, v37
    v_mov_b32 v178, v38
    v_mov_b32 v179, v39
    v_mov_b32 v180, v40
    v_mov_b32 v181, v41
    v_mov_b32 v182, v42
    v_mov_b32 v183, v43
    v_mov_b32 v184, v44
    v_mov_b32 v185, v45
    v_mov_b32 v186, v46
    v_mov_b32 v187, v47
    v_mov_b32 v188, v48
    v_mov_b32 v189, v49
    v_mov_b32 v190, v50
    v_mov_b32 v191, v51
    v_mov_b32 v192, v52
    v_mov_b32 v193, v53
    v_mov_b32 v194, v54
    v_mov_b32 v195, v55
    v_mov_b32 v196, v56
    v_mov_b32 v197, v57
    v_mov_b32 v198, v58
    v_mov_b32 v199, v59
    v_mov_b32 v200, v60
    v_mov_b32 v201, v61
    v_mov_b32 v202, v62
    v_mov_b32 v203, v63
    v_mov_b32 v204, v64
    v_mov_b32 v205, v65
    v_mov_b32 v206, v66
    v_mov_b32 v207, v67
    s_lshl_b32 s40, s12, 3
    s_lshl_b32 s41, s18, 1
    s_add_u32 s40, s40, s41
    s_mul_i32 s40, s40, 73728
    s_lshr_b32 s41, s14, 1
    s_mul_i32 s41, s41, 9
    s_and_b32 s20, s14, 1
    s_lshl_b32 s21, s20, 2
    s_add_u32 s21, s21, s41
    s_lshl_b32 s21, s21, 10
    s_add_u32 s21, s21, s40
    s_add_u32 s22, s41, 8
    s_lshl_b32 s22, s22, 10
    s_lshl_b32 s20, s20, 9
    s_add_u32 s22, s22, s20
    s_add_u32 s22, s22, s40
    s_add_u32 s48, s21, 73728
    s_add_u32 s49, s22, 73728
    s_add_u32 s26, s6, 46137344
    s_addc_u32 s27, s7, 0
    s_mov_b32 s32, s26
    s_and_b32 s33, s27, 0xffff
    s_mov_b32 s34, 9437184
    s_mov_b32 s35, 0x20000
    s_mov_b32 s36, s8
    s_and_b32 s37, s9, 0xffff
    s_mov_b32 s38, 4096
    s_mov_b32 s39, 0x20000
    v_lshlrev_b32 v213, 4, v254
    v_lshlrev_b32 v218, 3, v254
    s_lshl_b32 s25, s12, 7
    s_lshl_b32 s20, s18, 5
    s_add_u32 s25, s25, s20
    s_lshl_b32 s25, s25, 1
    v_and_b32 v214, 15, v254
    v_lshlrev_b32 v215, 1, v214
    buffer_load_ushort v208, v215, s[36:39], s25 offen
    buffer_load_ushort v209, v215, s[36:39], s25 offen offset:32
    v_lshrrev_b32 v216, 4, v254
    v_and_b32 v217, 7, v254
    v_xor_b32 v216, v216, v217
    v_lshlrev_b32 v216, 4, v216
    v_lshlrev_b32 v217, 7, v214
    v_add_u32 v216, v216, v217
    s_lshl_b32 s20, s18, 12
    v_add_u32 v216, s20, v216
    v_add_u32 v160, 0, v216
    v_xor_b32 v161, 64, v160
    v_add_u32 v162, 16384, v213
    v_add_u32 v163, 34816, v216
    v_xor_b32 v164, 64, v163
    v_add_u32 v165, 51200, v213
    v_add_u32 v166, 69632, v216
    v_xor_b32 v167, 64, v166
    v_add_u32 v168, 86016, v213
    v_add_u32 v169, 104448, v216
    v_xor_b32 v170, 64, v169
    v_add_u32 v171, 120832, v213
    v_mov_b32 v0, 0
    v_mov_b32 v1, 0
    v_mov_b32 v2, 0
    v_mov_b32 v3, 0
    v_mov_b32 v4, 0
    v_mov_b32 v5, 0
    v_mov_b32 v6, 0
    v_mov_b32 v7, 0
    v_mov_b32 v8, 0
    v_mov_b32 v9, 0
    v_mov_b32 v10, 0
    v_mov_b32 v11, 0
    v_mov_b32 v12, 0
    v_mov_b32 v13, 0
    v_mov_b32 v14, 0
    v_mov_b32 v15, 0
    v_mov_b32 v16, 0
    v_mov_b32 v17, 0
    v_mov_b32 v18, 0
    v_mov_b32 v19, 0
    v_mov_b32 v20, 0
    v_mov_b32 v21, 0
    v_mov_b32 v22, 0
    v_mov_b32 v23, 0
    v_mov_b32 v24, 0
    v_mov_b32 v25, 0
    v_mov_b32 v26, 0
    v_mov_b32 v27, 0
    v_mov_b32 v28, 0
    v_mov_b32 v29, 0
    v_mov_b32 v30, 0
    v_mov_b32 v31, 0
    v_mov_b32 v32, 0
    v_mov_b32 v33, 0
    v_mov_b32 v34, 0
    v_mov_b32 v35, 0
    v_mov_b32 v36, 0
    v_mov_b32 v37, 0
    v_mov_b32 v38, 0
    v_mov_b32 v39, 0
    v_mov_b32 v40, 0
    v_mov_b32 v41, 0
    v_mov_b32 v42, 0
    v_mov_b32 v43, 0
    v_mov_b32 v44, 0
    v_mov_b32 v45, 0
    v_mov_b32 v46, 0
    v_mov_b32 v47, 0
    v_mov_b32 v48, 0
    v_mov_b32 v49, 0
    v_mov_b32 v50, 0
    v_mov_b32 v51, 0
    v_mov_b32 v52, 0
    v_mov_b32 v53, 0
    v_mov_b32 v54, 0
    v_mov_b32 v55, 0
    v_mov_b32 v56, 0
    v_mov_b32 v57, 0
    v_mov_b32 v58, 0
    v_mov_b32 v59, 0
    v_mov_b32 v60, 0
    v_mov_b32 v61, 0
    v_mov_b32 v62, 0
    v_mov_b32 v63, 0
    v_mov_b32 v64, 0
    v_mov_b32 v65, 0
    v_mov_b32 v66, 0
    v_mov_b32 v67, 0
    v_mov_b32 v68, 0
    v_mov_b32 v69, 0
    v_mov_b32 v70, 0
    v_mov_b32 v71, 0
    s_barrier
    s_barrier
    s_barrier
    ds_read_b128 v[144:147], v166 offset:0
    ds_read_b128 v[148:151], v166 offset:2048
    ds_read_b128 v[72:75], v168 offset:0
    ds_read_b128 v[76:79], v168 offset:1024
    ds_read_b128 v[80:83], v168 offset:2048
    ds_read_b128 v[84:87], v168 offset:3072
    ds_read_b128 v[88:91], v168 offset:4096
    ds_read_b128 v[92:95], v168 offset:5120
    ds_read_b128 v[96:99], v168 offset:6144
    ds_read_b128 v[100:103], v168 offset:7168
    ds_read_b128 v[104:107], v168 offset:8192
    s_mov_b32 s40, 0
back_kernel_cloop:
    s_waitcnt lgkmcnt(6)
    v_mfma_f32_16x16x32_bf16 v[0:3], v[72:75], v[144:147], v[0:3]
    ds_read_b128 v[152:155], v167 offset:0
    v_mfma_f32_16x16x32_bf16 v[4:7], v[72:75], v[148:151], v[4:7]
    ds_read_b128 v[156:159], v167 offset:2048
    v_mfma_f32_16x16x32_bf16 v[8:11], v[76:79], v[144:147], v[8:11]
    ds_read_b128 v[108:111], v168 offset:9216
    v_mfma_f32_16x16x32_bf16 v[12:15], v[76:79], v[148:151], v[12:15]
    v_mfma_f32_16x16x32_bf16 v[16:19], v[80:83], v[144:147], v[16:19]
    ds_read_b128 v[112:115], v168 offset:10240
    v_mfma_f32_16x16x32_bf16 v[20:23], v[80:83], v[148:151], v[20:23]
    ds_read_b128 v[116:119], v168 offset:11264
    s_waitcnt lgkmcnt(8)
    v_mfma_f32_16x16x32_bf16 v[24:27], v[84:87], v[144:147], v[24:27]
    v_mfma_f32_16x16x32_bf16 v[28:31], v[84:87], v[148:151], v[28:31]
    ds_read_b128 v[120:123], v168 offset:12288
    v_mfma_f32_16x16x32_bf16 v[32:35], v[88:91], v[144:147], v[32:35]
    ds_read_b128 v[124:127], v168 offset:13312
    v_mfma_f32_16x16x32_bf16 v[36:39], v[88:91], v[148:151], v[36:39]
    v_mfma_f32_16x16x32_bf16 v[40:43], v[92:95], v[144:147], v[40:43]
    ds_read_b128 v[128:131], v168 offset:14336
    v_mfma_f32_16x16x32_bf16 v[44:47], v[92:95], v[148:151], v[44:47]
    ds_read_b128 v[132:135], v168 offset:15360
    s_waitcnt lgkmcnt(9)
    v_mfma_f32_16x16x32_bf16 v[48:51], v[96:99], v[144:147], v[48:51]
    v_mfma_f32_16x16x32_bf16 v[52:55], v[96:99], v[148:151], v[52:55]
    ds_read_b128 v[136:139], v168 offset:16384
    v_mfma_f32_16x16x32_bf16 v[56:59], v[100:103], v[144:147], v[56:59]
    ds_read_b128 v[140:143], v168 offset:17408
    v_mfma_f32_16x16x32_bf16 v[60:63], v[100:103], v[148:151], v[60:63]
    v_mfma_f32_16x16x32_bf16 v[64:67], v[104:107], v[144:147], v[64:67]
    v_mfma_f32_16x16x32_bf16 v[68:71], v[104:107], v[148:151], v[68:71]
    s_waitcnt lgkmcnt(0)
    s_barrier
    v_mfma_f32_16x16x32_bf16 v[0:3], v[108:111], v[152:155], v[0:3]
    ds_read_b128 v[144:147], v169 offset:0
    v_mfma_f32_16x16x32_bf16 v[4:7], v[108:111], v[156:159], v[4:7]
    ds_read_b128 v[148:151], v169 offset:2048
    v_mfma_f32_16x16x32_bf16 v[8:11], v[112:115], v[152:155], v[8:11]
    ds_read_b128 v[72:75], v171 offset:0
    v_mfma_f32_16x16x32_bf16 v[12:15], v[112:115], v[156:159], v[12:15]
    v_mfma_f32_16x16x32_bf16 v[16:19], v[116:119], v[152:155], v[16:19]
    ds_read_b128 v[76:79], v171 offset:1024
    v_mfma_f32_16x16x32_bf16 v[20:23], v[116:119], v[156:159], v[20:23]
    ds_read_b128 v[80:83], v171 offset:2048
    v_mfma_f32_16x16x32_bf16 v[24:27], v[120:123], v[152:155], v[24:27]
    v_mfma_f32_16x16x32_bf16 v[28:31], v[120:123], v[156:159], v[28:31]
    ds_read_b128 v[84:87], v171 offset:3072
    v_mfma_f32_16x16x32_bf16 v[32:35], v[124:127], v[152:155], v[32:35]
    ds_read_b128 v[88:91], v171 offset:4096
    v_mfma_f32_16x16x32_bf16 v[36:39], v[124:127], v[156:159], v[36:39]
    v_mfma_f32_16x16x32_bf16 v[40:43], v[128:131], v[152:155], v[40:43]
    ds_read_b128 v[92:95], v171 offset:5120
    v_mfma_f32_16x16x32_bf16 v[44:47], v[128:131], v[156:159], v[44:47]
    ds_read_b128 v[96:99], v171 offset:6144
    v_mfma_f32_16x16x32_bf16 v[48:51], v[132:135], v[152:155], v[48:51]
    v_mfma_f32_16x16x32_bf16 v[52:55], v[132:135], v[156:159], v[52:55]
    ds_read_b128 v[100:103], v171 offset:7168
    v_mfma_f32_16x16x32_bf16 v[56:59], v[136:139], v[152:155], v[56:59]
    ds_read_b128 v[104:107], v171 offset:8192
    v_mfma_f32_16x16x32_bf16 v[60:63], v[136:139], v[156:159], v[60:63]
    v_mfma_f32_16x16x32_bf16 v[64:67], v[140:143], v[152:155], v[64:67]
    v_mfma_f32_16x16x32_bf16 v[68:71], v[140:143], v[156:159], v[68:71]
    s_waitcnt lgkmcnt(6)
    v_mfma_f32_16x16x32_bf16 v[0:3], v[72:75], v[144:147], v[0:3]
    ds_read_b128 v[152:155], v170 offset:0
    v_mfma_f32_16x16x32_bf16 v[4:7], v[72:75], v[148:151], v[4:7]
    ds_read_b128 v[156:159], v170 offset:2048
    v_mfma_f32_16x16x32_bf16 v[8:11], v[76:79], v[144:147], v[8:11]
    ds_read_b128 v[108:111], v171 offset:9216
    v_mfma_f32_16x16x32_bf16 v[12:15], v[76:79], v[148:151], v[12:15]
    v_mfma_f32_16x16x32_bf16 v[16:19], v[80:83], v[144:147], v[16:19]
    ds_read_b128 v[112:115], v171 offset:10240
    v_mfma_f32_16x16x32_bf16 v[20:23], v[80:83], v[148:151], v[20:23]
    ds_read_b128 v[116:119], v171 offset:11264
    s_waitcnt lgkmcnt(8)
    v_mfma_f32_16x16x32_bf16 v[24:27], v[84:87], v[144:147], v[24:27]
    v_mfma_f32_16x16x32_bf16 v[28:31], v[84:87], v[148:151], v[28:31]
    ds_read_b128 v[120:123], v171 offset:12288
    v_mfma_f32_16x16x32_bf16 v[32:35], v[88:91], v[144:147], v[32:35]
    ds_read_b128 v[124:127], v171 offset:13312
    v_mfma_f32_16x16x32_bf16 v[36:39], v[88:91], v[148:151], v[36:39]
    v_mfma_f32_16x16x32_bf16 v[40:43], v[92:95], v[144:147], v[40:43]
    ds_read_b128 v[128:131], v171 offset:14336
    v_mfma_f32_16x16x32_bf16 v[44:47], v[92:95], v[148:151], v[44:47]
    ds_read_b128 v[132:135], v171 offset:15360
    s_waitcnt lgkmcnt(9)
    v_mfma_f32_16x16x32_bf16 v[48:51], v[96:99], v[144:147], v[48:51]
    v_mfma_f32_16x16x32_bf16 v[52:55], v[96:99], v[148:151], v[52:55]
    ds_read_b128 v[136:139], v171 offset:16384
    v_mfma_f32_16x16x32_bf16 v[56:59], v[100:103], v[144:147], v[56:59]
    ds_read_b128 v[140:143], v171 offset:17408
    v_mfma_f32_16x16x32_bf16 v[60:63], v[100:103], v[148:151], v[60:63]
    v_mfma_f32_16x16x32_bf16 v[64:67], v[104:107], v[144:147], v[64:67]
    v_mfma_f32_16x16x32_bf16 v[68:71], v[104:107], v[148:151], v[68:71]
    s_waitcnt lgkmcnt(0)
    s_barrier
    v_mfma_f32_16x16x32_bf16 v[0:3], v[108:111], v[152:155], v[0:3]
    ds_read_b128 v[144:147], v160 offset:0
    v_mfma_f32_16x16x32_bf16 v[4:7], v[108:111], v[156:159], v[4:7]
    ds_read_b128 v[148:151], v160 offset:2048
    v_mfma_f32_16x16x32_bf16 v[8:11], v[112:115], v[152:155], v[8:11]
    ds_read_b128 v[72:75], v162 offset:0
    v_mfma_f32_16x16x32_bf16 v[12:15], v[112:115], v[156:159], v[12:15]
    v_mfma_f32_16x16x32_bf16 v[16:19], v[116:119], v[152:155], v[16:19]
    ds_read_b128 v[76:79], v162 offset:1024
    v_mfma_f32_16x16x32_bf16 v[20:23], v[116:119], v[156:159], v[20:23]
    ds_read_b128 v[80:83], v162 offset:2048
    v_mfma_f32_16x16x32_bf16 v[24:27], v[120:123], v[152:155], v[24:27]
    v_mfma_f32_16x16x32_bf16 v[28:31], v[120:123], v[156:159], v[28:31]
    ds_read_b128 v[84:87], v162 offset:3072
    v_mfma_f32_16x16x32_bf16 v[32:35], v[124:127], v[152:155], v[32:35]
    ds_read_b128 v[88:91], v162 offset:4096
    v_mfma_f32_16x16x32_bf16 v[36:39], v[124:127], v[156:159], v[36:39]
    v_mfma_f32_16x16x32_bf16 v[40:43], v[128:131], v[152:155], v[40:43]
    ds_read_b128 v[92:95], v162 offset:5120
    v_mfma_f32_16x16x32_bf16 v[44:47], v[128:131], v[156:159], v[44:47]
    ds_read_b128 v[96:99], v162 offset:6144
    v_mfma_f32_16x16x32_bf16 v[48:51], v[132:135], v[152:155], v[48:51]
    v_mfma_f32_16x16x32_bf16 v[52:55], v[132:135], v[156:159], v[52:55]
    ds_read_b128 v[100:103], v162 offset:7168
    v_mfma_f32_16x16x32_bf16 v[56:59], v[136:139], v[152:155], v[56:59]
    ds_read_b128 v[104:107], v162 offset:8192
    v_mfma_f32_16x16x32_bf16 v[60:63], v[136:139], v[156:159], v[60:63]
    v_mfma_f32_16x16x32_bf16 v[64:67], v[140:143], v[152:155], v[64:67]
    v_mfma_f32_16x16x32_bf16 v[68:71], v[140:143], v[156:159], v[68:71]
    s_waitcnt lgkmcnt(6)
    v_mfma_f32_16x16x32_bf16 v[0:3], v[72:75], v[144:147], v[0:3]
    ds_read_b128 v[152:155], v161 offset:0
    v_mfma_f32_16x16x32_bf16 v[4:7], v[72:75], v[148:151], v[4:7]
    ds_read_b128 v[156:159], v161 offset:2048
    v_mfma_f32_16x16x32_bf16 v[8:11], v[76:79], v[144:147], v[8:11]
    ds_read_b128 v[108:111], v162 offset:9216
    v_mfma_f32_16x16x32_bf16 v[12:15], v[76:79], v[148:151], v[12:15]
    v_mfma_f32_16x16x32_bf16 v[16:19], v[80:83], v[144:147], v[16:19]
    ds_read_b128 v[112:115], v162 offset:10240
    v_mfma_f32_16x16x32_bf16 v[20:23], v[80:83], v[148:151], v[20:23]
    ds_read_b128 v[116:119], v162 offset:11264
    s_waitcnt lgkmcnt(8)
    v_mfma_f32_16x16x32_bf16 v[24:27], v[84:87], v[144:147], v[24:27]
    v_mfma_f32_16x16x32_bf16 v[28:31], v[84:87], v[148:151], v[28:31]
    ds_read_b128 v[120:123], v162 offset:12288
    v_mfma_f32_16x16x32_bf16 v[32:35], v[88:91], v[144:147], v[32:35]
    ds_read_b128 v[124:127], v162 offset:13312
    v_mfma_f32_16x16x32_bf16 v[36:39], v[88:91], v[148:151], v[36:39]
    v_mfma_f32_16x16x32_bf16 v[40:43], v[92:95], v[144:147], v[40:43]
    ds_read_b128 v[128:131], v162 offset:14336
    v_mfma_f32_16x16x32_bf16 v[44:47], v[92:95], v[148:151], v[44:47]
    ds_read_b128 v[132:135], v162 offset:15360
    s_waitcnt lgkmcnt(9)
    v_mfma_f32_16x16x32_bf16 v[48:51], v[96:99], v[144:147], v[48:51]
    v_mfma_f32_16x16x32_bf16 v[52:55], v[96:99], v[148:151], v[52:55]
    ds_read_b128 v[136:139], v162 offset:16384
    v_mfma_f32_16x16x32_bf16 v[56:59], v[100:103], v[144:147], v[56:59]
    ds_read_b128 v[140:143], v162 offset:17408
    v_mfma_f32_16x16x32_bf16 v[60:63], v[100:103], v[148:151], v[60:63]
    v_mfma_f32_16x16x32_bf16 v[64:67], v[104:107], v[144:147], v[64:67]
    v_mfma_f32_16x16x32_bf16 v[68:71], v[104:107], v[148:151], v[68:71]
    s_waitcnt lgkmcnt(0)
    s_barrier
    v_mfma_f32_16x16x32_bf16 v[0:3], v[108:111], v[152:155], v[0:3]
    ds_read_b128 v[144:147], v163 offset:0
    v_mfma_f32_16x16x32_bf16 v[4:7], v[108:111], v[156:159], v[4:7]
    ds_read_b128 v[148:151], v163 offset:2048
    v_mfma_f32_16x16x32_bf16 v[8:11], v[112:115], v[152:155], v[8:11]
    ds_read_b128 v[72:75], v165 offset:0
    v_mfma_f32_16x16x32_bf16 v[12:15], v[112:115], v[156:159], v[12:15]
    v_mfma_f32_16x16x32_bf16 v[16:19], v[116:119], v[152:155], v[16:19]
    ds_read_b128 v[76:79], v165 offset:1024
    v_mfma_f32_16x16x32_bf16 v[20:23], v[116:119], v[156:159], v[20:23]
    ds_read_b128 v[80:83], v165 offset:2048
    v_mfma_f32_16x16x32_bf16 v[24:27], v[120:123], v[152:155], v[24:27]
    v_mfma_f32_16x16x32_bf16 v[28:31], v[120:123], v[156:159], v[28:31]
    ds_read_b128 v[84:87], v165 offset:3072
    v_mfma_f32_16x16x32_bf16 v[32:35], v[124:127], v[152:155], v[32:35]
    ds_read_b128 v[88:91], v165 offset:4096
    v_mfma_f32_16x16x32_bf16 v[36:39], v[124:127], v[156:159], v[36:39]
    v_mfma_f32_16x16x32_bf16 v[40:43], v[128:131], v[152:155], v[40:43]
    ds_read_b128 v[92:95], v165 offset:5120
    v_mfma_f32_16x16x32_bf16 v[44:47], v[128:131], v[156:159], v[44:47]
    ds_read_b128 v[96:99], v165 offset:6144
    v_mfma_f32_16x16x32_bf16 v[48:51], v[132:135], v[152:155], v[48:51]
    v_mfma_f32_16x16x32_bf16 v[52:55], v[132:135], v[156:159], v[52:55]
    ds_read_b128 v[100:103], v165 offset:7168
    v_mfma_f32_16x16x32_bf16 v[56:59], v[136:139], v[152:155], v[56:59]
    ds_read_b128 v[104:107], v165 offset:8192
    v_mfma_f32_16x16x32_bf16 v[60:63], v[136:139], v[156:159], v[60:63]
    v_mfma_f32_16x16x32_bf16 v[64:67], v[140:143], v[152:155], v[64:67]
    v_mfma_f32_16x16x32_bf16 v[68:71], v[140:143], v[156:159], v[68:71]
    s_waitcnt lgkmcnt(6)
    v_mfma_f32_16x16x32_bf16 v[0:3], v[72:75], v[144:147], v[0:3]
    ds_read_b128 v[152:155], v164 offset:0
    v_mfma_f32_16x16x32_bf16 v[4:7], v[72:75], v[148:151], v[4:7]
    ds_read_b128 v[156:159], v164 offset:2048
    v_mfma_f32_16x16x32_bf16 v[8:11], v[76:79], v[144:147], v[8:11]
    ds_read_b128 v[108:111], v165 offset:9216
    v_mfma_f32_16x16x32_bf16 v[12:15], v[76:79], v[148:151], v[12:15]
    v_mfma_f32_16x16x32_bf16 v[16:19], v[80:83], v[144:147], v[16:19]
    ds_read_b128 v[112:115], v165 offset:10240
    v_mfma_f32_16x16x32_bf16 v[20:23], v[80:83], v[148:151], v[20:23]
    ds_read_b128 v[116:119], v165 offset:11264
    s_waitcnt lgkmcnt(8)
    v_mfma_f32_16x16x32_bf16 v[24:27], v[84:87], v[144:147], v[24:27]
    v_mfma_f32_16x16x32_bf16 v[28:31], v[84:87], v[148:151], v[28:31]
    ds_read_b128 v[120:123], v165 offset:12288
    v_mfma_f32_16x16x32_bf16 v[32:35], v[88:91], v[144:147], v[32:35]
    ds_read_b128 v[124:127], v165 offset:13312
    v_mfma_f32_16x16x32_bf16 v[36:39], v[88:91], v[148:151], v[36:39]
    v_mfma_f32_16x16x32_bf16 v[40:43], v[92:95], v[144:147], v[40:43]
    ds_read_b128 v[128:131], v165 offset:14336
    v_mfma_f32_16x16x32_bf16 v[44:47], v[92:95], v[148:151], v[44:47]
    ds_read_b128 v[132:135], v165 offset:15360
    s_waitcnt lgkmcnt(9)
    v_mfma_f32_16x16x32_bf16 v[48:51], v[96:99], v[144:147], v[48:51]
    v_mfma_f32_16x16x32_bf16 v[52:55], v[96:99], v[148:151], v[52:55]
    ds_read_b128 v[136:139], v165 offset:16384
    v_mfma_f32_16x16x32_bf16 v[56:59], v[100:103], v[144:147], v[56:59]
    ds_read_b128 v[140:143], v165 offset:17408
    v_mfma_f32_16x16x32_bf16 v[60:63], v[100:103], v[148:151], v[60:63]
    v_mfma_f32_16x16x32_bf16 v[64:67], v[104:107], v[144:147], v[64:67]
    v_mfma_f32_16x16x32_bf16 v[68:71], v[104:107], v[148:151], v[68:71]
    s_waitcnt lgkmcnt(0)
    s_barrier
    v_mfma_f32_16x16x32_bf16 v[0:3], v[108:111], v[152:155], v[0:3]
    ds_read_b128 v[144:147], v166 offset:0
    v_mfma_f32_16x16x32_bf16 v[4:7], v[108:111], v[156:159], v[4:7]
    ds_read_b128 v[148:151], v166 offset:2048
    v_mfma_f32_16x16x32_bf16 v[8:11], v[112:115], v[152:155], v[8:11]
    ds_read_b128 v[72:75], v168 offset:0
    v_mfma_f32_16x16x32_bf16 v[12:15], v[112:115], v[156:159], v[12:15]
    v_mfma_f32_16x16x32_bf16 v[16:19], v[116:119], v[152:155], v[16:19]
    ds_read_b128 v[76:79], v168 offset:1024
    v_mfma_f32_16x16x32_bf16 v[20:23], v[116:119], v[156:159], v[20:23]
    ds_read_b128 v[80:83], v168 offset:2048
    v_mfma_f32_16x16x32_bf16 v[24:27], v[120:123], v[152:155], v[24:27]
    v_mfma_f32_16x16x32_bf16 v[28:31], v[120:123], v[156:159], v[28:31]
    ds_read_b128 v[84:87], v168 offset:3072
    v_mfma_f32_16x16x32_bf16 v[32:35], v[124:127], v[152:155], v[32:35]
    ds_read_b128 v[88:91], v168 offset:4096
    v_mfma_f32_16x16x32_bf16 v[36:39], v[124:127], v[156:159], v[36:39]
    v_mfma_f32_16x16x32_bf16 v[40:43], v[128:131], v[152:155], v[40:43]
    ds_read_b128 v[92:95], v168 offset:5120
    v_mfma_f32_16x16x32_bf16 v[44:47], v[128:131], v[156:159], v[44:47]
    ds_read_b128 v[96:99], v168 offset:6144
    v_mfma_f32_16x16x32_bf16 v[48:51], v[132:135], v[152:155], v[48:51]
    v_mfma_f32_16x16x32_bf16 v[52:55], v[132:135], v[156:159], v[52:55]
    ds_read_b128 v[100:103], v168 offset:7168
    v_mfma_f32_16x16x32_bf16 v[56:59], v[136:139], v[152:155], v[56:59]
    ds_read_b128 v[104:107], v168 offset:8192
    v_mfma_f32_16x16x32_bf16 v[60:63], v[136:139], v[156:159], v[60:63]
    v_mfma_f32_16x16x32_bf16 v[64:67], v[140:143], v[152:155], v[64:67]
    v_mfma_f32_16x16x32_bf16 v[68:71], v[140:143], v[156:159], v[68:71]
    s_add_u32 s40, s40, 1
    s_cmp_lt_u32 s40, 8
    s_cbranch_scc1 back_kernel_cloop
    s_waitcnt lgkmcnt(0) vmcnt(0)
    v_lshlrev_b32 v208, 16, v208
    v_lshlrev_b32 v209, 16, v209
    s_nop 7
    v_lshlrev_b32 v104, 16, v172
    v_and_b32 v105, 0xffff0000, v172
    v_lshlrev_b32 v106, 16, v173
    v_and_b32 v107, 0xffff0000, v173
    v_pk_add_f32 v[0:1], v[0:1], v[208:209] op_sel_hi:[1,0]
    v_pk_add_f32 v[2:3], v[2:3], v[208:209] op_sel_hi:[1,0]
    v_pk_mul_f32 v[0:1], v[0:1], v[104:105]
    v_pk_mul_f32 v[2:3], v[2:3], v[106:107]
    v_cvt_pk_bf16_f32 v72, v0, v1
    v_cvt_pk_bf16_f32 v73, v2, v3
    v_lshlrev_b32 v104, 16, v174
    v_and_b32 v105, 0xffff0000, v174
    v_lshlrev_b32 v106, 16, v175
    v_and_b32 v107, 0xffff0000, v175
    v_pk_add_f32 v[8:9], v[8:9], v[208:209] op_sel_hi:[1,0]
    v_pk_add_f32 v[10:11], v[10:11], v[208:209] op_sel_hi:[1,0]
    v_pk_mul_f32 v[8:9], v[8:9], v[104:105]
    v_pk_mul_f32 v[10:11], v[10:11], v[106:107]
    v_cvt_pk_bf16_f32 v74, v8, v9
    v_cvt_pk_bf16_f32 v75, v10, v11
    buffer_store_dwordx4 v[72:75], v213, s[32:35], s21 offen offset:0 sc1
    v_lshlrev_b32 v104, 16, v176
    v_and_b32 v105, 0xffff0000, v176
    v_lshlrev_b32 v106, 16, v177
    v_and_b32 v107, 0xffff0000, v177
    v_pk_add_f32 v[16:17], v[16:17], v[208:209] op_sel_hi:[1,0]
    v_pk_add_f32 v[18:19], v[18:19], v[208:209] op_sel_hi:[1,0]
    v_pk_mul_f32 v[16:17], v[16:17], v[104:105]
    v_pk_mul_f32 v[18:19], v[18:19], v[106:107]
    v_cvt_pk_bf16_f32 v76, v16, v17
    v_cvt_pk_bf16_f32 v77, v18, v19
    v_lshlrev_b32 v104, 16, v178
    v_and_b32 v105, 0xffff0000, v178
    v_lshlrev_b32 v106, 16, v179
    v_and_b32 v107, 0xffff0000, v179
    v_pk_add_f32 v[24:25], v[24:25], v[208:209] op_sel_hi:[1,0]
    v_pk_add_f32 v[26:27], v[26:27], v[208:209] op_sel_hi:[1,0]
    v_pk_mul_f32 v[24:25], v[24:25], v[104:105]
    v_pk_mul_f32 v[26:27], v[26:27], v[106:107]
    v_cvt_pk_bf16_f32 v78, v24, v25
    v_cvt_pk_bf16_f32 v79, v26, v27
    buffer_store_dwordx4 v[76:79], v213, s[32:35], s21 offen offset:1024 sc1
    v_lshlrev_b32 v104, 16, v180
    v_and_b32 v105, 0xffff0000, v180
    v_lshlrev_b32 v106, 16, v181
    v_and_b32 v107, 0xffff0000, v181
    v_pk_add_f32 v[32:33], v[32:33], v[208:209] op_sel_hi:[1,0]
    v_pk_add_f32 v[34:35], v[34:35], v[208:209] op_sel_hi:[1,0]
    v_pk_mul_f32 v[32:33], v[32:33], v[104:105]
    v_pk_mul_f32 v[34:35], v[34:35], v[106:107]
    v_cvt_pk_bf16_f32 v80, v32, v33
    v_cvt_pk_bf16_f32 v81, v34, v35
    v_lshlrev_b32 v104, 16, v182
    v_and_b32 v105, 0xffff0000, v182
    v_lshlrev_b32 v106, 16, v183
    v_and_b32 v107, 0xffff0000, v183
    v_pk_add_f32 v[40:41], v[40:41], v[208:209] op_sel_hi:[1,0]
    v_pk_add_f32 v[42:43], v[42:43], v[208:209] op_sel_hi:[1,0]
    v_pk_mul_f32 v[40:41], v[40:41], v[104:105]
    v_pk_mul_f32 v[42:43], v[42:43], v[106:107]
    v_cvt_pk_bf16_f32 v82, v40, v41
    v_cvt_pk_bf16_f32 v83, v42, v43
    buffer_store_dwordx4 v[80:83], v213, s[32:35], s21 offen offset:2048 sc1
    v_lshlrev_b32 v104, 16, v184
    v_and_b32 v105, 0xffff0000, v184
    v_lshlrev_b32 v106, 16, v185
    v_and_b32 v107, 0xffff0000, v185
    v_pk_add_f32 v[48:49], v[48:49], v[208:209] op_sel_hi:[1,0]
    v_pk_add_f32 v[50:51], v[50:51], v[208:209] op_sel_hi:[1,0]
    v_pk_mul_f32 v[48:49], v[48:49], v[104:105]
    v_pk_mul_f32 v[50:51], v[50:51], v[106:107]
    v_cvt_pk_bf16_f32 v84, v48, v49
    v_cvt_pk_bf16_f32 v85, v50, v51
    v_lshlrev_b32 v104, 16, v186
    v_and_b32 v105, 0xffff0000, v186
    v_lshlrev_b32 v106, 16, v187
    v_and_b32 v107, 0xffff0000, v187
    v_pk_add_f32 v[56:57], v[56:57], v[208:209] op_sel_hi:[1,0]
    v_pk_add_f32 v[58:59], v[58:59], v[208:209] op_sel_hi:[1,0]
    v_pk_mul_f32 v[56:57], v[56:57], v[104:105]
    v_pk_mul_f32 v[58:59], v[58:59], v[106:107]
    v_cvt_pk_bf16_f32 v86, v56, v57
    v_cvt_pk_bf16_f32 v87, v58, v59
    buffer_store_dwordx4 v[84:87], v213, s[32:35], s21 offen offset:3072 sc1
    v_lshlrev_b32 v104, 16, v188
    v_and_b32 v105, 0xffff0000, v188
    v_lshlrev_b32 v106, 16, v189
    v_and_b32 v107, 0xffff0000, v189
    v_pk_add_f32 v[64:65], v[64:65], v[208:209] op_sel_hi:[1,0]
    v_pk_add_f32 v[66:67], v[66:67], v[208:209] op_sel_hi:[1,0]
    v_pk_mul_f32 v[64:65], v[64:65], v[104:105]
    v_pk_mul_f32 v[66:67], v[66:67], v[106:107]
    v_cvt_pk_bf16_f32 v88, v64, v65
    v_cvt_pk_bf16_f32 v89, v66, v67
    buffer_store_dwordx2 v[88:89], v218, s[32:35], s22 offen sc1
    v_lshlrev_b32 v104, 16, v190
    v_and_b32 v105, 0xffff0000, v190
    v_lshlrev_b32 v106, 16, v191
    v_and_b32 v107, 0xffff0000, v191
    v_pk_add_f32 v[4:5], v[4:5], v[208:209] op_sel:[0,1]
    v_pk_add_f32 v[6:7], v[6:7], v[208:209] op_sel:[0,1]
    v_pk_mul_f32 v[4:5], v[4:5], v[104:105]
    v_pk_mul_f32 v[6:7], v[6:7], v[106:107]
    v_cvt_pk_bf16_f32 v92, v4, v5
    v_cvt_pk_bf16_f32 v93, v6, v7
    v_lshlrev_b32 v104, 16, v192
    v_and_b32 v105, 0xffff0000, v192
    v_lshlrev_b32 v106, 16, v193
    v_and_b32 v107, 0xffff0000, v193
    v_pk_add_f32 v[12:13], v[12:13], v[208:209] op_sel:[0,1]
    v_pk_add_f32 v[14:15], v[14:15], v[208:209] op_sel:[0,1]
    v_pk_mul_f32 v[12:13], v[12:13], v[104:105]
    v_pk_mul_f32 v[14:15], v[14:15], v[106:107]
    v_cvt_pk_bf16_f32 v94, v12, v13
    v_cvt_pk_bf16_f32 v95, v14, v15
    buffer_store_dwordx4 v[92:95], v213, s[32:35], s48 offen offset:0 sc1
    v_lshlrev_b32 v104, 16, v194
    v_and_b32 v105, 0xffff0000, v194
    v_lshlrev_b32 v106, 16, v195
    v_and_b32 v107, 0xffff0000, v195
    v_pk_add_f32 v[20:21], v[20:21], v[208:209] op_sel:[0,1]
    v_pk_add_f32 v[22:23], v[22:23], v[208:209] op_sel:[0,1]
    v_pk_mul_f32 v[20:21], v[20:21], v[104:105]
    v_pk_mul_f32 v[22:23], v[22:23], v[106:107]
    v_cvt_pk_bf16_f32 v96, v20, v21
    v_cvt_pk_bf16_f32 v97, v22, v23
    v_lshlrev_b32 v104, 16, v196
    v_and_b32 v105, 0xffff0000, v196
    v_lshlrev_b32 v106, 16, v197
    v_and_b32 v107, 0xffff0000, v197
    v_pk_add_f32 v[28:29], v[28:29], v[208:209] op_sel:[0,1]
    v_pk_add_f32 v[30:31], v[30:31], v[208:209] op_sel:[0,1]
    v_pk_mul_f32 v[28:29], v[28:29], v[104:105]
    v_pk_mul_f32 v[30:31], v[30:31], v[106:107]
    v_cvt_pk_bf16_f32 v98, v28, v29
    v_cvt_pk_bf16_f32 v99, v30, v31
    buffer_store_dwordx4 v[96:99], v213, s[32:35], s48 offen offset:1024 sc1
    v_lshlrev_b32 v104, 16, v198
    v_and_b32 v105, 0xffff0000, v198
    v_lshlrev_b32 v106, 16, v199
    v_and_b32 v107, 0xffff0000, v199
    v_pk_add_f32 v[36:37], v[36:37], v[208:209] op_sel:[0,1]
    v_pk_add_f32 v[38:39], v[38:39], v[208:209] op_sel:[0,1]
    v_pk_mul_f32 v[36:37], v[36:37], v[104:105]
    v_pk_mul_f32 v[38:39], v[38:39], v[106:107]
    v_cvt_pk_bf16_f32 v100, v36, v37
    v_cvt_pk_bf16_f32 v101, v38, v39
    v_lshlrev_b32 v104, 16, v200
    v_and_b32 v105, 0xffff0000, v200
    v_lshlrev_b32 v106, 16, v201
    v_and_b32 v107, 0xffff0000, v201
    v_pk_add_f32 v[44:45], v[44:45], v[208:209] op_sel:[0,1]
    v_pk_add_f32 v[46:47], v[46:47], v[208:209] op_sel:[0,1]
    v_pk_mul_f32 v[44:45], v[44:45], v[104:105]
    v_pk_mul_f32 v[46:47], v[46:47], v[106:107]
    v_cvt_pk_bf16_f32 v102, v44, v45
    v_cvt_pk_bf16_f32 v103, v46, v47
    buffer_store_dwordx4 v[100:103], v213, s[32:35], s48 offen offset:2048 sc1
    v_lshlrev_b32 v104, 16, v202
    v_and_b32 v105, 0xffff0000, v202
    v_lshlrev_b32 v106, 16, v203
    v_and_b32 v107, 0xffff0000, v203
    v_pk_add_f32 v[52:53], v[52:53], v[208:209] op_sel:[0,1]
    v_pk_add_f32 v[54:55], v[54:55], v[208:209] op_sel:[0,1]
    v_pk_mul_f32 v[52:53], v[52:53], v[104:105]
    v_pk_mul_f32 v[54:55], v[54:55], v[106:107]
    v_cvt_pk_bf16_f32 v72, v52, v53
    v_cvt_pk_bf16_f32 v73, v54, v55
    v_lshlrev_b32 v104, 16, v204
    v_and_b32 v105, 0xffff0000, v204
    v_lshlrev_b32 v106, 16, v205
    v_and_b32 v107, 0xffff0000, v205
    v_pk_add_f32 v[60:61], v[60:61], v[208:209] op_sel:[0,1]
    v_pk_add_f32 v[62:63], v[62:63], v[208:209] op_sel:[0,1]
    v_pk_mul_f32 v[60:61], v[60:61], v[104:105]
    v_pk_mul_f32 v[62:63], v[62:63], v[106:107]
    v_cvt_pk_bf16_f32 v74, v60, v61
    v_cvt_pk_bf16_f32 v75, v62, v63
    buffer_store_dwordx4 v[72:75], v213, s[32:35], s48 offen offset:3072 sc1
    v_lshlrev_b32 v104, 16, v206
    v_and_b32 v105, 0xffff0000, v206
    v_lshlrev_b32 v106, 16, v207
    v_and_b32 v107, 0xffff0000, v207
    v_pk_add_f32 v[68:69], v[68:69], v[208:209] op_sel:[0,1]
    v_pk_add_f32 v[70:71], v[70:71], v[208:209] op_sel:[0,1]
    v_pk_mul_f32 v[68:69], v[68:69], v[104:105]
    v_pk_mul_f32 v[70:71], v[70:71], v[106:107]
    v_cvt_pk_bf16_f32 v76, v68, v69
    v_cvt_pk_bf16_f32 v77, v70, v71
    buffer_store_dwordx2 v[76:77], v218, s[32:35], s49 offen sc1
    s_waitcnt vmcnt(0)
    s_barrier
    s_cmp_eq_u32 s18, 0
    s_cbranch_scc0 back_kernel_fin
    s_lshl_b32 s42, s12, 6
    s_add_u32 s42, s42, 1024
    s_lshl_b32 s43, s14, 2
    s_add_u32 s43, s43, s42
    v_mov_b32 v3, s43
    v_mov_b32 v4, 1
    s_mov_b64 s[44:45], exec
    s_mov_b64 exec, 1
    global_store_dword v3, v4, s[58:59] sc1
    s_mov_b64 exec, s[44:45]
    s_barrier
    v_and_b32 v3, 15, v254
    v_lshlrev_b32 v3, 2, v3
    v_add_u32 v3, s42, v3
    s_mov_b32 s46, 0
back_kernel_p2:
    v_mov_b32 v5, 0
    s_mov_b64 s[44:45], exec
    s_mov_b64 exec, 0xffff
    global_atomic_add v4, v3, v5, s[58:59] sc0 sc1
    s_mov_b64 exec, s[44:45]
    s_waitcnt vmcnt(0)
    s_nop 0
    v_cmp_eq_u32 vcc, 0, v4
    s_and_b64 vcc, vcc, 0xffff
    s_nop 1
    s_cmp_eq_u64 vcc, 0
    s_cbranch_scc1 back_kernel_p2_ok
    s_add_u32 s46, s46, 1
    s_cmp_lt_u32 s46, 0x40000
    s_cbranch_scc0 back_kernel_p2_ok
    s_sleep 4
    s_branch back_kernel_p2
back_kernel_p2_ok:
    s_barrier
    s_branch back_kernel_fin
back_kernel_g0:
    v_lshrrev_b32 v3, 4, v254
    v_bfe_u32 v4, v254, 2, 2
    v_and_b32 v5, 3, v254
    v_and_b32 v6, 1, v3
    v_lshlrev_b32 v6, 2, v6
    v_or_b32 v6, v6, v4
    v_lshlrev_b32 v3, 3, v3
    v_add_u32 v3, v3, v4
    v_lshlrev_b32 v3, 8, v3
    v_lshlrev_b32 v5, 3, v5
    v_add_u32 v3, v3, v5
    s_lshl_b32 s20, s18, 1
    s_add_u32 s21, s20, 0
    v_xor_b32 v7, s21, v6
    v_lshlrev_b32 v7, 5, v7
    v_add_u32 v7, v7, v3
    v_add_u32 v160, 0, v7
    v_add_u32 v163, 34816, v7
    v_add_u32 v166, 69632, v7
    v_add_u32 v169, 104448, v7
    s_add_u32 s21, s20, 1
    v_xor_b32 v7, s21, v6
    v_lshlrev_b32 v7, 5, v7
    v_add_u32 v7, v7, v3
    v_add_u32 v161, 0, v7
    v_add_u32 v164, 34816, v7
    v_add_u32 v167, 69632, v7
    v_add_u32 v170, 104448, v7
    v_lshlrev_b32 v8, 4, v254
    v_add_u32 v162, 16384, v8
    v_add_u32 v165, 51200, v8
    v_add_u32 v168, 86016, v8
    v_add_u32 v171, 120832, v8
    v_mov_b32 v0, 0
    v_mov_b32 v1, 0
    v_mov_b32 v2, 0
    v_mov_b32 v3, 0
    v_mov_b32 v4, 0
    v_mov_b32 v5, 0
    v_mov_b32 v6, 0
    v_mov_b32 v7, 0
    v_mov_b32 v8, 0
    v_mov_b32 v9, 0
    v_mov_b32 v10, 0
    v_mov_b32 v11, 0
    v_mov_b32 v12, 0
    v_mov_b32 v13, 0
    v_mov_b32 v14, 0
    v_mov_b32 v15, 0
    v_mov_b32 v16, 0
    v_mov_b32 v17, 0
    v_mov_b32 v18, 0
    v_mov_b32 v19, 0
    v_mov_b32 v20, 0
    v_mov_b32 v21, 0
    v_mov_b32 v22, 0
    v_mov_b32 v23, 0
    v_mov_b32 v24, 0
    v_mov_b32 v25, 0
    v_mov_b32 v26, 0
    v_mov_b32 v27, 0
    v_mov_b32 v28, 0
    v_mov_b32 v29, 0
    v_mov_b32 v30, 0
    v_mov_b32 v31, 0
    v_mov_b32 v32, 0
    v_mov_b32 v33, 0
    v_mov_b32 v34, 0
    v_mov_b32 v35, 0
    v_mov_b32 v36, 0
    v_mov_b32 v37, 0
    v_mov_b32 v38, 0
    v_mov_b32 v39, 0
    v_mov_b32 v40, 0
    v_mov_b32 v41, 0
    v_mov_b32 v42, 0
    v_mov_b32 v43, 0
    v_mov_b32 v44, 0
    v_mov_b32 v45, 0
    v_mov_b32 v46, 0
    v_mov_b32 v47, 0
    v_mov_b32 v48, 0
    v_mov_b32 v49, 0
    v_mov_b32 v50, 0
    v_mov_b32 v51, 0
    v_mov_b32 v52, 0
    v_mov_b32 v53, 0
    v_mov_b32 v54, 0
    v_mov_b32 v55, 0
    v_mov_b32 v56, 0
    v_mov_b32 v57, 0
    v_mov_b32 v58, 0
    v_mov_b32 v59, 0
    v_mov_b32 v60, 0
    v_mov_b32 v61, 0
    v_mov_b32 v62, 0
    v_mov_b32 v63, 0
    v_mov_b32 v64, 0
    v_mov_b32 v65, 0
    v_mov_b32 v66, 0
    v_mov_b32 v67, 0
    v_mov_b32 v68, 0
    v_mov_b32 v69, 0
    v_mov_b32 v70, 0
    v_mov_b32 v71, 0
    v_lshrrev_b32 v3, 3, v254
    v_and_b32 v4, 7, v254
    v_xor_b32 v4, v4, v3
    v_lshlrev_b32 v4, 4, v4
    v_lshlrev_b32 v3, 12, v3
    v_add_u32 v3, v3, v4
    s_lshl_b32 s20, s18, 17
    v_add_u32 v246, s20, v3
    v_add_u32 v247, 31744, v246
    v_add_u32 v248, 63488, v246
    v_add_u32 v249, 95232, v246
    s_lshl_b32 s20, s12, 19
    s_add_u32 s4, s4, s20
    s_addc_u32 s5, s5, 0
    s_mov_b32 s28, s4
    s_and_b32 s29, s5, 0xffff
    s_mov_b32 s30, 524288
    s_mov_b32 s31, 0x20000
    s_barrier
    ds_read_b64_tr_b16 v[144:145], v160 offset:0
    ds_read_b64_tr_b16 v[146:147], v160 offset:1024
    ds_read_b64_tr_b16 v[148:149], v161 offset:0
    ds_read_b64_tr_b16 v[150:151], v161 offset:1024
    ds_read_b128 v[72:75], v162 offset:0
    ds_read_b128 v[76:79], v162 offset:1024
    ds_read_b128 v[80:83], v162 offset:2048
    ds_read_b128 v[84:87], v162 offset:3072
    ds_read_b128 v[88:91], v162 offset:4096
    ds_read_b128 v[92:95], v162 offset:5120
    ds_read_b128 v[96:99], v162 offset:6144
    ds_read_b128 v[100:103], v162 offset:7168
    ds_read_b128 v[104:107], v162 offset:8192
    s_waitcnt lgkmcnt(6)
    v_mfma_f32_16x16x32_bf16 v[0:3], v[144:147], v[72:75], v[0:3]
    ds_read_b64_tr_b16 v[152:153], v160 offset:8192
    v_mfma_f32_16x16x32_bf16 v[4:7], v[148:151], v[72:75], v[4:7]
    ds_read_b64_tr_b16 v[154:155], v160 offset:9216
    v_mfma_f32_16x16x32_bf16 v[8:11], v[144:147], v[76:79], v[8:11]
    ds_read_b64_tr_b16 v[156:157], v161 offset:8192
    v_mfma_f32_16x16x32_bf16 v[12:15], v[148:151], v[76:79], v[12:15]
    ds_read_b64_tr_b16 v[158:159], v161 offset:9216
    v_mfma_f32_16x16x32_bf16 v[16:19], v[144:147], v[80:83], v[16:19]
    ds_read_b128 v[108:111], v162 offset:9216
    v_mfma_f32_16x16x32_bf16 v[20:23], v[148:151], v[80:83], v[20:23]
    ds_read_b128 v[112:115], v162 offset:10240
    s_waitcnt lgkmcnt(9)
    v_mfma_f32_16x16x32_bf16 v[24:27], v[144:147], v[84:87], v[24:27]
    ds_read_b128 v[116:119], v162 offset:11264
    v_mfma_f32_16x16x32_bf16 v[28:31], v[148:151], v[84:87], v[28:31]
    v_mfma_f32_16x16x32_bf16 v[32:35], v[144:147], v[88:91], v[32:35]
    ds_read_b128 v[120:123], v162 offset:12288
    v_mfma_f32_16x16x32_bf16 v[36:39], v[148:151], v[88:91], v[36:39]
    ds_read_b128 v[124:127], v162 offset:13312
    v_mfma_f32_16x16x32_bf16 v[40:43], v[144:147], v[92:95], v[40:43]
    ds_read_b128 v[128:131], v162 offset:14336
    v_mfma_f32_16x16x32_bf16 v[44:47], v[148:151], v[92:95], v[44:47]
    ds_read_b128 v[132:135], v162 offset:15360
    s_waitcnt lgkmcnt(11)
    v_mfma_f32_16x16x32_bf16 v[48:51], v[144:147], v[96:99], v[48:51]
    ds_read_b128 v[136:139], v162 offset:16384
    v_mfma_f32_16x16x32_bf16 v[52:55], v[148:151], v[96:99], v[52:55]
    ds_read_b128 v[140:143], v162 offset:17408
    v_mfma_f32_16x16x32_bf16 v[56:59], v[144:147], v[100:103], v[56:59]
    v_mfma_f32_16x16x32_bf16 v[60:63], v[148:151], v[100:103], v[60:63]
    v_mfma_f32_16x16x32_bf16 v[64:67], v[144:147], v[104:107], v[64:67]
    v_mfma_f32_16x16x32_bf16 v[68:71], v[148:151], v[104:107], v[68:71]
    s_waitcnt lgkmcnt(0)
    s_barrier
    v_mfma_f32_16x16x32_bf16 v[0:3], v[152:155], v[108:111], v[0:3]
    ds_read_b64_tr_b16 v[144:145], v163 offset:0
    v_mfma_f32_16x16x32_bf16 v[4:7], v[156:159], v[108:111], v[4:7]
    ds_read_b64_tr_b16 v[146:147], v163 offset:1024
    v_mfma_f32_16x16x32_bf16 v[8:11], v[152:155], v[112:115], v[8:11]
    ds_read_b64_tr_b16 v[148:149], v164 offset:0
    v_mfma_f32_16x16x32_bf16 v[12:15], v[156:159], v[112:115], v[12:15]
    ds_read_b64_tr_b16 v[150:151], v164 offset:1024
    v_mfma_f32_16x16x32_bf16 v[16:19], v[152:155], v[116:119], v[16:19]
    ds_read_b128 v[72:75], v165 offset:0
    v_mfma_f32_16x16x32_bf16 v[20:23], v[156:159], v[116:119], v[20:23]
    ds_read_b128 v[76:79], v165 offset:1024
    v_mfma_f32_16x16x32_bf16 v[24:27], v[152:155], v[120:123], v[24:27]
    ds_read_b128 v[80:83], v165 offset:2048
    v_mfma_f32_16x16x32_bf16 v[28:31], v[156:159], v[120:123], v[28:31]
    v_mfma_f32_16x16x32_bf16 v[32:35], v[152:155], v[124:127], v[32:35]
    ds_read_b128 v[84:87], v165 offset:3072
    v_mfma_f32_16x16x32_bf16 v[36:39], v[156:159], v[124:127], v[36:39]
    ds_read_b128 v[88:91], v165 offset:4096
    v_mfma_f32_16x16x32_bf16 v[40:43], v[152:155], v[128:131], v[40:43]
    ds_read_b128 v[92:95], v165 offset:5120
    v_mfma_f32_16x16x32_bf16 v[44:47], v[156:159], v[128:131], v[44:47]
    ds_read_b128 v[96:99], v165 offset:6144
    v_mfma_f32_16x16x32_bf16 v[48:51], v[152:155], v[132:135], v[48:51]
    ds_read_b128 v[100:103], v165 offset:7168
    v_mfma_f32_16x16x32_bf16 v[52:55], v[156:159], v[132:135], v[52:55]
    ds_read_b128 v[104:107], v165 offset:8192
    v_mfma_f32_16x16x32_bf16 v[56:59], v[152:155], v[136:139], v[56:59]
    v_mfma_f32_16x16x32_bf16 v[60:63], v[156:159], v[136:139], v[60:63]
    v_mfma_f32_16x16x32_bf16 v[64:67], v[152:155], v[140:143], v[64:67]
    v_mfma_f32_16x16x32_bf16 v[68:71], v[156:159], v[140:143], v[68:71]
    s_waitcnt lgkmcnt(6)
    v_mfma_f32_16x16x32_bf16 v[0:3], v[144:147], v[72:75], v[0:3]
    ds_read_b64_tr_b16 v[152:153], v163 offset:8192
    v_mfma_f32_16x16x32_bf16 v[4:7], v[148:151], v[72:75], v[4:7]
    ds_read_b64_tr_b16 v[154:155], v163 offset:9216
    v_mfma_f32_16x16x32_bf16 v[8:11], v[144:147], v[76:79], v[8:11]
    ds_read_b64_tr_b16 v[156:157], v164 offset:8192
    v_mfma_f32_16x16x32_bf16 v[12:15], v[148:151], v[76:79], v[12:15]
    ds_read_b64_tr_b16 v[158:159], v164 offset:9216
    v_mfma_f32_16x16x32_bf16 v[16:19], v[144:147], v[80:83], v[16:19]
    ds_read_b128 v[108:111], v165 offset:9216
    v_mfma_f32_16x16x32_bf16 v[20:23], v[148:151], v[80:83], v[20:23]
    ds_read_b128 v[112:115], v165 offset:10240
    s_waitcnt lgkmcnt(9)
    v_mfma_f32_16x16x32_bf16 v[24:27], v[144:147], v[84:87], v[24:27]
    ds_read_b128 v[116:119], v165 offset:11264
    v_mfma_f32_16x16x32_bf16 v[28:31], v[148:151], v[84:87], v[28:31]
    v_mfma_f32_16x16x32_bf16 v[32:35], v[144:147], v[88:91], v[32:35]
    ds_read_b128 v[120:123], v165 offset:12288
    v_mfma_f32_16x16x32_bf16 v[36:39], v[148:151], v[88:91], v[36:39]
    ds_read_b128 v[124:127], v165 offset:13312
    v_mfma_f32_16x16x32_bf16 v[40:43], v[144:147], v[92:95], v[40:43]
    ds_read_b128 v[128:131], v165 offset:14336
    v_mfma_f32_16x16x32_bf16 v[44:47], v[148:151], v[92:95], v[44:47]
    ds_read_b128 v[132:135], v165 offset:15360
    s_waitcnt lgkmcnt(11)
    v_mfma_f32_16x16x32_bf16 v[48:51], v[144:147], v[96:99], v[48:51]
    ds_read_b128 v[136:139], v165 offset:16384
    v_mfma_f32_16x16x32_bf16 v[52:55], v[148:151], v[96:99], v[52:55]
    ds_read_b128 v[140:143], v165 offset:17408
    v_mfma_f32_16x16x32_bf16 v[56:59], v[144:147], v[100:103], v[56:59]
    v_mfma_f32_16x16x32_bf16 v[60:63], v[148:151], v[100:103], v[60:63]
    v_mfma_f32_16x16x32_bf16 v[64:67], v[144:147], v[104:107], v[64:67]
    v_mfma_f32_16x16x32_bf16 v[68:71], v[148:151], v[104:107], v[68:71]
    s_waitcnt lgkmcnt(0)
    s_barrier
    v_mfma_f32_16x16x32_bf16 v[0:3], v[152:155], v[108:111], v[0:3]
    ds_read_b64_tr_b16 v[144:145], v166 offset:0
    v_mfma_f32_16x16x32_bf16 v[4:7], v[156:159], v[108:111], v[4:7]
    ds_read_b64_tr_b16 v[146:147], v166 offset:1024
    v_mfma_f32_16x16x32_bf16 v[8:11], v[152:155], v[112:115], v[8:11]
    ds_read_b64_tr_b16 v[148:149], v167 offset:0
    v_mfma_f32_16x16x32_bf16 v[12:15], v[156:159], v[112:115], v[12:15]
    ds_read_b64_tr_b16 v[150:151], v167 offset:1024
    v_mfma_f32_16x16x32_bf16 v[16:19], v[152:155], v[116:119], v[16:19]
    ds_read_b128 v[72:75], v168 offset:0
    v_mfma_f32_16x16x32_bf16 v[20:23], v[156:159], v[116:119], v[20:23]
    ds_read_b128 v[76:79], v168 offset:1024
    v_mfma_f32_16x16x32_bf16 v[24:27], v[152:155], v[120:123], v[24:27]
    ds_read_b128 v[80:83], v168 offset:2048
    v_mfma_f32_16x16x32_bf16 v[28:31], v[156:159], v[120:123], v[28:31]
    v_mfma_f32_16x16x32_bf16 v[32:35], v[152:155], v[124:127], v[32:35]
    ds_read_b128 v[84:87], v168 offset:3072
    v_mfma_f32_16x16x32_bf16 v[36:39], v[156:159], v[124:127], v[36:39]
    ds_read_b128 v[88:91], v168 offset:4096
    v_mfma_f32_16x16x32_bf16 v[40:43], v[152:155], v[128:131], v[40:43]
    ds_read_b128 v[92:95], v168 offset:5120
    v_mfma_f32_16x16x32_bf16 v[44:47], v[156:159], v[128:131], v[44:47]
    ds_read_b128 v[96:99], v168 offset:6144
    v_mfma_f32_16x16x32_bf16 v[48:51], v[152:155], v[132:135], v[48:51]
    ds_read_b128 v[100:103], v168 offset:7168
    v_mfma_f32_16x16x32_bf16 v[52:55], v[156:159], v[132:135], v[52:55]
    ds_read_b128 v[104:107], v168 offset:8192
    v_mfma_f32_16x16x32_bf16 v[56:59], v[152:155], v[136:139], v[56:59]
    v_mfma_f32_16x16x32_bf16 v[60:63], v[156:159], v[136:139], v[60:63]
    v_mfma_f32_16x16x32_bf16 v[64:67], v[152:155], v[140:143], v[64:67]
    v_mfma_f32_16x16x32_bf16 v[68:71], v[156:159], v[140:143], v[68:71]
    s_waitcnt lgkmcnt(6)
    v_mfma_f32_16x16x32_bf16 v[0:3], v[144:147], v[72:75], v[0:3]
    ds_read_b64_tr_b16 v[152:153], v166 offset:8192
    v_mfma_f32_16x16x32_bf16 v[4:7], v[148:151], v[72:75], v[4:7]
    ds_read_b64_tr_b16 v[154:155], v166 offset:9216
    v_mfma_f32_16x16x32_bf16 v[8:11], v[144:147], v[76:79], v[8:11]
    ds_read_b64_tr_b16 v[156:157], v167 offset:8192
    v_mfma_f32_16x16x32_bf16 v[12:15], v[148:151], v[76:79], v[12:15]
    ds_read_b64_tr_b16 v[158:159], v167 offset:9216
    v_mfma_f32_16x16x32_bf16 v[16:19], v[144:147], v[80:83], v[16:19]
    ds_read_b128 v[108:111], v168 offset:9216
    v_mfma_f32_16x16x32_bf16 v[20:23], v[148:151], v[80:83], v[20:23]
    ds_read_b128 v[112:115], v168 offset:10240
    s_waitcnt lgkmcnt(9)
    v_mfma_f32_16x16x32_bf16 v[24:27], v[144:147], v[84:87], v[24:27]
    ds_read_b128 v[116:119], v168 offset:11264
    v_mfma_f32_16x16x32_bf16 v[28:31], v[148:151], v[84:87], v[28:31]
    v_mfma_f32_16x16x32_bf16 v[32:35], v[144:147], v[88:91], v[32:35]
    ds_read_b128 v[120:123], v168 offset:12288
    v_mfma_f32_16x16x32_bf16 v[36:39], v[148:151], v[88:91], v[36:39]
    ds_read_b128 v[124:127], v168 offset:13312
    v_mfma_f32_16x16x32_bf16 v[40:43], v[144:147], v[92:95], v[40:43]
    ds_read_b128 v[128:131], v168 offset:14336
    v_mfma_f32_16x16x32_bf16 v[44:47], v[148:151], v[92:95], v[44:47]
    ds_read_b128 v[132:135], v168 offset:15360
    s_waitcnt lgkmcnt(11)
    v_mfma_f32_16x16x32_bf16 v[48:51], v[144:147], v[96:99], v[48:51]
    ds_read_b128 v[136:139], v168 offset:16384
    v_mfma_f32_16x16x32_bf16 v[52:55], v[148:151], v[96:99], v[52:55]
    ds_read_b128 v[140:143], v168 offset:17408
    v_mfma_f32_16x16x32_bf16 v[56:59], v[144:147], v[100:103], v[56:59]
    v_mfma_f32_16x16x32_bf16 v[60:63], v[148:151], v[100:103], v[60:63]
    v_mfma_f32_16x16x32_bf16 v[64:67], v[144:147], v[104:107], v[64:67]
    v_mfma_f32_16x16x32_bf16 v[68:71], v[148:151], v[104:107], v[68:71]
    s_waitcnt lgkmcnt(0)
    s_barrier
    v_mfma_f32_16x16x32_bf16 v[0:3], v[152:155], v[108:111], v[0:3]
    ds_read_b64_tr_b16 v[144:145], v169 offset:0
    v_mfma_f32_16x16x32_bf16 v[4:7], v[156:159], v[108:111], v[4:7]
    ds_read_b64_tr_b16 v[146:147], v169 offset:1024
    v_mfma_f32_16x16x32_bf16 v[8:11], v[152:155], v[112:115], v[8:11]
    ds_read_b64_tr_b16 v[148:149], v170 offset:0
    v_mfma_f32_16x16x32_bf16 v[12:15], v[156:159], v[112:115], v[12:15]
    ds_read_b64_tr_b16 v[150:151], v170 offset:1024
    v_mfma_f32_16x16x32_bf16 v[16:19], v[152:155], v[116:119], v[16:19]
    ds_read_b128 v[72:75], v171 offset:0
    v_mfma_f32_16x16x32_bf16 v[20:23], v[156:159], v[116:119], v[20:23]
    ds_read_b128 v[76:79], v171 offset:1024
    v_mfma_f32_16x16x32_bf16 v[24:27], v[152:155], v[120:123], v[24:27]
    ds_read_b128 v[80:83], v171 offset:2048
    v_mfma_f32_16x16x32_bf16 v[28:31], v[156:159], v[120:123], v[28:31]
    v_mfma_f32_16x16x32_bf16 v[32:35], v[152:155], v[124:127], v[32:35]
    ds_read_b128 v[84:87], v171 offset:3072
    v_mfma_f32_16x16x32_bf16 v[36:39], v[156:159], v[124:127], v[36:39]
    ds_read_b128 v[88:91], v171 offset:4096
    v_mfma_f32_16x16x32_bf16 v[40:43], v[152:155], v[128:131], v[40:43]
    ds_read_b128 v[92:95], v171 offset:5120
    v_mfma_f32_16x16x32_bf16 v[44:47], v[156:159], v[128:131], v[44:47]
    ds_read_b128 v[96:99], v171 offset:6144
    v_mfma_f32_16x16x32_bf16 v[48:51], v[152:155], v[132:135], v[48:51]
    ds_read_b128 v[100:103], v171 offset:7168
    v_mfma_f32_16x16x32_bf16 v[52:55], v[156:159], v[132:135], v[52:55]
    ds_read_b128 v[104:107], v171 offset:8192
    v_mfma_f32_16x16x32_bf16 v[56:59], v[152:155], v[136:139], v[56:59]
    v_mfma_f32_16x16x32_bf16 v[60:63], v[156:159], v[136:139], v[60:63]
    v_mfma_f32_16x16x32_bf16 v[64:67], v[152:155], v[140:143], v[64:67]
    v_mfma_f32_16x16x32_bf16 v[68:71], v[156:159], v[140:143], v[68:71]
    s_waitcnt lgkmcnt(6)
    v_mfma_f32_16x16x32_bf16 v[0:3], v[144:147], v[72:75], v[0:3]
    ds_read_b64_tr_b16 v[152:153], v169 offset:8192
    v_mfma_f32_16x16x32_bf16 v[4:7], v[148:151], v[72:75], v[4:7]
    ds_read_b64_tr_b16 v[154:155], v169 offset:9216
    v_mfma_f32_16x16x32_bf16 v[8:11], v[144:147], v[76:79], v[8:11]
    ds_read_b64_tr_b16 v[156:157], v170 offset:8192
    v_mfma_f32_16x16x32_bf16 v[12:15], v[148:151], v[76:79], v[12:15]
    ds_read_b64_tr_b16 v[158:159], v170 offset:9216
    v_mfma_f32_16x16x32_bf16 v[16:19], v[144:147], v[80:83], v[16:19]
    ds_read_b128 v[108:111], v171 offset:9216
    v_mfma_f32_16x16x32_bf16 v[20:23], v[148:151], v[80:83], v[20:23]
    ds_read_b128 v[112:115], v171 offset:10240
    s_waitcnt lgkmcnt(9)
    v_mfma_f32_16x16x32_bf16 v[24:27], v[144:147], v[84:87], v[24:27]
    ds_read_b128 v[116:119], v171 offset:11264
    v_mfma_f32_16x16x32_bf16 v[28:31], v[148:151], v[84:87], v[28:31]
    v_mfma_f32_16x16x32_bf16 v[32:35], v[144:147], v[88:91], v[32:35]
    ds_read_b128 v[120:123], v171 offset:12288
    v_mfma_f32_16x16x32_bf16 v[36:39], v[148:151], v[88:91], v[36:39]
    ds_read_b128 v[124:127], v171 offset:13312
    v_mfma_f32_16x16x32_bf16 v[40:43], v[144:147], v[92:95], v[40:43]
    ds_read_b128 v[128:131], v171 offset:14336
    v_mfma_f32_16x16x32_bf16 v[44:47], v[148:151], v[92:95], v[44:47]
    ds_read_b128 v[132:135], v171 offset:15360
    s_waitcnt lgkmcnt(11)
    v_mfma_f32_16x16x32_bf16 v[48:51], v[144:147], v[96:99], v[48:51]
    ds_read_b128 v[136:139], v171 offset:16384
    v_mfma_f32_16x16x32_bf16 v[52:55], v[148:151], v[96:99], v[52:55]
    ds_read_b128 v[140:143], v171 offset:17408
    v_mfma_f32_16x16x32_bf16 v[56:59], v[144:147], v[100:103], v[56:59]
    v_mfma_f32_16x16x32_bf16 v[60:63], v[148:151], v[100:103], v[60:63]
    v_mfma_f32_16x16x32_bf16 v[64:67], v[144:147], v[104:107], v[64:67]
    v_mfma_f32_16x16x32_bf16 v[68:71], v[148:151], v[104:107], v[68:71]
    s_waitcnt lgkmcnt(0)
    s_barrier
    v_mfma_f32_16x16x32_bf16 v[0:3], v[152:155], v[108:111], v[0:3]
    ds_read_b64_tr_b16 v[144:145], v160 offset:0
    v_mfma_f32_16x16x32_bf16 v[4:7], v[156:159], v[108:111], v[4:7]
    ds_read_b64_tr_b16 v[146:147], v160 offset:1024
    v_mfma_f32_16x16x32_bf16 v[8:11], v[152:155], v[112:115], v[8:11]
    ds_read_b64_tr_b16 v[148:149], v161 offset:0
    v_mfma_f32_16x16x32_bf16 v[12:15], v[156:159], v[112:115], v[12:15]
    ds_read_b64_tr_b16 v[150:151], v161 offset:1024
    v_mfma_f32_16x16x32_bf16 v[16:19], v[152:155], v[116:119], v[16:19]
    ds_read_b128 v[72:75], v162 offset:0
    v_mfma_f32_16x16x32_bf16 v[20:23], v[156:159], v[116:119], v[20:23]
    ds_read_b128 v[76:79], v162 offset:1024
    v_mfma_f32_16x16x32_bf16 v[24:27], v[152:155], v[120:123], v[24:27]
    ds_read_b128 v[80:83], v162 offset:2048
    v_mfma_f32_16x16x32_bf16 v[28:31], v[156:159], v[120:123], v[28:31]
    v_mfma_f32_16x16x32_bf16 v[32:35], v[152:155], v[124:127], v[32:35]
    ds_read_b128 v[84:87], v162 offset:3072
    v_mfma_f32_16x16x32_bf16 v[36:39], v[156:159], v[124:127], v[36:39]
    ds_read_b128 v[88:91], v162 offset:4096
    v_mfma_f32_16x16x32_bf16 v[40:43], v[152:155], v[128:131], v[40:43]
    ds_read_b128 v[92:95], v162 offset:5120
    v_mfma_f32_16x16x32_bf16 v[44:47], v[156:159], v[128:131], v[44:47]
    ds_read_b128 v[96:99], v162 offset:6144
    v_mfma_f32_16x16x32_bf16 v[48:51], v[152:155], v[132:135], v[48:51]
    ds_read_b128 v[100:103], v162 offset:7168
    v_mfma_f32_16x16x32_bf16 v[52:55], v[156:159], v[132:135], v[52:55]
    ds_read_b128 v[104:107], v162 offset:8192
    v_mfma_f32_16x16x32_bf16 v[56:59], v[152:155], v[136:139], v[56:59]
    v_mfma_f32_16x16x32_bf16 v[60:63], v[156:159], v[136:139], v[60:63]
    v_mfma_f32_16x16x32_bf16 v[64:67], v[152:155], v[140:143], v[64:67]
    v_mfma_f32_16x16x32_bf16 v[68:71], v[156:159], v[140:143], v[68:71]
    s_waitcnt lgkmcnt(6)
    v_mfma_f32_16x16x32_bf16 v[0:3], v[144:147], v[72:75], v[0:3]
    ds_read_b64_tr_b16 v[152:153], v160 offset:8192
    v_mfma_f32_16x16x32_bf16 v[4:7], v[148:151], v[72:75], v[4:7]
    ds_read_b64_tr_b16 v[154:155], v160 offset:9216
    v_mfma_f32_16x16x32_bf16 v[8:11], v[144:147], v[76:79], v[8:11]
    ds_read_b64_tr_b16 v[156:157], v161 offset:8192
    v_mfma_f32_16x16x32_bf16 v[12:15], v[148:151], v[76:79], v[12:15]
    ds_read_b64_tr_b16 v[158:159], v161 offset:9216
    v_mfma_f32_16x16x32_bf16 v[16:19], v[144:147], v[80:83], v[16:19]
    ds_read_b128 v[108:111], v162 offset:9216
    v_mfma_f32_16x16x32_bf16 v[20:23], v[148:151], v[80:83], v[20:23]
    ds_read_b128 v[112:115], v162 offset:10240
    s_waitcnt lgkmcnt(9)
    v_mfma_f32_16x16x32_bf16 v[24:27], v[144:147], v[84:87], v[24:27]
    ds_read_b128 v[116:119], v162 offset:11264
    v_mfma_f32_16x16x32_bf16 v[28:31], v[148:151], v[84:87], v[28:31]
    v_mfma_f32_16x16x32_bf16 v[32:35], v[144:147], v[88:91], v[32:35]
    ds_read_b128 v[120:123], v162 offset:12288
    v_mfma_f32_16x16x32_bf16 v[36:39], v[148:151], v[88:91], v[36:39]
    ds_read_b128 v[124:127], v162 offset:13312
    v_mfma_f32_16x16x32_bf16 v[40:43], v[144:147], v[92:95], v[40:43]
    ds_read_b128 v[128:131], v162 offset:14336
    v_mfma_f32_16x16x32_bf16 v[44:47], v[148:151], v[92:95], v[44:47]
    ds_read_b128 v[132:135], v162 offset:15360
    s_waitcnt lgkmcnt(11)
    v_mfma_f32_16x16x32_bf16 v[48:51], v[144:147], v[96:99], v[48:51]
    ds_read_b128 v[136:139], v162 offset:16384
    v_mfma_f32_16x16x32_bf16 v[52:55], v[148:151], v[96:99], v[52:55]
    ds_read_b128 v[140:143], v162 offset:17408
    v_mfma_f32_16x16x32_bf16 v[56:59], v[144:147], v[100:103], v[56:59]
    v_mfma_f32_16x16x32_bf16 v[60:63], v[148:151], v[100:103], v[60:63]
    v_mfma_f32_16x16x32_bf16 v[64:67], v[144:147], v[104:107], v[64:67]
    v_mfma_f32_16x16x32_bf16 v[68:71], v[148:151], v[104:107], v[68:71]
    s_waitcnt lgkmcnt(0)
    s_barrier
    s_cmp_eq_u32 s18, 0
    s_cbranch_scc0 back_kernel_npf4
    s_lshl_b32 s42, s14, 15
    s_lshl_b32 s43, s18, 13
    s_add_u32 s42, s42, s43
    v_lshlrev_b32 v208, 7, v254
    buffer_load_dword v209, v208, s[28:31], s42 offen
back_kernel_npf4:
    v_mfma_f32_16x16x32_bf16 v[0:3], v[152:155], v[108:111], v[0:3]
    ds_read_b64_tr_b16 v[144:145], v163 offset:0
    v_mfma_f32_16x16x32_bf16 v[4:7], v[156:159], v[108:111], v[4:7]
    ds_read_b64_tr_b16 v[146:147], v163 offset:1024
    v_mfma_f32_16x16x32_bf16 v[8:11], v[152:155], v[112:115], v[8:11]
    ds_read_b64_tr_b16 v[148:149], v164 offset:0
    v_mfma_f32_16x16x32_bf16 v[12:15], v[156:159], v[112:115], v[12:15]
    ds_read_b64_tr_b16 v[150:151], v164 offset:1024
    v_mfma_f32_16x16x32_bf16 v[16:19], v[152:155], v[116:119], v[16:19]
    ds_read_b128 v[72:75], v165 offset:0
    v_mfma_f32_16x16x32_bf16 v[20:23], v[156:159], v[116:119], v[20:23]
    ds_read_b128 v[76:79], v165 offset:1024
    v_mfma_f32_16x16x32_bf16 v[24:27], v[152:155], v[120:123], v[24:27]
    ds_read_b128 v[80:83], v165 offset:2048
    v_mfma_f32_16x16x32_bf16 v[28:31], v[156:159], v[120:123], v[28:31]
    v_mfma_f32_16x16x32_bf16 v[32:35], v[152:155], v[124:127], v[32:35]
    ds_read_b128 v[84:87], v165 offset:3072
    v_mfma_f32_16x16x32_bf16 v[36:39], v[156:159], v[124:127], v[36:39]
    ds_read_b128 v[88:91], v165 offset:4096
    v_mfma_f32_16x16x32_bf16 v[40:43], v[152:155], v[128:131], v[40:43]
    ds_read_b128 v[92:95], v165 offset:5120
    v_mfma_f32_16x16x32_bf16 v[44:47], v[156:159], v[128:131], v[44:47]
    ds_read_b128 v[96:99], v165 offset:6144
    v_mfma_f32_16x16x32_bf16 v[48:51], v[152:155], v[132:135], v[48:51]
    ds_read_b128 v[100:103], v165 offset:7168
    v_mfma_f32_16x16x32_bf16 v[52:55], v[156:159], v[132:135], v[52:55]
    ds_read_b128 v[104:107], v165 offset:8192
    v_mfma_f32_16x16x32_bf16 v[56:59], v[152:155], v[136:139], v[56:59]
    v_mfma_f32_16x16x32_bf16 v[60:63], v[156:159], v[136:139], v[60:63]
    v_mfma_f32_16x16x32_bf16 v[64:67], v[152:155], v[140:143], v[64:67]
    v_mfma_f32_16x16x32_bf16 v[68:71], v[156:159], v[140:143], v[68:71]
    s_waitcnt lgkmcnt(6)
    v_mfma_f32_16x16x32_bf16 v[0:3], v[144:147], v[72:75], v[0:3]
    ds_read_b64_tr_b16 v[152:153], v163 offset:8192
    v_mfma_f32_16x16x32_bf16 v[4:7], v[148:151], v[72:75], v[4:7]
    ds_read_b64_tr_b16 v[154:155], v163 offset:9216
    v_mfma_f32_16x16x32_bf16 v[8:11], v[144:147], v[76:79], v[8:11]
    ds_read_b64_tr_b16 v[156:157], v164 offset:8192
    v_mfma_f32_16x16x32_bf16 v[12:15], v[148:151], v[76:79], v[12:15]
    ds_read_b64_tr_b16 v[158:159], v164 offset:9216
    v_mfma_f32_16x16x32_bf16 v[16:19], v[144:147], v[80:83], v[16:19]
    ds_read_b128 v[108:111], v165 offset:9216
    v_mfma_f32_16x16x32_bf16 v[20:23], v[148:151], v[80:83], v[20:23]
    ds_read_b128 v[112:115], v165 offset:10240
    s_waitcnt lgkmcnt(9)
    v_mfma_f32_16x16x32_bf16 v[24:27], v[144:147], v[84:87], v[24:27]
    ds_read_b128 v[116:119], v165 offset:11264
    v_mfma_f32_16x16x32_bf16 v[28:31], v[148:151], v[84:87], v[28:31]
    v_mfma_f32_16x16x32_bf16 v[32:35], v[144:147], v[88:91], v[32:35]
    ds_read_b128 v[120:123], v165 offset:12288
    v_mfma_f32_16x16x32_bf16 v[36:39], v[148:151], v[88:91], v[36:39]
    ds_read_b128 v[124:127], v165 offset:13312
    v_mfma_f32_16x16x32_bf16 v[40:43], v[144:147], v[92:95], v[40:43]
    ds_read_b128 v[128:131], v165 offset:14336
    v_mfma_f32_16x16x32_bf16 v[44:47], v[148:151], v[92:95], v[44:47]
    ds_read_b128 v[132:135], v165 offset:15360
    s_waitcnt lgkmcnt(11)
    v_mfma_f32_16x16x32_bf16 v[48:51], v[144:147], v[96:99], v[48:51]
    ds_read_b128 v[136:139], v165 offset:16384
    v_mfma_f32_16x16x32_bf16 v[52:55], v[148:151], v[96:99], v[52:55]
    ds_read_b128 v[140:143], v165 offset:17408
    v_mfma_f32_16x16x32_bf16 v[56:59], v[144:147], v[100:103], v[56:59]
    v_mfma_f32_16x16x32_bf16 v[60:63], v[148:151], v[100:103], v[60:63]
    v_mfma_f32_16x16x32_bf16 v[64:67], v[144:147], v[104:107], v[64:67]
    v_mfma_f32_16x16x32_bf16 v[68:71], v[148:151], v[104:107], v[68:71]
    s_waitcnt lgkmcnt(0)
    s_barrier
    s_cmp_eq_u32 s18, 1
    s_cbranch_scc0 back_kernel_npf5
    s_lshl_b32 s42, s14, 15
    s_lshl_b32 s43, s18, 13
    s_add_u32 s42, s42, s43
    v_lshlrev_b32 v208, 7, v254
    buffer_load_dword v209, v208, s[28:31], s42 offen
back_kernel_npf5:
    v_mfma_f32_16x16x32_bf16 v[0:3], v[152:155], v[108:111], v[0:3]
    ds_read_b64_tr_b16 v[144:145], v166 offset:0
    v_mfma_f32_16x16x32_bf16 v[4:7], v[156:159], v[108:111], v[4:7]
    ds_read_b64_tr_b16 v[146:147], v166 offset:1024
    v_mfma_f32_16x16x32_bf16 v[8:11], v[152:155], v[112:115], v[8:11]
    ds_read_b64_tr_b16 v[148:149], v167 offset:0
    v_mfma_f32_16x16x32_bf16 v[12:15], v[156:159], v[112:115], v[12:15]
    ds_read_b64_tr_b16 v[150:151], v167 offset:1024
    v_mfma_f32_16x16x32_bf16 v[16:19], v[152:155], v[116:119], v[16:19]
    ds_read_b128 v[72:75], v168 offset:0
    v_mfma_f32_16x16x32_bf16 v[20:23], v[156:159], v[116:119], v[20:23]
    ds_read_b128 v[76:79], v168 offset:1024
    v_mfma_f32_16x16x32_bf16 v[24:27], v[152:155], v[120:123], v[24:27]
    ds_read_b128 v[80:83], v168 offset:2048
    v_mfma_f32_16x16x32_bf16 v[28:31], v[156:159], v[120:123], v[28:31]
    v_mfma_f32_16x16x32_bf16 v[32:35], v[152:155], v[124:127], v[32:35]
    ds_read_b128 v[84:87], v168 offset:3072
    v_mfma_f32_16x16x32_bf16 v[36:39], v[156:159], v[124:127], v[36:39]
    ds_read_b128 v[88:91], v168 offset:4096
    v_mfma_f32_16x16x32_bf16 v[40:43], v[152:155], v[128:131], v[40:43]
    ds_read_b128 v[92:95], v168 offset:5120
    v_mfma_f32_16x16x32_bf16 v[44:47], v[156:159], v[128:131], v[44:47]
    ds_read_b128 v[96:99], v168 offset:6144
    v_mfma_f32_16x16x32_bf16 v[48:51], v[152:155], v[132:135], v[48:51]
    ds_read_b128 v[100:103], v168 offset:7168
    v_mfma_f32_16x16x32_bf16 v[52:55], v[156:159], v[132:135], v[52:55]
    ds_read_b128 v[104:107], v168 offset:8192
    v_mfma_f32_16x16x32_bf16 v[56:59], v[152:155], v[136:139], v[56:59]
    v_mfma_f32_16x16x32_bf16 v[60:63], v[156:159], v[136:139], v[60:63]
    v_mfma_f32_16x16x32_bf16 v[64:67], v[152:155], v[140:143], v[64:67]
    v_mfma_f32_16x16x32_bf16 v[68:71], v[156:159], v[140:143], v[68:71]
    s_waitcnt lgkmcnt(6)
    v_mfma_f32_16x16x32_bf16 v[0:3], v[144:147], v[72:75], v[0:3]
    ds_read_b64_tr_b16 v[152:153], v166 offset:8192
    v_mfma_f32_16x16x32_bf16 v[4:7], v[148:151], v[72:75], v[4:7]
    ds_read_b64_tr_b16 v[154:155], v166 offset:9216
    v_mfma_f32_16x16x32_bf16 v[8:11], v[144:147], v[76:79], v[8:11]
    ds_read_b64_tr_b16 v[156:157], v167 offset:8192
    v_mfma_f32_16x16x32_bf16 v[12:15], v[148:151], v[76:79], v[12:15]
    ds_read_b64_tr_b16 v[158:159], v167 offset:9216
    v_mfma_f32_16x16x32_bf16 v[16:19], v[144:147], v[80:83], v[16:19]
    ds_read_b128 v[108:111], v168 offset:9216
    v_mfma_f32_16x16x32_bf16 v[20:23], v[148:151], v[80:83], v[20:23]
    ds_read_b128 v[112:115], v168 offset:10240
    s_waitcnt lgkmcnt(9)
    v_mfma_f32_16x16x32_bf16 v[24:27], v[144:147], v[84:87], v[24:27]
    ds_read_b128 v[116:119], v168 offset:11264
    v_mfma_f32_16x16x32_bf16 v[28:31], v[148:151], v[84:87], v[28:31]
    v_mfma_f32_16x16x32_bf16 v[32:35], v[144:147], v[88:91], v[32:35]
    ds_read_b128 v[120:123], v168 offset:12288
    v_mfma_f32_16x16x32_bf16 v[36:39], v[148:151], v[88:91], v[36:39]
    ds_read_b128 v[124:127], v168 offset:13312
    v_mfma_f32_16x16x32_bf16 v[40:43], v[144:147], v[92:95], v[40:43]
    ds_read_b128 v[128:131], v168 offset:14336
    v_mfma_f32_16x16x32_bf16 v[44:47], v[148:151], v[92:95], v[44:47]
    ds_read_b128 v[132:135], v168 offset:15360
    s_waitcnt lgkmcnt(11)
    v_mfma_f32_16x16x32_bf16 v[48:51], v[144:147], v[96:99], v[48:51]
    ds_read_b128 v[136:139], v168 offset:16384
    v_mfma_f32_16x16x32_bf16 v[52:55], v[148:151], v[96:99], v[52:55]
    ds_read_b128 v[140:143], v168 offset:17408
    v_mfma_f32_16x16x32_bf16 v[56:59], v[144:147], v[100:103], v[56:59]
    v_mfma_f32_16x16x32_bf16 v[60:63], v[148:151], v[100:103], v[60:63]
    v_mfma_f32_16x16x32_bf16 v[64:67], v[144:147], v[104:107], v[64:67]
    v_mfma_f32_16x16x32_bf16 v[68:71], v[148:151], v[104:107], v[68:71]
    s_waitcnt lgkmcnt(0)
    s_barrier
    s_cmp_eq_u32 s18, 2
    s_cbranch_scc0 back_kernel_npf6
    s_lshl_b32 s42, s14, 15
    s_lshl_b32 s43, s18, 13
    s_add_u32 s42, s42, s43
    v_lshlrev_b32 v208, 7, v254
    buffer_load_dword v209, v208, s[28:31], s42 offen
back_kernel_npf6:
    v_mfma_f32_16x16x32_bf16 v[0:3], v[152:155], v[108:111], v[0:3]
    ds_read_b64_tr_b16 v[144:145], v169 offset:0
    v_mfma_f32_16x16x32_bf16 v[4:7], v[156:159], v[108:111], v[4:7]
    ds_read_b64_tr_b16 v[146:147], v169 offset:1024
    v_mfma_f32_16x16x32_bf16 v[8:11], v[152:155], v[112:115], v[8:11]
    ds_read_b64_tr_b16 v[148:149], v170 offset:0
    v_mfma_f32_16x16x32_bf16 v[12:15], v[156:159], v[112:115], v[12:15]
    ds_read_b64_tr_b16 v[150:151], v170 offset:1024
    v_mfma_f32_16x16x32_bf16 v[16:19], v[152:155], v[116:119], v[16:19]
    ds_read_b128 v[72:75], v171 offset:0
    v_mfma_f32_16x16x32_bf16 v[20:23], v[156:159], v[116:119], v[20:23]
    ds_read_b128 v[76:79], v171 offset:1024
    v_mfma_f32_16x16x32_bf16 v[24:27], v[152:155], v[120:123], v[24:27]
    ds_read_b128 v[80:83], v171 offset:2048
    v_mfma_f32_16x16x32_bf16 v[28:31], v[156:159], v[120:123], v[28:31]
    v_mfma_f32_16x16x32_bf16 v[32:35], v[152:155], v[124:127], v[32:35]
    ds_read_b128 v[84:87], v171 offset:3072
    v_mfma_f32_16x16x32_bf16 v[36:39], v[156:159], v[124:127], v[36:39]
    ds_read_b128 v[88:91], v171 offset:4096
    v_mfma_f32_16x16x32_bf16 v[40:43], v[152:155], v[128:131], v[40:43]
    ds_read_b128 v[92:95], v171 offset:5120
    v_mfma_f32_16x16x32_bf16 v[44:47], v[156:159], v[128:131], v[44:47]
    ds_read_b128 v[96:99], v171 offset:6144
    v_mfma_f32_16x16x32_bf16 v[48:51], v[152:155], v[132:135], v[48:51]
    ds_read_b128 v[100:103], v171 offset:7168
    v_mfma_f32_16x16x32_bf16 v[52:55], v[156:159], v[132:135], v[52:55]
    ds_read_b128 v[104:107], v171 offset:8192
    v_mfma_f32_16x16x32_bf16 v[56:59], v[152:155], v[136:139], v[56:59]
    v_mfma_f32_16x16x32_bf16 v[60:63], v[156:159], v[136:139], v[60:63]
    v_mfma_f32_16x16x32_bf16 v[64:67], v[152:155], v[140:143], v[64:67]
    v_mfma_f32_16x16x32_bf16 v[68:71], v[156:159], v[140:143], v[68:71]
    s_waitcnt lgkmcnt(6)
    v_mfma_f32_16x16x32_bf16 v[0:3], v[144:147], v[72:75], v[0:3]
    ds_read_b64_tr_b16 v[152:153], v169 offset:8192
    v_mfma_f32_16x16x32_bf16 v[4:7], v[148:151], v[72:75], v[4:7]
    ds_read_b64_tr_b16 v[154:155], v169 offset:9216
    v_mfma_f32_16x16x32_bf16 v[8:11], v[144:147], v[76:79], v[8:11]
    ds_read_b64_tr_b16 v[156:157], v170 offset:8192
    v_mfma_f32_16x16x32_bf16 v[12:15], v[148:151], v[76:79], v[12:15]
    ds_read_b64_tr_b16 v[158:159], v170 offset:9216
    v_mfma_f32_16x16x32_bf16 v[16:19], v[144:147], v[80:83], v[16:19]
    ds_read_b128 v[108:111], v171 offset:9216
    v_mfma_f32_16x16x32_bf16 v[20:23], v[148:151], v[80:83], v[20:23]
    ds_read_b128 v[112:115], v171 offset:10240
    s_waitcnt lgkmcnt(9)
    v_mfma_f32_16x16x32_bf16 v[24:27], v[144:147], v[84:87], v[24:27]
    ds_read_b128 v[116:119], v171 offset:11264
    v_mfma_f32_16x16x32_bf16 v[28:31], v[148:151], v[84:87], v[28:31]
    v_mfma_f32_16x16x32_bf16 v[32:35], v[144:147], v[88:91], v[32:35]
    ds_read_b128 v[120:123], v171 offset:12288
    v_mfma_f32_16x16x32_bf16 v[36:39], v[148:151], v[88:91], v[36:39]
    ds_read_b128 v[124:127], v171 offset:13312
    v_mfma_f32_16x16x32_bf16 v[40:43], v[144:147], v[92:95], v[40:43]
    ds_read_b128 v[128:131], v171 offset:14336
    v_mfma_f32_16x16x32_bf16 v[44:47], v[148:151], v[92:95], v[44:47]
    ds_read_b128 v[132:135], v171 offset:15360
    s_waitcnt lgkmcnt(11)
    v_mfma_f32_16x16x32_bf16 v[48:51], v[144:147], v[96:99], v[48:51]
    ds_read_b128 v[136:139], v171 offset:16384
    v_mfma_f32_16x16x32_bf16 v[52:55], v[148:151], v[96:99], v[52:55]
    ds_read_b128 v[140:143], v171 offset:17408
    v_mfma_f32_16x16x32_bf16 v[56:59], v[144:147], v[100:103], v[56:59]
    v_mfma_f32_16x16x32_bf16 v[60:63], v[148:151], v[100:103], v[60:63]
    v_mfma_f32_16x16x32_bf16 v[64:67], v[144:147], v[104:107], v[64:67]
    v_mfma_f32_16x16x32_bf16 v[68:71], v[148:151], v[104:107], v[68:71]
    s_waitcnt lgkmcnt(0)
    s_barrier
    s_cmp_eq_u32 s18, 3
    s_cbranch_scc0 back_kernel_npf7
    s_lshl_b32 s42, s14, 15
    s_lshl_b32 s43, s18, 13
    s_add_u32 s42, s42, s43
    v_lshlrev_b32 v208, 7, v254
    buffer_load_dword v209, v208, s[28:31], s42 offen
back_kernel_npf7:
    v_mfma_f32_16x16x32_bf16 v[0:3], v[152:155], v[108:111], v[0:3]
    ds_read_b64_tr_b16 v[144:145], v160 offset:0
    v_mfma_f32_16x16x32_bf16 v[4:7], v[156:159], v[108:111], v[4:7]
    ds_read_b64_tr_b16 v[146:147], v160 offset:1024
    v_mfma_f32_16x16x32_bf16 v[8:11], v[152:155], v[112:115], v[8:11]
    ds_read_b64_tr_b16 v[148:149], v161 offset:0
    v_mfma_f32_16x16x32_bf16 v[12:15], v[156:159], v[112:115], v[12:15]
    ds_read_b64_tr_b16 v[150:151], v161 offset:1024
    v_mfma_f32_16x16x32_bf16 v[16:19], v[152:155], v[116:119], v[16:19]
    ds_read_b128 v[72:75], v162 offset:0
    v_mfma_f32_16x16x32_bf16 v[20:23], v[156:159], v[116:119], v[20:23]
    ds_read_b128 v[76:79], v162 offset:1024
    v_mfma_f32_16x16x32_bf16 v[24:27], v[152:155], v[120:123], v[24:27]
    ds_read_b128 v[80:83], v162 offset:2048
    v_mfma_f32_16x16x32_bf16 v[28:31], v[156:159], v[120:123], v[28:31]
    v_mfma_f32_16x16x32_bf16 v[32:35], v[152:155], v[124:127], v[32:35]
    ds_read_b128 v[84:87], v162 offset:3072
    v_mfma_f32_16x16x32_bf16 v[36:39], v[156:159], v[124:127], v[36:39]
    ds_read_b128 v[88:91], v162 offset:4096
    v_mfma_f32_16x16x32_bf16 v[40:43], v[152:155], v[128:131], v[40:43]
    ds_read_b128 v[92:95], v162 offset:5120
    v_mfma_f32_16x16x32_bf16 v[44:47], v[156:159], v[128:131], v[44:47]
    ds_read_b128 v[96:99], v162 offset:6144
    v_mfma_f32_16x16x32_bf16 v[48:51], v[152:155], v[132:135], v[48:51]
    ds_read_b128 v[100:103], v162 offset:7168
    v_mfma_f32_16x16x32_bf16 v[52:55], v[156:159], v[132:135], v[52:55]
    ds_read_b128 v[104:107], v162 offset:8192
    v_mfma_f32_16x16x32_bf16 v[56:59], v[152:155], v[136:139], v[56:59]
    v_mfma_f32_16x16x32_bf16 v[60:63], v[156:159], v[136:139], v[60:63]
    v_mfma_f32_16x16x32_bf16 v[64:67], v[152:155], v[140:143], v[64:67]
    v_mfma_f32_16x16x32_bf16 v[68:71], v[156:159], v[140:143], v[68:71]
    s_waitcnt lgkmcnt(6)
    v_mfma_f32_16x16x32_bf16 v[0:3], v[144:147], v[72:75], v[0:3]
    ds_read_b64_tr_b16 v[152:153], v160 offset:8192
    v_mfma_f32_16x16x32_bf16 v[4:7], v[148:151], v[72:75], v[4:7]
    ds_read_b64_tr_b16 v[154:155], v160 offset:9216
    v_mfma_f32_16x16x32_bf16 v[8:11], v[144:147], v[76:79], v[8:11]
    ds_read_b64_tr_b16 v[156:157], v161 offset:8192
    v_mfma_f32_16x16x32_bf16 v[12:15], v[148:151], v[76:79], v[12:15]
    ds_read_b64_tr_b16 v[158:159], v161 offset:9216
    v_mfma_f32_16x16x32_bf16 v[16:19], v[144:147], v[80:83], v[16:19]
    ds_read_b128 v[108:111], v162 offset:9216
    v_mfma_f32_16x16x32_bf16 v[20:23], v[148:151], v[80:83], v[20:23]
    ds_read_b128 v[112:115], v162 offset:10240
    s_waitcnt lgkmcnt(9)
    v_mfma_f32_16x16x32_bf16 v[24:27], v[144:147], v[84:87], v[24:27]
    ds_read_b128 v[116:119], v162 offset:11264
    v_mfma_f32_16x16x32_bf16 v[28:31], v[148:151], v[84:87], v[28:31]
    v_mfma_f32_16x16x32_bf16 v[32:35], v[144:147], v[88:91], v[32:35]
    ds_read_b128 v[120:123], v162 offset:12288
    v_mfma_f32_16x16x32_bf16 v[36:39], v[148:151], v[88:91], v[36:39]
    ds_read_b128 v[124:127], v162 offset:13312
    v_mfma_f32_16x16x32_bf16 v[40:43], v[144:147], v[92:95], v[40:43]
    ds_read_b128 v[128:131], v162 offset:14336
    v_mfma_f32_16x16x32_bf16 v[44:47], v[148:151], v[92:95], v[44:47]
    ds_read_b128 v[132:135], v162 offset:15360
    s_waitcnt lgkmcnt(11)
    v_mfma_f32_16x16x32_bf16 v[48:51], v[144:147], v[96:99], v[48:51]
    ds_read_b128 v[136:139], v162 offset:16384
    v_mfma_f32_16x16x32_bf16 v[52:55], v[148:151], v[96:99], v[52:55]
    ds_read_b128 v[140:143], v162 offset:17408
    v_mfma_f32_16x16x32_bf16 v[56:59], v[144:147], v[100:103], v[56:59]
    v_mfma_f32_16x16x32_bf16 v[60:63], v[148:151], v[100:103], v[60:63]
    v_mfma_f32_16x16x32_bf16 v[64:67], v[144:147], v[104:107], v[64:67]
    v_mfma_f32_16x16x32_bf16 v[68:71], v[148:151], v[104:107], v[68:71]
    s_waitcnt lgkmcnt(0)
    s_barrier
    v_mfma_f32_16x16x32_bf16 v[0:3], v[152:155], v[108:111], v[0:3]
    v_mfma_f32_16x16x32_bf16 v[4:7], v[156:159], v[108:111], v[4:7]
    v_mfma_f32_16x16x32_bf16 v[8:11], v[152:155], v[112:115], v[8:11]
    v_mfma_f32_16x16x32_bf16 v[12:15], v[156:159], v[112:115], v[12:15]
    v_mfma_f32_16x16x32_bf16 v[16:19], v[152:155], v[116:119], v[16:19]
    v_mfma_f32_16x16x32_bf16 v[20:23], v[156:159], v[116:119], v[20:23]
    v_mfma_f32_16x16x32_bf16 v[24:27], v[152:155], v[120:123], v[24:27]
    v_mfma_f32_16x16x32_bf16 v[28:31], v[156:159], v[120:123], v[28:31]
    v_mfma_f32_16x16x32_bf16 v[32:35], v[152:155], v[124:127], v[32:35]
    v_mfma_f32_16x16x32_bf16 v[36:39], v[156:159], v[124:127], v[36:39]
    v_mfma_f32_16x16x32_bf16 v[40:43], v[152:155], v[128:131], v[40:43]
    v_mfma_f32_16x16x32_bf16 v[44:47], v[156:159], v[128:131], v[44:47]
    v_mfma_f32_16x16x32_bf16 v[48:51], v[152:155], v[132:135], v[48:51]
    v_mfma_f32_16x16x32_bf16 v[52:55], v[156:159], v[132:135], v[52:55]
    v_mfma_f32_16x16x32_bf16 v[56:59], v[152:155], v[136:139], v[56:59]
    v_mfma_f32_16x16x32_bf16 v[60:63], v[156:159], v[136:139], v[60:63]
    v_mfma_f32_16x16x32_bf16 v[64:67], v[152:155], v[140:143], v[64:67]
    v_mfma_f32_16x16x32_bf16 v[68:71], v[156:159], v[140:143], v[68:71]
    s_mov_b32 s46, 0xbdd2d3e8
    v_mov_b32 v200, 0xc09d30fc
    v_lshrrev_b32 v180, 4, v254
    s_lshl_b32 s20, s18, 5
    v_lshlrev_b32 v180, 2, v180
    v_add_u32 v180, s20, v180
    v_lshlrev_b32 v180, 2, v180
    v_add_u32 v180, 139264, v180
    v_and_b32 v181, 15, v254
    v_lshlrev_b32 v181, 2, v181
    v_add_u32 v181, 140288, v181
    v_mov_b32 v108, 0
    v_mov_b32 v109, 0
    v_mov_b32 v110, 0
    v_mov_b32 v111, 0
    v_mov_b32 v112, 0
    v_mov_b32 v113, 0
    v_mov_b32 v114, 0
    v_mov_b32 v115, 0
    v_mov_b32 v116, 0
    v_mov_b32 v117, 0
    v_mov_b32 v118, 0
    v_mov_b32 v119, 0
    v_mov_b32 v120, 0
    v_mov_b32 v121, 0
    v_mov_b32 v122, 0
    v_mov_b32 v123, 0
    s_barrier
    ds_read_b128 v[72:75], v180 offset:0
    ds_read_b128 v[80:83], v180 offset:512
    ds_read_b128 v[76:79], v180 offset:64
    ds_read_b128 v[84:87], v180 offset:576
    ds_read_b32 v88, v181 offset:0
    ds_read_b32 v89, v181 offset:64
    ds_read_b32 v90, v181 offset:128
    ds_read_b32 v91, v181 offset:192
    ds_read_b32 v92, v181 offset:256
    ds_read_b32 v93, v181 offset:320
    ds_read_b32 v94, v181 offset:384
    ds_read_b32 v95, v181 offset:448
    ds_read_b32 v96, v181 offset:512
    s_waitcnt lgkmcnt(4)
    ds_read_b32 v98, v181 offset:576
    ds_read_b32 v99, v181 offset:640
    ds_read_b32 v100, v181 offset:704
    ds_read_b32 v101, v181 offset:768
    ds_read_b32 v102, v181 offset:832
    ds_read_b32 v103, v181 offset:896
    ds_read_b32 v104, v181 offset:960
    ds_read_b32 v105, v181 offset:1024
    ds_read_b32 v106, v181 offset:1088
    s_waitcnt lgkmcnt(0)
    v_fma_f32 v124, v80, v88, v98
    v_fma_f32 v125, v81, v88, v98
    v_fma_f32 v126, v82, v88, v98
    v_fma_f32 v127, v83, v88, v98
    v_fma_f32 v128, v84, v88, v98
    v_fma_f32 v129, v85, v88, v98
    v_fma_f32 v130, v86, v88, v98
    v_fma_f32 v131, v87, v88, v98
    v_fma_f32 v0, v72, v0, v124
    v_fma_f32 v1, v73, v1, v125
    v_fma_f32 v2, v74, v2, v126
    v_fma_f32 v3, v75, v3, v127
    v_fma_f32 v4, v76, v4, v128
    v_fma_f32 v5, v77, v5, v129
    v_fma_f32 v6, v78, v6, v130
    v_fma_f32 v7, v79, v7, v131
    v_fma_f32 v124, -v0, v0, v200
    v_fma_f32 v125, -v1, v1, v200
    v_fma_f32 v126, -v2, v2, v200
    v_fma_f32 v127, -v3, v3, v200
    v_fma_f32 v128, -v4, v4, v200
    v_fma_f32 v129, -v5, v5, v200
    v_fma_f32 v130, -v6, v6, v200
    v_fma_f32 v131, -v7, v7, v200
    v_mul_f32 v124, v124, v0
    v_mul_f32 v125, v125, v1
    v_mul_f32 v126, v126, v2
    v_mul_f32 v127, v127, v3
    v_mul_f32 v128, v128, v4
    v_mul_f32 v129, v129, v5
    v_mul_f32 v130, v130, v6
    v_mul_f32 v131, v131, v7
    v_exp_f32 v124, v124
    v_exp_f32 v125, v125
    v_exp_f32 v126, v126
    v_exp_f32 v127, v127
    v_exp_f32 v128, v128
    v_exp_f32 v129, v129
    v_exp_f32 v130, v130
    v_exp_f32 v131, v131
    v_add_f32 v124, 1.0, v124
    v_add_f32 v125, 1.0, v125
    v_add_f32 v126, 1.0, v126
    v_add_f32 v127, 1.0, v127
    v_add_f32 v128, 1.0, v128
    v_add_f32 v129, 1.0, v129
    v_add_f32 v130, 1.0, v130
    v_add_f32 v131, 1.0, v131
    v_rcp_f32 v124, v124
    v_rcp_f32 v125, v125
    v_rcp_f32 v126, v126
    v_rcp_f32 v127, v127
    v_rcp_f32 v128, v128
    v_rcp_f32 v129, v129
    v_rcp_f32 v130, v130
    v_rcp_f32 v131, v131
    v_mul_f32 v0, v0, v124
    v_mul_f32 v1, v1, v125
    v_mul_f32 v2, v2, v126
    v_mul_f32 v3, v3, v127
    v_mul_f32 v4, v4, v128
    v_mul_f32 v5, v5, v129
    v_mul_f32 v6, v6, v130
    v_mul_f32 v7, v7, v131
    v_add_f32 v108, v108, v0
    v_add_f32 v109, v109, v1
    v_add_f32 v110, v110, v2
    v_add_f32 v111, v111, v3
    v_add_f32 v112, v112, v4
    v_add_f32 v113, v113, v5
    v_add_f32 v114, v114, v6
    v_add_f32 v115, v115, v7
    v_fmac_f32 v116, v0, v0
    v_fmac_f32 v117, v1, v1
    v_fmac_f32 v118, v2, v2
    v_fmac_f32 v119, v3, v3
    v_fmac_f32 v120, v4, v4
    v_fmac_f32 v121, v5, v5
    v_fmac_f32 v122, v6, v6
    v_fmac_f32 v123, v7, v7
    v_fma_f32 v124, v80, v89, v99
    v_fma_f32 v125, v81, v89, v99
    v_fma_f32 v126, v82, v89, v99
    v_fma_f32 v127, v83, v89, v99
    v_fma_f32 v128, v84, v89, v99
    v_fma_f32 v129, v85, v89, v99
    v_fma_f32 v130, v86, v89, v99
    v_fma_f32 v131, v87, v89, v99
    v_fma_f32 v8, v72, v8, v124
    v_fma_f32 v9, v73, v9, v125
    v_fma_f32 v10, v74, v10, v126
    v_fma_f32 v11, v75, v11, v127
    v_fma_f32 v12, v76, v12, v128
    v_fma_f32 v13, v77, v13, v129
    v_fma_f32 v14, v78, v14, v130
    v_fma_f32 v15, v79, v15, v131
    v_fma_f32 v124, -v8, v8, v200
    v_fma_f32 v125, -v9, v9, v200
    v_fma_f32 v126, -v10, v10, v200
    v_fma_f32 v127, -v11, v11, v200
    v_fma_f32 v128, -v12, v12, v200
    v_fma_f32 v129, -v13, v13, v200
    v_fma_f32 v130, -v14, v14, v200
    v_fma_f32 v131, -v15, v15, v200
    v_mul_f32 v124, v124, v8
    v_mul_f32 v125, v125, v9
    v_mul_f32 v126, v126, v10
    v_mul_f32 v127, v127, v11
    v_mul_f32 v128, v128, v12
    v_mul_f32 v129, v129, v13
    v_mul_f32 v130, v130, v14
    v_mul_f32 v131, v131, v15
    v_exp_f32 v124, v124
    v_exp_f32 v125, v125
    v_exp_f32 v126, v126
    v_exp_f32 v127, v127
    v_exp_f32 v128, v128
    v_exp_f32 v129, v129
    v_exp_f32 v130, v130
    v_exp_f32 v131, v131
    v_add_f32 v124, 1.0, v124
    v_add_f32 v125, 1.0, v125
    v_add_f32 v126, 1.0, v126
    v_add_f32 v127, 1.0, v127
    v_add_f32 v128, 1.0, v128
    v_add_f32 v129, 1.0, v129
    v_add_f32 v130, 1.0, v130
    v_add_f32 v131, 1.0, v131
    v_rcp_f32 v124, v124
    v_rcp_f32 v125, v125
    v_rcp_f32 v126, v126
    v_rcp_f32 v127, v127
    v_rcp_f32 v128, v128
    v_rcp_f32 v129, v129
    v_rcp_f32 v130, v130
    v_rcp_f32 v131, v131
    v_mul_f32 v8, v8, v124
    v_mul_f32 v9, v9, v125
    v_mul_f32 v10, v10, v126
    v_mul_f32 v11, v11, v127
    v_mul_f32 v12, v12, v128
    v_mul_f32 v13, v13, v129
    v_mul_f32 v14, v14, v130
    v_mul_f32 v15, v15, v131
    v_add_f32 v108, v108, v8
    v_add_f32 v109, v109, v9
    v_add_f32 v110, v110, v10
    v_add_f32 v111, v111, v11
    v_add_f32 v112, v112, v12
    v_add_f32 v113, v113, v13
    v_add_f32 v114, v114, v14
    v_add_f32 v115, v115, v15
    v_fmac_f32 v116, v8, v8
    v_fmac_f32 v117, v9, v9
    v_fmac_f32 v118, v10, v10
    v_fmac_f32 v119, v11, v11
    v_fmac_f32 v120, v12, v12
    v_fmac_f32 v121, v13, v13
    v_fmac_f32 v122, v14, v14
    v_fmac_f32 v123, v15, v15
    s_barrier
    s_mov_b32 s41, 165888
    s_add_u32 m0, s23, 51200
    s_nop 0
    buffer_load_dwordx4 v250, s[32:35], s41 offen lds
    buffer_load_dwordx4 v250, s[32:35], s41 offen offset:1024 lds
    buffer_load_dwordx4 v250, s[32:35], s41 offen offset:2048 lds
    buffer_load_dwordx4 v250, s[32:35], s41 offen offset:3072 lds
    s_add_u32 m0, s24, 67584
    s_mov_b32 exec_hi, 0
    buffer_load_dwordx4 v251, s[32:35], s41 offen lds
    s_mov_b32 exec_hi, -1
    v_fma_f32 v124, v80, v90, v100
    v_fma_f32 v125, v81, v90, v100
    v_fma_f32 v126, v82, v90, v100
    v_fma_f32 v127, v83, v90, v100
    v_fma_f32 v128, v84, v90, v100
    v_fma_f32 v129, v85, v90, v100
    v_fma_f32 v130, v86, v90, v100
    v_fma_f32 v131, v87, v90, v100
    v_fma_f32 v16, v72, v16, v124
    v_fma_f32 v17, v73, v17, v125
    v_fma_f32 v18, v74, v18, v126
    v_fma_f32 v19, v75, v19, v127
    v_fma_f32 v20, v76, v20, v128
    v_fma_f32 v21, v77, v21, v129
    v_fma_f32 v22, v78, v22, v130
    v_fma_f32 v23, v79, v23, v131
    v_fma_f32 v124, -v16, v16, v200
    v_fma_f32 v125, -v17, v17, v200
    v_fma_f32 v126, -v18, v18, v200
    v_fma_f32 v127, -v19, v19, v200
    v_fma_f32 v128, -v20, v20, v200
    v_fma_f32 v129, -v21, v21, v200
    v_fma_f32 v130, -v22, v22, v200
    v_fma_f32 v131, -v23, v23, v200
    v_mul_f32 v124, v124, v16
    v_mul_f32 v125, v125, v17
    v_mul_f32 v126, v126, v18
    v_mul_f32 v127, v127, v19
    v_mul_f32 v128, v128, v20
    v_mul_f32 v129, v129, v21
    v_mul_f32 v130, v130, v22
    v_mul_f32 v131, v131, v23
    v_exp_f32 v124, v124
    v_exp_f32 v125, v125
    v_exp_f32 v126, v126
    v_exp_f32 v127, v127
    v_exp_f32 v128, v128
    v_exp_f32 v129, v129
    v_exp_f32 v130, v130
    v_exp_f32 v131, v131
    v_add_f32 v124, 1.0, v124
    v_add_f32 v125, 1.0, v125
    v_add_f32 v126, 1.0, v126
    v_add_f32 v127, 1.0, v127
    v_add_f32 v128, 1.0, v128
    v_add_f32 v129, 1.0, v129
    v_add_f32 v130, 1.0, v130
    v_add_f32 v131, 1.0, v131
    v_rcp_f32 v124, v124
    v_rcp_f32 v125, v125
    v_rcp_f32 v126, v126
    v_rcp_f32 v127, v127
    v_rcp_f32 v128, v128
    v_rcp_f32 v129, v129
    v_rcp_f32 v130, v130
    v_rcp_f32 v131, v131
    v_mul_f32 v16, v16, v124
    v_mul_f32 v17, v17, v125
    v_mul_f32 v18, v18, v126
    v_mul_f32 v19, v19, v127
    v_mul_f32 v20, v20, v128
    v_mul_f32 v21, v21, v129
    v_mul_f32 v22, v22, v130
    v_mul_f32 v23, v23, v131
    v_add_f32 v108, v108, v16
    v_add_f32 v109, v109, v17
    v_add_f32 v110, v110, v18
    v_add_f32 v111, v111, v19
    v_add_f32 v112, v112, v20
    v_add_f32 v113, v113, v21
    v_add_f32 v114, v114, v22
    v_add_f32 v115, v115, v23
    v_fmac_f32 v116, v16, v16
    v_fmac_f32 v117, v17, v17
    v_fmac_f32 v118, v18, v18
    v_fmac_f32 v119, v19, v19
    v_fmac_f32 v120, v20, v20
    v_fmac_f32 v121, v21, v21
    v_fmac_f32 v122, v22, v22
    v_fmac_f32 v123, v23, v23
    v_fma_f32 v124, v80, v91, v101
    v_fma_f32 v125, v81, v91, v101
    v_fma_f32 v126, v82, v91, v101
    v_fma_f32 v127, v83, v91, v101
    v_fma_f32 v128, v84, v91, v101
    v_fma_f32 v129, v85, v91, v101
    v_fma_f32 v130, v86, v91, v101
    v_fma_f32 v131, v87, v91, v101
    v_fma_f32 v24, v72, v24, v124
    v_fma_f32 v25, v73, v25, v125
    v_fma_f32 v26, v74, v26, v126
    v_fma_f32 v27, v75, v27, v127
    v_fma_f32 v28, v76, v28, v128
    v_fma_f32 v29, v77, v29, v129
    v_fma_f32 v30, v78, v30, v130
    v_fma_f32 v31, v79, v31, v131
    v_fma_f32 v124, -v24, v24, v200
    v_fma_f32 v125, -v25, v25, v200
    v_fma_f32 v126, -v26, v26, v200
    v_fma_f32 v127, -v27, v27, v200
    v_fma_f32 v128, -v28, v28, v200
    v_fma_f32 v129, -v29, v29, v200
    v_fma_f32 v130, -v30, v30, v200
    v_fma_f32 v131, -v31, v31, v200
    v_mul_f32 v124, v124, v24
    v_mul_f32 v125, v125, v25
    v_mul_f32 v126, v126, v26
    v_mul_f32 v127, v127, v27
    v_mul_f32 v128, v128, v28
    v_mul_f32 v129, v129, v29
    v_mul_f32 v130, v130, v30
    v_mul_f32 v131, v131, v31
    v_exp_f32 v124, v124
    v_exp_f32 v125, v125
    v_exp_f32 v126, v126
    v_exp_f32 v127, v127
    v_exp_f32 v128, v128
    v_exp_f32 v129, v129
    v_exp_f32 v130, v130
    v_exp_f32 v131, v131
    v_add_f32 v124, 1.0, v124
    v_add_f32 v125, 1.0, v125
    v_add_f32 v126, 1.0, v126
    v_add_f32 v127, 1.0, v127
    v_add_f32 v128, 1.0, v128
    v_add_f32 v129, 1.0, v129
    v_add_f32 v130, 1.0, v130
    v_add_f32 v131, 1.0, v131
    v_rcp_f32 v124, v124
    v_rcp_f32 v125, v125
    v_rcp_f32 v126, v126
    v_rcp_f32 v127, v127
    v_rcp_f32 v128, v128
    v_rcp_f32 v129, v129
    v_rcp_f32 v130, v130
    v_rcp_f32 v131, v131
    v_mul_f32 v24, v24, v124
    v_mul_f32 v25, v25, v125
    v_mul_f32 v26, v26, v126
    v_mul_f32 v27, v27, v127
    v_mul_f32 v28, v28, v128
    v_mul_f32 v29, v29, v129
    v_mul_f32 v30, v30, v130
    v_mul_f32 v31, v31, v131
    v_add_f32 v108, v108, v24
    v_add_f32 v109, v109, v25
    v_add_f32 v110, v110, v26
    v_add_f32 v111, v111, v27
    v_add_f32 v112, v112, v28
    v_add_f32 v113, v113, v29
    v_add_f32 v114, v114, v30
    v_add_f32 v115, v115, v31
    v_fmac_f32 v116, v24, v24
    v_fmac_f32 v117, v25, v25
    v_fmac_f32 v118, v26, v26
    v_fmac_f32 v119, v27, v27
    v_fmac_f32 v120, v28, v28
    v_fmac_f32 v121, v29, v29
    v_fmac_f32 v122, v30, v30
    v_fmac_f32 v123, v31, v31
    s_barrier
    s_mov_b32 s41, 202752
    s_add_u32 m0, s23, 86016
    s_nop 0
    buffer_load_dwordx4 v250, s[32:35], s41 offen lds
    buffer_load_dwordx4 v250, s[32:35], s41 offen offset:1024 lds
    buffer_load_dwordx4 v250, s[32:35], s41 offen offset:2048 lds
    buffer_load_dwordx4 v250, s[32:35], s41 offen offset:3072 lds
    s_add_u32 m0, s24, 102400
    s_mov_b32 exec_hi, 0
    buffer_load_dwordx4 v251, s[32:35], s41 offen lds
    s_mov_b32 exec_hi, -1
    v_fma_f32 v124, v80, v92, v102
    v_fma_f32 v125, v81, v92, v102
    v_fma_f32 v126, v82, v92, v102
    v_fma_f32 v127, v83, v92, v102
    v_fma_f32 v128, v84, v92, v102
    v_fma_f32 v129, v85, v92, v102
    v_fma_f32 v130, v86, v92, v102
    v_fma_f32 v131, v87, v92, v102
    v_fma_f32 v32, v72, v32, v124
    v_fma_f32 v33, v73, v33, v125
    v_fma_f32 v34, v74, v34, v126
    v_fma_f32 v35, v75, v35, v127
    v_fma_f32 v36, v76, v36, v128
    v_fma_f32 v37, v77, v37, v129
    v_fma_f32 v38, v78, v38, v130
    v_fma_f32 v39, v79, v39, v131
    v_fma_f32 v124, -v32, v32, v200
    v_fma_f32 v125, -v33, v33, v200
    v_fma_f32 v126, -v34, v34, v200
    v_fma_f32 v127, -v35, v35, v200
    v_fma_f32 v128, -v36, v36, v200
    v_fma_f32 v129, -v37, v37, v200
    v_fma_f32 v130, -v38, v38, v200
    v_fma_f32 v131, -v39, v39, v200
    v_mul_f32 v124, v124, v32
    v_mul_f32 v125, v125, v33
    v_mul_f32 v126, v126, v34
    v_mul_f32 v127, v127, v35
    v_mul_f32 v128, v128, v36
    v_mul_f32 v129, v129, v37
    v_mul_f32 v130, v130, v38
    v_mul_f32 v131, v131, v39
    v_exp_f32 v124, v124
    v_exp_f32 v125, v125
    v_exp_f32 v126, v126
    v_exp_f32 v127, v127
    v_exp_f32 v128, v128
    v_exp_f32 v129, v129
    v_exp_f32 v130, v130
    v_exp_f32 v131, v131
    v_add_f32 v124, 1.0, v124
    v_add_f32 v125, 1.0, v125
    v_add_f32 v126, 1.0, v126
    v_add_f32 v127, 1.0, v127
    v_add_f32 v128, 1.0, v128
    v_add_f32 v129, 1.0, v129
    v_add_f32 v130, 1.0, v130
    v_add_f32 v131, 1.0, v131
    v_rcp_f32 v124, v124
    v_rcp_f32 v125, v125
    v_rcp_f32 v126, v126
    v_rcp_f32 v127, v127
    v_rcp_f32 v128, v128
    v_rcp_f32 v129, v129
    v_rcp_f32 v130, v130
    v_rcp_f32 v131, v131
    v_mul_f32 v32, v32, v124
    v_mul_f32 v33, v33, v125
    v_mul_f32 v34, v34, v126
    v_mul_f32 v35, v35, v127
    v_mul_f32 v36, v36, v128
    v_mul_f32 v37, v37, v129
    v_mul_f32 v38, v38, v130
    v_mul_f32 v39, v39, v131
    v_add_f32 v108, v108, v32
    v_add_f32 v109, v109, v33
    v_add_f32 v110, v110, v34
    v_add_f32 v111, v111, v35
    v_add_f32 v112, v112, v36
    v_add_f32 v113, v113, v37
    v_add_f32 v114, v114, v38
    v_add_f32 v115, v115, v39
    v_fmac_f32 v116, v32, v32
    v_fmac_f32 v117, v33, v33
    v_fmac_f32 v118, v34, v34
    v_fmac_f32 v119, v35, v35
    v_fmac_f32 v120, v36, v36
    v_fmac_f32 v121, v37, v37
    v_fmac_f32 v122, v38, v38
    v_fmac_f32 v123, v39, v39
    v_fma_f32 v124, v80, v93, v103
    v_fma_f32 v125, v81, v93, v103
    v_fma_f32 v126, v82, v93, v103
    v_fma_f32 v127, v83, v93, v103
    v_fma_f32 v128, v84, v93, v103
    v_fma_f32 v129, v85, v93, v103
    v_fma_f32 v130, v86, v93, v103
    v_fma_f32 v131, v87, v93, v103
    v_fma_f32 v40, v72, v40, v124
    v_fma_f32 v41, v73, v41, v125
    v_fma_f32 v42, v74, v42, v126
    v_fma_f32 v43, v75, v43, v127
    v_fma_f32 v44, v76, v44, v128
    v_fma_f32 v45, v77, v45, v129
    v_fma_f32 v46, v78, v46, v130
    v_fma_f32 v47, v79, v47, v131
    v_fma_f32 v124, -v40, v40, v200
    v_fma_f32 v125, -v41, v41, v200
    v_fma_f32 v126, -v42, v42, v200
    v_fma_f32 v127, -v43, v43, v200
    v_fma_f32 v128, -v44, v44, v200
    v_fma_f32 v129, -v45, v45, v200
    v_fma_f32 v130, -v46, v46, v200
    v_fma_f32 v131, -v47, v47, v200
    v_mul_f32 v124, v124, v40
    v_mul_f32 v125, v125, v41
    v_mul_f32 v126, v126, v42
    v_mul_f32 v127, v127, v43
    v_mul_f32 v128, v128, v44
    v_mul_f32 v129, v129, v45
    v_mul_f32 v130, v130, v46
    v_mul_f32 v131, v131, v47
    v_exp_f32 v124, v124
    v_exp_f32 v125, v125
    v_exp_f32 v126, v126
    v_exp_f32 v127, v127
    v_exp_f32 v128, v128
    v_exp_f32 v129, v129
    v_exp_f32 v130, v130
    v_exp_f32 v131, v131
    v_add_f32 v124, 1.0, v124
    v_add_f32 v125, 1.0, v125
    v_add_f32 v126, 1.0, v126
    v_add_f32 v127, 1.0, v127
    v_add_f32 v128, 1.0, v128
    v_add_f32 v129, 1.0, v129
    v_add_f32 v130, 1.0, v130
    v_add_f32 v131, 1.0, v131
    v_rcp_f32 v124, v124
    v_rcp_f32 v125, v125
    v_rcp_f32 v126, v126
    v_rcp_f32 v127, v127
    v_rcp_f32 v128, v128
    v_rcp_f32 v129, v129
    v_rcp_f32 v130, v130
    v_rcp_f32 v131, v131
    v_mul_f32 v40, v40, v124
    v_mul_f32 v41, v41, v125
    v_mul_f32 v42, v42, v126
    v_mul_f32 v43, v43, v127
    v_mul_f32 v44, v44, v128
    v_mul_f32 v45, v45, v129
    v_mul_f32 v46, v46, v130
    v_mul_f32 v47, v47, v131
    v_add_f32 v108, v108, v40
    v_add_f32 v109, v109, v41
    v_add_f32 v110, v110, v42
    v_add_f32 v111, v111, v43
    v_add_f32 v112, v112, v44
    v_add_f32 v113, v113, v45
    v_add_f32 v114, v114, v46
    v_add_f32 v115, v115, v47
    v_fmac_f32 v116, v40, v40
    v_fmac_f32 v117, v41, v41
    v_fmac_f32 v118, v42, v42
    v_fmac_f32 v119, v43, v43
    v_fmac_f32 v120, v44, v44
    v_fmac_f32 v121, v45, v45
    v_fmac_f32 v122, v46, v46
    v_fmac_f32 v123, v47, v47
    s_waitcnt vmcnt(5)
    s_barrier
    s_mov_b32 s41, 239616
    s_add_u32 m0, s23, 120832
    s_nop 0
    buffer_load_dwordx4 v250, s[32:35], s41 offen lds
    buffer_load_dwordx4 v250, s[32:35], s41 offen offset:1024 lds
    buffer_load_dwordx4 v250, s[32:35], s41 offen offset:2048 lds
    buffer_load_dwordx4 v250, s[32:35], s41 offen offset:3072 lds
    s_add_u32 m0, s24, 137216
    s_mov_b32 exec_hi, 0
    buffer_load_dwordx4 v251, s[32:35], s41 offen lds
    s_mov_b32 exec_hi, -1
    v_fma_f32 v124, v80, v94, v104
    v_fma_f32 v125, v81, v94, v104
    v_fma_f32 v126, v82, v94, v104
    v_fma_f32 v127, v83, v94, v104
    v_fma_f32 v128, v84, v94, v104
    v_fma_f32 v129, v85, v94, v104
    v_fma_f32 v130, v86, v94, v104
    v_fma_f32 v131, v87, v94, v104
    v_fma_f32 v48, v72, v48, v124
    v_fma_f32 v49, v73, v49, v125
    v_fma_f32 v50, v74, v50, v126
    v_fma_f32 v51, v75, v51, v127
    v_fma_f32 v52, v76, v52, v128
    v_fma_f32 v53, v77, v53, v129
    v_fma_f32 v54, v78, v54, v130
    v_fma_f32 v55, v79, v55, v131
    v_fma_f32 v124, -v48, v48, v200
    v_fma_f32 v125, -v49, v49, v200
    v_fma_f32 v126, -v50, v50, v200
    v_fma_f32 v127, -v51, v51, v200
    v_fma_f32 v128, -v52, v52, v200
    v_fma_f32 v129, -v53, v53, v200
    v_fma_f32 v130, -v54, v54, v200
    v_fma_f32 v131, -v55, v55, v200
    v_mul_f32 v124, v124, v48
    v_mul_f32 v125, v125, v49
    v_mul_f32 v126, v126, v50
    v_mul_f32 v127, v127, v51
    v_mul_f32 v128, v128, v52
    v_mul_f32 v129, v129, v53
    v_mul_f32 v130, v130, v54
    v_mul_f32 v131, v131, v55
    v_exp_f32 v124, v124
    v_exp_f32 v125, v125
    v_exp_f32 v126, v126
    v_exp_f32 v127, v127
    v_exp_f32 v128, v128
    v_exp_f32 v129, v129
    v_exp_f32 v130, v130
    v_exp_f32 v131, v131
    v_add_f32 v124, 1.0, v124
    v_add_f32 v125, 1.0, v125
    v_add_f32 v126, 1.0, v126
    v_add_f32 v127, 1.0, v127
    v_add_f32 v128, 1.0, v128
    v_add_f32 v129, 1.0, v129
    v_add_f32 v130, 1.0, v130
    v_add_f32 v131, 1.0, v131
    v_rcp_f32 v124, v124
    v_rcp_f32 v125, v125
    v_rcp_f32 v126, v126
    v_rcp_f32 v127, v127
    v_rcp_f32 v128, v128
    v_rcp_f32 v129, v129
    v_rcp_f32 v130, v130
    v_rcp_f32 v131, v131
    v_mul_f32 v48, v48, v124
    v_mul_f32 v49, v49, v125
    v_mul_f32 v50, v50, v126
    v_mul_f32 v51, v51, v127
    v_mul_f32 v52, v52, v128
    v_mul_f32 v53, v53, v129
    v_mul_f32 v54, v54, v130
    v_mul_f32 v55, v55, v131
    v_add_f32 v108, v108, v48
    v_add_f32 v109, v109, v49
    v_add_f32 v110, v110, v50
    v_add_f32 v111, v111, v51
    v_add_f32 v112, v112, v52
    v_add_f32 v113, v113, v53
    v_add_f32 v114, v114, v54
    v_add_f32 v115, v115, v55
    v_fmac_f32 v116, v48, v48
    v_fmac_f32 v117, v49, v49
    v_fmac_f32 v118, v50, v50
    v_fmac_f32 v119, v51, v51
    v_fmac_f32 v120, v52, v52
    v_fmac_f32 v121, v53, v53
    v_fmac_f32 v122, v54, v54
    v_fmac_f32 v123, v55, v55
    v_fma_f32 v124, v80, v95, v105
    v_fma_f32 v125, v81, v95, v105
    v_fma_f32 v126, v82, v95, v105
    v_fma_f32 v127, v83, v95, v105
    v_fma_f32 v128, v84, v95, v105
    v_fma_f32 v129, v85, v95, v105
    v_fma_f32 v130, v86, v95, v105
    v_fma_f32 v131, v87, v95, v105
    v_fma_f32 v56, v72, v56, v124
    v_fma_f32 v57, v73, v57, v125
    v_fma_f32 v58, v74, v58, v126
    v_fma_f32 v59, v75, v59, v127
    v_fma_f32 v60, v76, v60, v128
    v_fma_f32 v61, v77, v61, v129
    v_fma_f32 v62, v78, v62, v130
    v_fma_f32 v63, v79, v63, v131
    v_fma_f32 v124, -v56, v56, v200
    v_fma_f32 v125, -v57, v57, v200
    v_fma_f32 v126, -v58, v58, v200
    v_fma_f32 v127, -v59, v59, v200
    v_fma_f32 v128, -v60, v60, v200
    v_fma_f32 v129, -v61, v61, v200
    v_fma_f32 v130, -v62, v62, v200
    v_fma_f32 v131, -v63, v63, v200
    v_mul_f32 v124, v124, v56
    v_mul_f32 v125, v125, v57
    v_mul_f32 v126, v126, v58
    v_mul_f32 v127, v127, v59
    v_mul_f32 v128, v128, v60
    v_mul_f32 v129, v129, v61
    v_mul_f32 v130, v130, v62
    v_mul_f32 v131, v131, v63
    v_exp_f32 v124, v124
    v_exp_f32 v125, v125
    v_exp_f32 v126, v126
    v_exp_f32 v127, v127
    v_exp_f32 v128, v128
    v_exp_f32 v129, v129
    v_exp_f32 v130, v130
    v_exp_f32 v131, v131
    v_add_f32 v124, 1.0, v124
    v_add_f32 v125, 1.0, v125
    v_add_f32 v126, 1.0, v126
    v_add_f32 v127, 1.0, v127
    v_add_f32 v128, 1.0, v128
    v_add_f32 v129, 1.0, v129
    v_add_f32 v130, 1.0, v130
    v_add_f32 v131, 1.0, v131
    v_rcp_f32 v124, v124
    v_rcp_f32 v125, v125
    v_rcp_f32 v126, v126
    v_rcp_f32 v127, v127
    v_rcp_f32 v128, v128
    v_rcp_f32 v129, v129
    v_rcp_f32 v130, v130
    v_rcp_f32 v131, v131
    v_mul_f32 v56, v56, v124
    v_mul_f32 v57, v57, v125
    v_mul_f32 v58, v58, v126
    v_mul_f32 v59, v59, v127
    v_mul_f32 v60, v60, v128
    v_mul_f32 v61, v61, v129
    v_mul_f32 v62, v62, v130
    v_mul_f32 v63, v63, v131
    v_add_f32 v108, v108, v56
    v_add_f32 v109, v109, v57
    v_add_f32 v110, v110, v58
    v_add_f32 v111, v111, v59
    v_add_f32 v112, v112, v60
    v_add_f32 v113, v113, v61
    v_add_f32 v114, v114, v62
    v_add_f32 v115, v115, v63
    v_fmac_f32 v116, v56, v56
    v_fmac_f32 v117, v57, v57
    v_fmac_f32 v118, v58, v58
    v_fmac_f32 v119, v59, v59
    v_fmac_f32 v120, v60, v60
    v_fmac_f32 v121, v61, v61
    v_fmac_f32 v122, v62, v62
    v_fmac_f32 v123, v63, v63
    s_waitcnt vmcnt(5)
    s_barrier
    s_mov_b32 s41, 276480
    s_add_u32 m0, s23, 16384
    s_nop 0
    buffer_load_dwordx4 v250, s[32:35], s41 offen lds
    buffer_load_dwordx4 v250, s[32:35], s41 offen offset:1024 lds
    buffer_load_dwordx4 v250, s[32:35], s41 offen offset:2048 lds
    buffer_load_dwordx4 v250, s[32:35], s41 offen offset:3072 lds
    s_add_u32 m0, s24, 32768
    s_mov_b32 exec_hi, 0
    buffer_load_dwordx4 v251, s[32:35], s41 offen lds
    s_mov_b32 exec_hi, -1
    v_fma_f32 v124, v80, v96, v106
    v_fma_f32 v125, v81, v96, v106
    v_fma_f32 v126, v82, v96, v106
    v_fma_f32 v127, v83, v96, v106
    v_fma_f32 v128, v84, v96, v106
    v_fma_f32 v129, v85, v96, v106
    v_fma_f32 v130, v86, v96, v106
    v_fma_f32 v131, v87, v96, v106
    v_fma_f32 v64, v72, v64, v124
    v_fma_f32 v65, v73, v65, v125
    v_fma_f32 v66, v74, v66, v126
    v_fma_f32 v67, v75, v67, v127
    v_fma_f32 v68, v76, v68, v128
    v_fma_f32 v69, v77, v69, v129
    v_fma_f32 v70, v78, v70, v130
    v_fma_f32 v71, v79, v71, v131
    v_fma_f32 v124, -v64, v64, v200
    v_fma_f32 v125, -v65, v65, v200
    v_fma_f32 v126, -v66, v66, v200
    v_fma_f32 v127, -v67, v67, v200
    v_fma_f32 v128, -v68, v68, v200
    v_fma_f32 v129, -v69, v69, v200
    v_fma_f32 v130, -v70, v70, v200
    v_fma_f32 v131, -v71, v71, v200
    v_mul_f32 v124, v124, v64
    v_mul_f32 v125, v125, v65
    v_mul_f32 v126, v126, v66
    v_mul_f32 v127, v127, v67
    v_mul_f32 v128, v128, v68
    v_mul_f32 v129, v129, v69
    v_mul_f32 v130, v130, v70
    v_mul_f32 v131, v131, v71
    v_exp_f32 v124, v124
    v_exp_f32 v125, v125
    v_exp_f32 v126, v126
    v_exp_f32 v127, v127
    v_exp_f32 v128, v128
    v_exp_f32 v129, v129
    v_exp_f32 v130, v130
    v_exp_f32 v131, v131
    v_add_f32 v124, 1.0, v124
    v_add_f32 v125, 1.0, v125
    v_add_f32 v126, 1.0, v126
    v_add_f32 v127, 1.0, v127
    v_add_f32 v128, 1.0, v128
    v_add_f32 v129, 1.0, v129
    v_add_f32 v130, 1.0, v130
    v_add_f32 v131, 1.0, v131
    v_rcp_f32 v124, v124
    v_rcp_f32 v125, v125
    v_rcp_f32 v126, v126
    v_rcp_f32 v127, v127
    v_rcp_f32 v128, v128
    v_rcp_f32 v129, v129
    v_rcp_f32 v130, v130
    v_rcp_f32 v131, v131
    v_mul_f32 v64, v64, v124
    v_mul_f32 v65, v65, v125
    v_mul_f32 v66, v66, v126
    v_mul_f32 v67, v67, v127
    v_mul_f32 v68, v68, v128
    v_mul_f32 v69, v69, v129
    v_mul_f32 v70, v70, v130
    v_mul_f32 v71, v71, v131
    v_add_f32 v108, v108, v64
    v_add_f32 v109, v109, v65
    v_add_f32 v110, v110, v66
    v_add_f32 v111, v111, v67
    v_add_f32 v112, v112, v68
    v_add_f32 v113, v113, v69
    v_add_f32 v114, v114, v70
    v_add_f32 v115, v115, v71
    v_fmac_f32 v116, v64, v64
    v_fmac_f32 v117, v65, v65
    v_fmac_f32 v118, v66, v66
    v_fmac_f32 v119, v67, v67
    v_fmac_f32 v120, v68, v68
    v_fmac_f32 v121, v69, v69
    v_fmac_f32 v122, v70, v70
    v_fmac_f32 v123, v71, v71
    s_nop 1
    v_add_f32_dpp v108, v108, v108 row_ror:8 row_mask:0xf bank_mask:0xf
    v_add_f32_dpp v109, v109, v109 row_ror:8 row_mask:0xf bank_mask:0xf
    v_add_f32_dpp v110, v110, v110 row_ror:8 row_mask:0xf bank_mask:0xf
    v_add_f32_dpp v111, v111, v111 row_ror:8 row_mask:0xf bank_mask:0xf
    v_add_f32_dpp v112, v112, v112 row_ror:8 row_mask:0xf bank_mask:0xf
    v_add_f32_dpp v113, v113, v113 row_ror:8 row_mask:0xf bank_mask:0xf
    v_add_f32_dpp v114, v114, v114 row_ror:8 row_mask:0xf bank_mask:0xf
    v_add_f32_dpp v115, v115, v115 row_ror:8 row_mask:0xf bank_mask:0xf
    v_add_f32_dpp v116, v116, v116 row_ror:8 row_mask:0xf bank_mask:0xf
    v_add_f32_dpp v117, v117, v117 row_ror:8 row_mask:0xf bank_mask:0xf
    v_add_f32_dpp v118, v118, v118 row_ror:8 row_mask:0xf bank_mask:0xf
    v_add_f32_dpp v119, v119, v119 row_ror:8 row_mask:0xf bank_mask:0xf
    v_add_f32_dpp v120, v120, v120 row_ror:8 row_mask:0xf bank_mask:0xf
    v_add_f32_dpp v121, v121, v121 row_ror:8 row_mask:0xf bank_mask:0xf
    v_add_f32_dpp v122, v122, v122 row_ror:8 row_mask:0xf bank_mask:0xf
    v_add_f32_dpp v123, v123, v123 row_ror:8 row_mask:0xf bank_mask:0xf
    v_add_f32_dpp v108, v108, v108 row_ror:4 row_mask:0xf bank_mask:0xf
    v_add_f32_dpp v109, v109, v109 row_ror:4 row_mask:0xf bank_mask:0xf
    v_add_f32_dpp v110, v110, v110 row_ror:4 row_mask:0xf bank_mask:0xf
    v_add_f32_dpp v111, v111, v111 row_ror:4 row_mask:0xf bank_mask:0xf
    v_add_f32_dpp v112, v112, v112 row_ror:4 row_mask:0xf bank_mask:0xf
    v_add_f32_dpp v113, v113, v113 row_ror:4 row_mask:0xf bank_mask:0xf
    v_add_f32_dpp v114, v114, v114 row_ror:4 row_mask:0xf bank_mask:0xf
    v_add_f32_dpp v115, v115, v115 row_ror:4 row_mask:0xf bank_mask:0xf
    v_add_f32_dpp v116, v116, v116 row_ror:4 row_mask:0xf bank_mask:0xf
    v_add_f32_dpp v117, v117, v117 row_ror:4 row_mask:0xf bank_mask:0xf
    v_add_f32_dpp v118, v118, v118 row_ror:4 row_mask:0xf bank_mask:0xf
    v_add_f32_dpp v119, v119, v119 row_ror:4 row_mask:0xf bank_mask:0xf
    v_add_f32_dpp v120, v120, v120 row_ror:4 row_mask:0xf bank_mask:0xf
    v_add_f32_dpp v121, v121, v121 row_ror:4 row_mask:0xf bank_mask:0xf
    v_add_f32_dpp v122, v122, v122 row_ror:4 row_mask:0xf bank_mask:0xf
    v_add_f32_dpp v123, v123, v123 row_ror:4 row_mask:0xf bank_mask:0xf
    v_add_f32_dpp v108, v108, v108 row_ror:2 row_mask:0xf bank_mask:0xf
    v_add_f32_dpp v109, v109, v109 row_ror:2 row_mask:0xf bank_mask:0xf
    v_add_f32_dpp v110, v110, v110 row_ror:2 row_mask:0xf bank_mask:0xf
    v_add_f32_dpp v111, v111, v111 row_ror:2 row_mask:0xf bank_mask:0xf
    v_add_f32_dpp v112, v112, v112 row_ror:2 row_mask:0xf bank_mask:0xf
    v_add_f32_dpp v113, v113, v113 row_ror:2 row_mask:0xf bank_mask:0xf
    v_add_f32_dpp v114, v114, v114 row_ror:2 row_mask:0xf bank_mask:0xf
    v_add_f32_dpp v115, v115, v115 row_ror:2 row_mask:0xf bank_mask:0xf
    v_add_f32_dpp v116, v116, v116 row_ror:2 row_mask:0xf bank_mask:0xf
    v_add_f32_dpp v117, v117, v117 row_ror:2 row_mask:0xf bank_mask:0xf
    v_add_f32_dpp v118, v118, v118 row_ror:2 row_mask:0xf bank_mask:0xf
    v_add_f32_dpp v119, v119, v119 row_ror:2 row_mask:0xf bank_mask:0xf
    v_add_f32_dpp v120, v120, v120 row_ror:2 row_mask:0xf bank_mask:0xf
    v_add_f32_dpp v121, v121, v121 row_ror:2 row_mask:0xf bank_mask:0xf
    v_add_f32_dpp v122, v122, v122 row_ror:2 row_mask:0xf bank_mask:0xf
    v_add_f32_dpp v123, v123, v123 row_ror:2 row_mask:0xf bank_mask:0xf
    v_add_f32_dpp v108, v108, v108 row_ror:1 row_mask:0xf bank_mask:0xf
    v_add_f32_dpp v109, v109, v109 row_ror:1 row_mask:0xf bank_mask:0xf
    v_add_f32_dpp v110, v110, v110 row_ror:1 row_mask:0xf bank_mask:0xf
    v_add_f32_dpp v111, v111, v111 row_ror:1 row_mask:0xf bank_mask:0xf
    v_add_f32_dpp v112, v112, v112 row_ror:1 row_mask:0xf bank_mask:0xf
    v_add_f32_dpp v113, v113, v113 row_ror:1 row_mask:0xf bank_mask:0xf
    v_add_f32_dpp v114, v114, v114 row_ror:1 row_mask:0xf bank_mask:0xf
    v_add_f32_dpp v115, v115, v115 row_ror:1 row_mask:0xf bank_mask:0xf
    v_add_f32_dpp v116, v116, v116 row_ror:1 row_mask:0xf bank_mask:0xf
    v_add_f32_dpp v117, v117, v117 row_ror:1 row_mask:0xf bank_mask:0xf
    v_add_f32_dpp v118, v118, v118 row_ror:1 row_mask:0xf bank_mask:0xf
    v_add_f32_dpp v119, v119, v119 row_ror:1 row_mask:0xf bank_mask:0xf
    v_add_f32_dpp v120, v120, v120 row_ror:1 row_mask:0xf bank_mask:0xf
    v_add_f32_dpp v121, v121, v121 row_ror:1 row_mask:0xf bank_mask:0xf
    v_add_f32_dpp v122, v122, v122 row_ror:1 row_mask:0xf bank_mask:0xf
    v_add_f32_dpp v123, v123, v123 row_ror:1 row_mask:0xf bank_mask:0xf
    v_and_b32 v181, 15, v254
    v_add_u32 v187, 3328, v180
    v_cmp_eq_u32 vcc, 0, v181
    s_and_saveexec_b64 s[44:45], vcc
    ds_write_b128 v187, v[108:111] offset:0
    ds_write_b128 v187, v[116:119] offset:512
    ds_write_b128 v187, v[112:115] offset:64
    ds_write_b128 v187, v[120:123] offset:576
    s_mov_b64 exec, s[44:45]
    v_and_b32 v182, 31, v254
    s_lshl_b32 s20, s18, 5
    v_add_u32 v182, s20, v182
    v_lshlrev_b32 v186, 2, v182
    v_add_u32 v186, 142592, v186
    v_lshlrev_b32 v182, 3, v182
    s_waitcnt lgkmcnt(0)
    ds_read_b32 v124, v186
    ds_read_b32 v125, v186 offset:512
    s_add_u32 s26, s6, 24117248
    s_addc_u32 s27, s7, 0
    s_mov_b32 s36, s26
    s_and_b32 s37, s27, 0xffff
    s_mov_b32 s38, 262144
    s_mov_b32 s39, 0x20000
    s_waitcnt vmcnt(5)
    s_barrier
    s_mov_b32 s41, 313344
    s_add_u32 m0, s23, 51200
    s_nop 0
    buffer_load_dwordx4 v250, s[32:35], s41 offen lds
    buffer_load_dwordx4 v250, s[32:35], s41 offen offset:1024 lds
    buffer_load_dwordx4 v250, s[32:35], s41 offen offset:2048 lds
    buffer_load_dwordx4 v250, s[32:35], s41 offen offset:3072 lds
    s_add_u32 m0, s24, 67584
    s_mov_b32 exec_hi, 0
    buffer_load_dwordx4 v251, s[32:35], s41 offen lds
    s_mov_b32 exec_hi, -1
    s_lshl_b32 s20, s12, 4
    s_add_u32 s21, s20, s14
    s_lshl_b32 s21, s21, 10
    v_cmp_gt_u32 vcc, 32, v254
    s_and_saveexec_b64 s[44:45], vcc
    s_waitcnt lgkmcnt(0)
    buffer_store_dwordx2 v[124:125], v182, s[36:39], s21 offen sc1
    s_mov_b64 exec, s[44:45]
    s_mov_b32 s42, 0
    s_add_u32 m0, s23, 69632
    s_nop 0
    buffer_load_dwordx4 v246, s[28:31], s42 offen offset:0 lds
    buffer_load_dwordx4 v247, s[28:31], s42 offen offset:1024 lds
    buffer_load_dwordx4 v248, s[28:31], s42 offen offset:2048 lds
    buffer_load_dwordx4 v249, s[28:31], s42 offen offset:3072 lds
    s_mov_b32 s42, 128
    s_add_u32 m0, s23, 104448
    s_nop 0
    buffer_load_dwordx4 v246, s[28:31], s42 offen offset:0 lds
    buffer_load_dwordx4 v247, s[28:31], s42 offen offset:1024 lds
    buffer_load_dwordx4 v248, s[28:31], s42 offen offset:2048 lds
    buffer_load_dwordx4 v249, s[28:31], s42 offen offset:3072 lds
    s_waitcnt vmcnt(14)
    s_barrier
    s_mov_b32 s42, 256
    s_add_u32 m0, s23, 0
    s_nop 0
    buffer_load_dwordx4 v246, s[28:31], s42 offen offset:0 lds
    buffer_load_dwordx4 v247, s[28:31], s42 offen offset:1024 lds
    buffer_load_dwordx4 v248, s[28:31], s42 offen offset:2048 lds
    buffer_load_dwordx4 v249, s[28:31], s42 offen offset:3072 lds
    s_mov_b32 s42, 384
    s_add_u32 m0, s23, 34816
    s_nop 0
    buffer_load_dwordx4 v246, s[28:31], s42 offen offset:0 lds
    buffer_load_dwordx4 v247, s[28:31], s42 offen offset:1024 lds
    buffer_load_dwordx4 v248, s[28:31], s42 offen offset:2048 lds
    buffer_load_dwordx4 v249, s[28:31], s42 offen offset:3072 lds
    s_waitcnt vmcnt(17)
    s_barrier
    s_barrier
    s_mul_i32 s20, s14, 589824
    s_add_u32 s20, s20, 35651584
    s_add_u32 s26, s6, s20
    s_addc_u32 s27, s7, 0
    s_mov_b32 s32, s26
    s_and_b32 s33, s27, 0xffff
    s_mov_b32 s34, 589824
    s_mov_b32 s35, 0x20000
    s_lshl_b32 s20, s12, 4
    s_lshl_b32 s20, s20, 10
    v_lshrrev_b32 v183, 5, v254
    v_lshlrev_b32 v183, 13, v183
    v_add_u32 v183, v183, v182
    v_add_u32 v184, 4096, v183
    s_mov_b32 s49, 0
    s_mov_b32 s48, 0xbf800000
back_kernel_poll:
    buffer_load_dwordx2 v[124:125], v183, s[36:39], s20 offen offset:0 sc1
    buffer_load_dwordx2 v[126:127], v183, s[36:39], s20 offen offset:1024 sc1
    buffer_load_dwordx2 v[128:129], v183, s[36:39], s20 offen offset:2048 sc1
    buffer_load_dwordx2 v[130:131], v183, s[36:39], s20 offen offset:3072 sc1
    buffer_load_dwordx2 v[132:133], v184, s[36:39], s20 offen offset:0 sc1
    buffer_load_dwordx2 v[134:135], v184, s[36:39], s20 offen offset:1024 sc1
    buffer_load_dwordx2 v[136:137], v184, s[36:39], s20 offen offset:2048 sc1
    buffer_load_dwordx2 v[138:139], v184, s[36:39], s20 offen offset:3072 sc1
    s_waitcnt vmcnt(0)
    v_cmp_eq_u32 vcc, s48, v125
    v_cmp_eq_u32 s[50:51], s48, v127
    s_or_b64 vcc, vcc, s[50:51]
    v_cmp_eq_u32 s[50:51], s48, v129
    s_or_b64 vcc, vcc, s[50:51]
    v_cmp_eq_u32 s[50:51], s48, v131
    s_or_b64 vcc, vcc, s[50:51]
    v_cmp_eq_u32 s[50:51], s48, v133
    s_or_b64 vcc, vcc, s[50:51]
    v_cmp_eq_u32 s[50:51], s48, v135
    s_or_b64 vcc, vcc, s[50:51]
    v_cmp_eq_u32 s[50:51], s48, v137
    s_or_b64 vcc, vcc, s[50:51]
    v_cmp_eq_u32 s[50:51], s48, v139
    s_or_b64 vcc, vcc, s[50:51]
    s_cmp_eq_u64 vcc, 0
    s_cbranch_scc1 back_kernel_got
    s_add_u32 s49, s49, 1
    s_cmp_lt_u32 s49, 0x40000
    s_cbranch_scc0 back_kernel_got
    s_sleep 1
    s_branch back_kernel_poll
back_kernel_got:
    v_pk_add_f32 v[124:125], v[124:125], v[126:127]
    v_pk_add_f32 v[124:125], v[124:125], v[128:129]
    v_pk_add_f32 v[124:125], v[124:125], v[130:131]
    v_pk_add_f32 v[124:125], v[124:125], v[132:133]
    v_pk_add_f32 v[124:125], v[124:125], v[134:135]
    v_pk_add_f32 v[124:125], v[124:125], v[136:137]
    v_pk_add_f32 v[124:125], v[124:125], v[138:139]
    v_mov_b32 v126, v124
    v_mov_b32 v127, v125
    s_nop 1
    v_permlane32_swap_b32 v124, v126
    v_permlane32_swap_b32 v125, v127
    s_nop 1
    v_add_f32 v124, v124, v126
    v_add_f32 v125, v125, v127
    v_mul_f32 v124, 0x39e38e39, v124
    v_mul_f32 v125, 0x39e38e39, v125
    v_fma_f32 v125, -v124, v124, v125
    v_max_f32 v125, 0, v125
    v_add_f32 v125, 0x361367a4, v125
    v_rsq_f32 v126, v125
    s_nop 0
    v_mul_f32 v127, v126, v124
    v_sub_f32 v127, 0, v127
    v_add_u32 v186, 1024, v186
    ds_write_b32 v186, v126
    ds_write_b32 v186, v127 offset:512
    v_add_u32 v187, 4352, v180
    s_waitcnt lgkmcnt(0)
    ds_read_b128 v[72:75], v187 offset:0
    ds_read_b128 v[80:83], v187 offset:512
    ds_read_b128 v[76:79], v187 offset:64
    ds_read_b128 v[84:87], v187 offset:576
    s_add_u32 s26, s6, 35651584
    s_addc_u32 s27, s7, 0
    s_mov_b32 s36, s26
    s_and_b32 s37, s27, 0xffff
    s_mov_b32 s38, 9437184
    s_mov_b32 s39, 0x20000
    s_lshl_b32 s20, s14, 6
    s_lshl_b32 s21, s12, 2
    s_add_u32 s20, s20, s21
    s_add_u32 s20, s20, s18
    s_mul_i32 s20, s20, 9216
    v_lshlrev_b32 v185, 4, v254
    s_waitcnt lgkmcnt(0)
    v_pk_fma_f32 v[0:1], v[0:1], v[72:73], v[80:81]
    v_pk_fma_f32 v[2:3], v[2:3], v[74:75], v[82:83]
    v_pk_fma_f32 v[4:5], v[4:5], v[76:77], v[84:85]
    v_pk_fma_f32 v[6:7], v[6:7], v[78:79], v[86:87]
    v_cvt_pk_bf16_f32 v108, v0, v1
    v_cvt_pk_bf16_f32 v109, v2, v3
    v_cvt_pk_bf16_f32 v110, v4, v5
    v_cvt_pk_bf16_f32 v111, v6, v7
    s_nop 1
    v_permlane32_swap_b32 v108, v110
    v_permlane32_swap_b32 v109, v111
    s_nop 1
    v_permlane16_swap_b32 v108, v110
    v_permlane16_swap_b32 v109, v111
    s_nop 0
    buffer_store_dwordx4 v[108:111], v185, s[36:39], s20 offen offset:0 sc1
    v_pk_fma_f32 v[8:9], v[8:9], v[72:73], v[80:81]
    v_pk_fma_f32 v[10:11], v[10:11], v[74:75], v[82:83]
    v_pk_fma_f32 v[12:13], v[12:13], v[76:77], v[84:85]
    v_pk_fma_f32 v[14:15], v[14:15], v[78:79], v[86:87]
    v_cvt_pk_bf16_f32 v112, v8, v9
    v_cvt_pk_bf16_f32 v113, v10, v11
    v_cvt_pk_bf16_f32 v114, v12, v13
    v_cvt_pk_bf16_f32 v115, v14, v15
    s_nop 1
    v_permlane32_swap_b32 v112, v114
    v_permlane32_swap_b32 v113, v115
    s_nop 1
    v_permlane16_swap_b32 v112, v114
    v_permlane16_swap_b32 v113, v115
    s_nop 0
    buffer_store_dwordx4 v[112:115], v185, s[36:39], s20 offen offset:1024 sc1
    v_pk_fma_f32 v[16:17], v[16:17], v[72:73], v[80:81]
    v_pk_fma_f32 v[18:19], v[18:19], v[74:75], v[82:83]
    v_pk_fma_f32 v[20:21], v[20:21], v[76:77], v[84:85]
    v_pk_fma_f32 v[22:23], v[22:23], v[78:79], v[86:87]
    v_cvt_pk_bf16_f32 v116, v16, v17
    v_cvt_pk_bf16_f32 v117, v18, v19
    v_cvt_pk_bf16_f32 v118, v20, v21
    v_cvt_pk_bf16_f32 v119, v22, v23
    s_nop 1
    v_permlane32_swap_b32 v116, v118
    v_permlane32_swap_b32 v117, v119
    s_nop 1
    v_permlane16_swap_b32 v116, v118
    v_permlane16_swap_b32 v117, v119
    s_nop 0
    buffer_store_dwordx4 v[116:119], v185, s[36:39], s20 offen offset:2048 sc1
    v_pk_fma_f32 v[24:25], v[24:25], v[72:73], v[80:81]
    v_pk_fma_f32 v[26:27], v[26:27], v[74:75], v[82:83]
    v_pk_fma_f32 v[28:29], v[28:29], v[76:77], v[84:85]
    v_pk_fma_f32 v[30:31], v[30:31], v[78:79], v[86:87]
    v_cvt_pk_bf16_f32 v120, v24, v25
    v_cvt_pk_bf16_f32 v121, v26, v27
    v_cvt_pk_bf16_f32 v122, v28, v29
    v_cvt_pk_bf16_f32 v123, v30, v31
    s_nop 1
    v_permlane32_swap_b32 v120, v122
    v_permlane32_swap_b32 v121, v123
    s_nop 1
    v_permlane16_swap_b32 v120, v122
    v_permlane16_swap_b32 v121, v123
    s_nop 0
    buffer_store_dwordx4 v[120:123], v185, s[36:39], s20 offen offset:3072 sc1
    v_pk_fma_f32 v[32:33], v[32:33], v[72:73], v[80:81]
    v_pk_fma_f32 v[34:35], v[34:35], v[74:75], v[82:83]
    v_pk_fma_f32 v[36:37], v[36:37], v[76:77], v[84:85]
    v_pk_fma_f32 v[38:39], v[38:39], v[78:79], v[86:87]
    v_cvt_pk_bf16_f32 v108, v32, v33
    v_cvt_pk_bf16_f32 v109, v34, v35
    v_cvt_pk_bf16_f32 v110, v36, v37
    v_cvt_pk_bf16_f32 v111, v38, v39
    s_nop 1
    v_permlane32_swap_b32 v108, v110
    v_permlane32_swap_b32 v109, v111
    s_nop 1
    v_permlane16_swap_b32 v108, v110
    v_permlane16_swap_b32 v109, v111
    s_add_u32 s20, s20, 4096
    s_nop 0
    buffer_store_dwordx4 v[108:111], v185, s[36:39], s20 offen offset:0 sc1
    v_pk_fma_f32 v[40:41], v[40:41], v[72:73], v[80:81]
    v_pk_fma_f32 v[42:43], v[42:43], v[74:75], v[82:83]
    v_pk_fma_f32 v[44:45], v[44:45], v[76:77], v[84:85]
    v_pk_fma_f32 v[46:47], v[46:47], v[78:79], v[86:87]
    v_cvt_pk_bf16_f32 v112, v40, v41
    v_cvt_pk_bf16_f32 v113, v42, v43
    v_cvt_pk_bf16_f32 v114, v44, v45
    v_cvt_pk_bf16_f32 v115, v46, v47
    s_nop 1
    v_permlane32_swap_b32 v112, v114
    v_permlane32_swap_b32 v113, v115
    s_nop 1
    v_permlane16_swap_b32 v112, v114
    v_permlane16_swap_b32 v113, v115
    s_nop 0
    buffer_store_dwordx4 v[112:115], v185, s[36:39], s20 offen offset:1024 sc1
    v_pk_fma_f32 v[48:49], v[48:49], v[72:73], v[80:81]
    v_pk_fma_f32 v[50:51], v[50:51], v[74:75], v[82:83]
    v_pk_fma_f32 v[52:53], v[52:53], v[76:77], v[84:85]
    v_pk_fma_f32 v[54:55], v[54:55], v[78:79], v[86:87]
    v_cvt_pk_bf16_f32 v116, v48, v49
    v_cvt_pk_bf16_f32 v117, v50, v51
    v_cvt_pk_bf16_f32 v118, v52, v53
    v_cvt_pk_bf16_f32 v119, v54, v55
    s_nop 1
    v_permlane32_swap_b32 v116, v118
    v_permlane32_swap_b32 v117, v119
    s_nop 1
    v_permlane16_swap_b32 v116, v118
    v_permlane16_swap_b32 v117, v119
    s_nop 0
    buffer_store_dwordx4 v[116:119], v185, s[36:39], s20 offen offset:2048 sc1
    v_pk_fma_f32 v[56:57], v[56:57], v[72:73], v[80:81]
    v_pk_fma_f32 v[58:59], v[58:59], v[74:75], v[82:83]
    v_pk_fma_f32 v[60:61], v[60:61], v[76:77], v[84:85]
    v_pk_fma_f32 v[62:63], v[62:63], v[78:79], v[86:87]
    v_cvt_pk_bf16_f32 v120, v56, v57
    v_cvt_pk_bf16_f32 v121, v58, v59
    v_cvt_pk_bf16_f32 v122, v60, v61
    v_cvt_pk_bf16_f32 v123, v62, v63
    s_nop 1
    v_permlane32_swap_b32 v120, v122
    v_permlane32_swap_b32 v121, v123
    s_nop 1
    v_permlane16_swap_b32 v120, v122
    v_permlane16_swap_b32 v121, v123
    s_nop 0
    buffer_store_dwordx4 v[120:123], v185, s[36:39], s20 offen offset:3072 sc1
    v_pk_fma_f32 v[64:65], v[64:65], v[72:73], v[80:81]
    v_pk_fma_f32 v[66:67], v[66:67], v[74:75], v[82:83]
    v_pk_fma_f32 v[68:69], v[68:69], v[76:77], v[84:85]
    v_pk_fma_f32 v[70:71], v[70:71], v[78:79], v[86:87]
    v_cvt_pk_bf16_f32 v108, v64, v65
    v_cvt_pk_bf16_f32 v109, v66, v67
    v_cvt_pk_bf16_f32 v110, v68, v69
    v_cvt_pk_bf16_f32 v111, v70, v71
    s_nop 1
    v_permlane32_swap_b32 v108, v110
    v_permlane32_swap_b32 v109, v111
    s_nop 1
    v_permlane16_swap_b32 v108, v110
    v_permlane16_swap_b32 v109, v111
    s_add_u32 s20, s20, 4096
    s_nop 0
    buffer_store_dwordx4 v[108:111], v185, s[36:39], s20 offen offset:0 sc1
    s_waitcnt vmcnt(0)
    s_barrier
    s_lshl_b32 s42, s14, 6
    s_lshl_b32 s43, s12, 2
    s_add_u32 s43, s43, s42
    s_cmp_eq_u32 s18, 0
    s_cbranch_scc0 back_kernel_nf1
    v_mov_b32 v3, s43
    v_mov_b32 v4, 1
    s_mov_b64 s[44:45], exec
    s_mov_b64 exec, 1
    global_store_dword v3, v4, s[58:59] sc1
    s_mov_b64 exec, s[44:45]
back_kernel_nf1:
    s_cmp_eq_u32 s18, 0
    s_cbranch_scc0 back_kernel_np1
    v_and_b32 v3, 15, v254
    v_lshlrev_b32 v3, 2, v3
    v_add_u32 v3, s42, v3
    s_mov_b32 s46, 0
back_kernel_p1:
    v_mov_b32 v5, 0
    s_mov_b64 s[44:45], exec
    s_mov_b64 exec, 0xffff
    global_atomic_add v4, v3, v5, s[58:59] sc0 sc1
    s_mov_b64 exec, s[44:45]
    s_waitcnt vmcnt(0)
    s_nop 0
    v_cmp_eq_u32 vcc, 0, v4
    s_and_b64 vcc, vcc, 0xffff
    s_nop 1
    s_cmp_eq_u64 vcc, 0
    s_cbranch_scc1 back_kernel_p1_ok
    s_add_u32 s46, s46, 1
    s_cmp_lt_u32 s46, 0x40000
    s_cbranch_scc0 back_kernel_p1_ok
    s_sleep 4
    s_branch back_kernel_p1
back_kernel_p1_ok:
back_kernel_np1:
    s_barrier
    s_mov_b32 s43, 0
    s_add_u32 m0, s23, 86016
    s_nop 0
    buffer_load_dwordx4 v250, s[32:35], s43 offen offset:0 sc1 lds
    buffer_load_dwordx4 v250, s[32:35], s43 offen offset:1024 sc1 lds
    buffer_load_dwordx4 v250, s[32:35], s43 offen offset:2048 sc1 lds
    buffer_load_dwordx4 v250, s[32:35], s43 offen offset:3072 sc1 lds
    s_add_u32 m0, s24, 102400
    s_mov_b32 exec_hi, 0
    buffer_load_dwordx4 v251, s[32:35], s43 offen sc1 lds
    s_mov_b32 exec_hi, -1
    s_mov_b32 s43, 18432
    s_add_u32 m0, s23, 120832
    s_nop 0
    buffer_load_dwordx4 v250, s[32:35], s43 offen offset:0 sc1 lds
    buffer_load_dwordx4 v250, s[32:35], s43 offen offset:1024 sc1 lds
    buffer_load_dwordx4 v250, s[32:35], s43 offen offset:2048 sc1 lds
    buffer_load_dwordx4 v250, s[32:35], s43 offen offset:3072 sc1 lds
    s_add_u32 m0, s24, 137216
    s_mov_b32 exec_hi, 0
    buffer_load_dwordx4 v251, s[32:35], s43 offen sc1 lds
    s_mov_b32 exec_hi, -1
    s_mov_b32 s43, 36864
    s_add_u32 m0, s23, 16384
    s_nop 0
    buffer_load_dwordx4 v250, s[32:35], s43 offen offset:0 sc1 lds
    buffer_load_dwordx4 v250, s[32:35], s43 offen offset:1024 sc1 lds
    buffer_load_dwordx4 v250, s[32:35], s43 offen offset:2048 sc1 lds
    buffer_load_dwordx4 v250, s[32:35], s43 offen offset:3072 sc1 lds
    s_add_u32 m0, s24, 32768
    s_mov_b32 exec_hi, 0
    buffer_load_dwordx4 v251, s[32:35], s43 offen sc1 lds
    s_mov_b32 exec_hi, -1
    s_mov_b32 s43, 55296
    s_add_u32 m0, s23, 51200
    s_nop 0
    buffer_load_dwordx4 v250, s[32:35], s43 offen offset:0 sc1 lds
    buffer_load_dwordx4 v250, s[32:35], s43 offen offset:1024 sc1 lds
    buffer_load_dwordx4 v250, s[32:35], s43 offen offset:2048 sc1 lds
    buffer_load_dwordx4 v250, s[32:35], s43 offen offset:3072 sc1 lds
    s_add_u32 m0, s24, 67584
    s_mov_b32 exec_hi, 0
    buffer_load_dwordx4 v251, s[32:35], s43 offen sc1 lds
    s_mov_b32 exec_hi, -1
    s_waitcnt vmcnt(15)
    s_barrier
    s_mov_b32 s42, 512
    s_mov_b32 s43, 73728
    s_waitcnt vmcnt(10)
    s_barrier
    s_add_u32 m0, s23, 69632
    s_nop 0
    buffer_load_dwordx4 v246, s[28:31], s42 offen offset:0 lds
    buffer_load_dwordx4 v247, s[28:31], s42 offen offset:1024 lds
    buffer_load_dwordx4 v248, s[28:31], s42 offen offset:2048 lds
    buffer_load_dwordx4 v249, s[28:31], s42 offen offset:3072 lds
    s_add_u32 m0, s23, 86016
    s_nop 0
    buffer_load_dwordx4 v250, s[32:35], s43 offen offset:0 sc1 lds
    buffer_load_dwordx4 v250, s[32:35], s43 offen offset:1024 sc1 lds
    buffer_load_dwordx4 v250, s[32:35], s43 offen offset:2048 sc1 lds
    buffer_load_dwordx4 v250, s[32:35], s43 offen offset:3072 sc1 lds
    s_add_u32 m0, s24, 102400
    s_mov_b32 exec_hi, 0
    buffer_load_dwordx4 v251, s[32:35], s43 offen sc1 lds
    s_mov_b32 exec_hi, -1
    s_add_u32 s42, s42, 128
    s_add_u32 s43, s43, 18432
    s_waitcnt vmcnt(14)
    s_barrier
    s_add_u32 m0, s23, 104448
    s_nop 0
    buffer_load_dwordx4 v246, s[28:31], s42 offen offset:0 lds
    buffer_load_dwordx4 v247, s[28:31], s42 offen offset:1024 lds
    buffer_load_dwordx4 v248, s[28:31], s42 offen offset:2048 lds
    buffer_load_dwordx4 v249, s[28:31], s42 offen offset:3072 lds
    s_add_u32 m0, s23, 120832
    s_nop 0
    buffer_load_dwordx4 v250, s[32:35], s43 offen offset:0 sc1 lds
    buffer_load_dwordx4 v250, s[32:35], s43 offen offset:1024 sc1 lds
    buffer_load_dwordx4 v250, s[32:35], s43 offen offset:2048 sc1 lds
    buffer_load_dwordx4 v250, s[32:35], s43 offen offset:3072 sc1 lds
    s_add_u32 m0, s24, 137216
    s_mov_b32 exec_hi, 0
    buffer_load_dwordx4 v251, s[32:35], s43 offen sc1 lds
    s_mov_b32 exec_hi, -1
    s_add_u32 s42, s42, 128
    s_add_u32 s43, s43, 18432
    s_mov_b32 s40, 0
back_kernel_lloop:
    s_waitcnt vmcnt(18)
    s_barrier
    s_add_u32 m0, s23, 0
    s_nop 0
    buffer_load_dwordx4 v246, s[28:31], s42 offen offset:0 lds
    buffer_load_dwordx4 v247, s[28:31], s42 offen offset:1024 lds
    buffer_load_dwordx4 v248, s[28:31], s42 offen offset:2048 lds
    buffer_load_dwordx4 v249, s[28:31], s42 offen offset:3072 lds
    s_add_u32 m0, s23, 16384
    s_nop 0
    buffer_load_dwordx4 v250, s[32:35], s43 offen offset:0 sc1 lds
    buffer_load_dwordx4 v250, s[32:35], s43 offen offset:1024 sc1 lds
    buffer_load_dwordx4 v250, s[32:35], s43 offen offset:2048 sc1 lds
    buffer_load_dwordx4 v250, s[32:35], s43 offen offset:3072 sc1 lds
    s_add_u32 m0, s24, 32768
    s_mov_b32 exec_hi, 0
    buffer_load_dwordx4 v251, s[32:35], s43 offen sc1 lds
    s_mov_b32 exec_hi, -1
    s_add_u32 s42, s42, 128
    s_add_u32 s43, s43, 18432
    s_waitcnt vmcnt(18)
    s_barrier
    s_add_u32 m0, s23, 34816
    s_nop 0
    buffer_load_dwordx4 v246, s[28:31], s42 offen offset:0 lds
    buffer_load_dwordx4 v247, s[28:31], s42 offen offset:1024 lds
    buffer_load_dwordx4 v248, s[28:31], s42 offen offset:2048 lds
    buffer_load_dwordx4 v249, s[28:31], s42 offen offset:3072 lds
    s_add_u32 m0, s23, 51200
    s_nop 0
    buffer_load_dwordx4 v250, s[32:35], s43 offen offset:0 sc1 lds
    buffer_load_dwordx4 v250, s[32:35], s43 offen offset:1024 sc1 lds
    buffer_load_dwordx4 v250, s[32:35], s43 offen offset:2048 sc1 lds
    buffer_load_dwordx4 v250, s[32:35], s43 offen offset:3072 sc1 lds
    s_add_u32 m0, s24, 67584
    s_mov_b32 exec_hi, 0
    buffer_load_dwordx4 v251, s[32:35], s43 offen sc1 lds
    s_mov_b32 exec_hi, -1
    s_add_u32 s42, s42, 128
    s_add_u32 s43, s43, 18432
    s_waitcnt vmcnt(18)
    s_barrier
    s_add_u32 m0, s23, 69632
    s_nop 0
    buffer_load_dwordx4 v246, s[28:31], s42 offen offset:0 lds
    buffer_load_dwordx4 v247, s[28:31], s42 offen offset:1024 lds
    buffer_load_dwordx4 v248, s[28:31], s42 offen offset:2048 lds
    buffer_load_dwordx4 v249, s[28:31], s42 offen offset:3072 lds
    s_add_u32 m0, s23, 86016
    s_nop 0
    buffer_load_dwordx4 v250, s[32:35], s43 offen offset:0 sc1 lds
    buffer_load_dwordx4 v250, s[32:35], s43 offen offset:1024 sc1 lds
    buffer_load_dwordx4 v250, s[32:35], s43 offen offset:2048 sc1 lds
    buffer_load_dwordx4 v250, s[32:35], s43 offen offset:3072 sc1 lds
    s_add_u32 m0, s24, 102400
    s_mov_b32 exec_hi, 0
    buffer_load_dwordx4 v251, s[32:35], s43 offen sc1 lds
    s_mov_b32 exec_hi, -1
    s_add_u32 s42, s42, 128
    s_add_u32 s43, s43, 18432
    s_waitcnt vmcnt(18)
    s_barrier
    s_add_u32 m0, s23, 104448
    s_nop 0
    buffer_load_dwordx4 v246, s[28:31], s42 offen offset:0 lds
    buffer_load_dwordx4 v247, s[28:31], s42 offen offset:1024 lds
    buffer_load_dwordx4 v248, s[28:31], s42 offen offset:2048 lds
    buffer_load_dwordx4 v249, s[28:31], s42 offen offset:3072 lds
    s_add_u32 m0, s23, 120832
    s_nop 0
    buffer_load_dwordx4 v250, s[32:35], s43 offen offset:0 sc1 lds
    buffer_load_dwordx4 v250, s[32:35], s43 offen offset:1024 sc1 lds
    buffer_load_dwordx4 v250, s[32:35], s43 offen offset:2048 sc1 lds
    buffer_load_dwordx4 v250, s[32:35], s43 offen offset:3072 sc1 lds
    s_add_u32 m0, s24, 137216
    s_mov_b32 exec_hi, 0
    buffer_load_dwordx4 v251, s[32:35], s43 offen sc1 lds
    s_mov_b32 exec_hi, -1
    s_add_u32 s42, s42, 128
    s_add_u32 s43, s43, 18432
    s_add_u32 s40, s40, 1
    s_cmp_lt_u32 s40, 6
    s_cbranch_scc1 back_kernel_lloop
    s_waitcnt vmcnt(18)
    s_barrier
    s_add_u32 m0, s23, 0
    s_nop 0
    buffer_load_dwordx4 v246, s[28:31], s42 offen offset:0 lds
    buffer_load_dwordx4 v247, s[28:31], s42 offen offset:1024 lds
    buffer_load_dwordx4 v248, s[28:31], s42 offen offset:2048 lds
    buffer_load_dwordx4 v249, s[28:31], s42 offen offset:3072 lds
    s_add_u32 m0, s23, 16384
    s_nop 0
    buffer_load_dwordx4 v250, s[32:35], s43 offen offset:0 sc1 lds
    buffer_load_dwordx4 v250, s[32:35], s43 offen offset:1024 sc1 lds
    buffer_load_dwordx4 v250, s[32:35], s43 offen offset:2048 sc1 lds
    buffer_load_dwordx4 v250, s[32:35], s43 offen offset:3072 sc1 lds
    s_add_u32 m0, s24, 32768
    s_mov_b32 exec_hi, 0
    buffer_load_dwordx4 v251, s[32:35], s43 offen sc1 lds
    s_mov_b32 exec_hi, -1
    s_add_u32 s42, s42, 128
    s_add_u32 s43, s43, 18432
    s_waitcnt vmcnt(18)
    s_barrier
    s_add_u32 m0, s23, 34816
    s_nop 0
    buffer_load_dwordx4 v246, s[28:31], s42 offen offset:0 lds
    buffer_load_dwordx4 v247, s[28:31], s42 offen offset:1024 lds
    buffer_load_dwordx4 v248, s[28:31], s42 offen offset:2048 lds
    buffer_load_dwordx4 v249, s[28:31], s42 offen offset:3072 lds
    s_add_u32 m0, s23, 51200
    s_nop 0
    buffer_load_dwordx4 v250, s[32:35], s43 offen offset:0 sc1 lds
    buffer_load_dwordx4 v250, s[32:35], s43 offen offset:1024 sc1 lds
    buffer_load_dwordx4 v250, s[32:35], s43 offen offset:2048 sc1 lds
    buffer_load_dwordx4 v250, s[32:35], s43 offen offset:3072 sc1 lds
    s_add_u32 m0, s24, 67584
    s_mov_b32 exec_hi, 0
    buffer_load_dwordx4 v251, s[32:35], s43 offen sc1 lds
    s_mov_b32 exec_hi, -1
    s_add_u32 s42, s42, 128
    s_add_u32 s43, s43, 18432
    s_waitcnt vmcnt(18)
    s_barrier
    s_waitcnt vmcnt(9)
    s_barrier
    s_waitcnt vmcnt(0)
    s_barrier
    s_barrier
    s_lshr_b32 s20, s14, 3
    s_lshl_b32 s12, s12, 1
    s_add_u32 s12, s12, s20
    s_and_b32 s13, s14, 7
    v_lshlrev_b32 v192, 4, v254
    v_add_u32 v188, 0, v192
    v_add_u32 v189, 73728, v192
    v_add_u32 v190, 147456, v192
    v_add_u32 v191, 221184, v192
    v_lshlrev_b32 v3, 3, v254
    v_add_u32 v248, 0, v3
    v_add_u32 v249, 73728, v3
    v_add_u32 v250, 147456, v3
    v_add_u32 v251, 221184, v3
    v_and_b32 v3, 15, v254
    v_add_u32 v4, 4096, v192
    v_mov_b32 v5, 0x40000000
    v_cmp_gt_u32 vcc, 8, v3
    s_nop 1
    v_cndmask_b32 v193, v5, v4, vcc
    s_mul_i32 s20, s12, 294912
    s_add_u32 s20, s20, 46137344
    s_add_u32 s26, s6, s20
    s_addc_u32 s27, s7, 0
    s_mov_b32 s28, s26
    s_and_b32 s29, s27, 0xffff
    s_mov_b32 s30, 294912
    s_mov_b32 s31, 0x20000
    s_mul_i32 s20, s13, 368640
    s_add_u32 s20, s20, 12582912
    s_add_u32 s26, s6, s20
    s_addc_u32 s27, s7, 0
    s_mov_b32 s32, s26
    s_and_b32 s33, s27, 0xffff
    s_mov_b32 s34, 368640
    s_mov_b32 s35, 0x20000
    s_mul_i32 s40, s18, 18432
    s_mul_i32 s41, s18, 92160
    s_add_u32 s26, s6, 9437184
    s_addc_u32 s27, s7, 0
    s_mov_b32 s36, s26
    s_and_b32 s37, s27, 0xffff
    s_mov_b32 s38, 2359296
    s_mov_b32 s39, 0x20000
    s_add_u32 s26, s6, 0
    s_addc_u32 s27, s7, 0
    s_mov_b32 s48, s26
    s_and_b32 s49, s27, 0xffff
    s_mov_b32 s50, 13824
    s_mov_b32 s51, 0x20000
    s_mov_b32 s52, 11520
    v_mov_b32 v212, v254
    s_add_u32 s20, s18, 0
    v_mov_b32 v217, s20
    s_mul_i32 s20, s13, 72
    v_add_u32 v3, s20, v212
    v_lshlrev_b32 v4, 12, v3
    s_lshl_b32 s21, s12, 7
    v_lshlrev_b32 v5, 3, v217
    v_add3_u32 v4, v4, v5, s21
    v_lshlrev_b32 v3, 2, v3
    buffer_load_dwordx2 v[196:197], v4, s[36:39], 0 offen
    buffer_load_dword v206, v3, s[48:51], s52 offen
    v_mov_b32 v213, v254
    s_add_u32 s20, s18, 4
    v_mov_b32 v218, s20
    s_mul_i32 s20, s13, 72
    v_add_u32 v3, s20, v213
    v_lshlrev_b32 v4, 12, v3
    s_lshl_b32 s21, s12, 7
    v_lshlrev_b32 v5, 3, v218
    v_add3_u32 v4, v4, v5, s21
    v_lshlrev_b32 v3, 2, v3
    buffer_load_dwordx2 v[198:199], v4, s[36:39], 0 offen
    buffer_load_dword v207, v3, s[48:51], s52 offen
    v_mov_b32 v214, v254
    s_add_u32 s20, s18, 8
    v_mov_b32 v219, s20
    s_mul_i32 s20, s13, 72
    v_add_u32 v3, s20, v214
    v_lshlrev_b32 v4, 12, v3
    s_lshl_b32 s21, s12, 7
    v_lshlrev_b32 v5, 3, v219
    v_add3_u32 v4, v4, v5, s21
    v_lshlrev_b32 v3, 2, v3
    buffer_load_dwordx2 v[200:201], v4, s[36:39], 0 offen
    buffer_load_dword v208, v3, s[48:51], s52 offen
    v_mov_b32 v215, v254
    s_add_u32 s20, s18, 12
    v_mov_b32 v220, s20
    s_mul_i32 s20, s13, 72
    v_add_u32 v3, s20, v215
    v_lshlrev_b32 v4, 12, v3
    s_lshl_b32 s21, s12, 7
    v_lshlrev_b32 v5, 3, v220
    v_add3_u32 v4, v4, v5, s21
    v_lshlrev_b32 v3, 2, v3
    buffer_load_dwordx2 v[202:203], v4, s[36:39], 0 offen
    buffer_load_dword v209, v3, s[48:51], s52 offen
    v_and_b32 v216, 7, v254
    v_add_u32 v216, 64, v216
    v_lshrrev_b32 v221, 3, v254
    s_lshl_b32 s20, s18, 3
    v_add_u32 v221, s20, v221
    v_mov_b32 v3, 0x4000
    v_cmp_gt_u32 vcc, 16, v221
    s_nop 1
    v_cndmask_b32 v216, v3, v216, vcc
    s_mul_i32 s20, s13, 72
    v_add_u32 v3, s20, v216
    v_lshlrev_b32 v4, 12, v3
    s_lshl_b32 s21, s12, 7
    v_lshlrev_b32 v5, 3, v221
    v_add3_u32 v4, v4, v5, s21
    v_lshlrev_b32 v3, 2, v3
    buffer_load_dwordx2 v[204:205], v4, s[36:39], 0 offen
    buffer_load_dword v210, v3, s[48:51], s52 offen
    v_mul_u32_u24 v224, 272, v212
    v_lshlrev_b32 v1, 4, v217
    v_add_u32 v224, v224, v1
    v_lshlrev_b32 v2, 2, v217
    s_lshl_b32 s20, s12, 6
    v_add_u32 v2, s20, v2
    v_mul_u32_u24 v2, 1152, v2
    s_mul_i32 s20, s13, 144
    v_lshlrev_b32 v3, 1, v212
    v_add3_u32 v230, v2, v3, s20
    v_mul_u32_u24 v225, 272, v213
    v_lshlrev_b32 v1, 4, v218
    v_add_u32 v225, v225, v1
    v_lshlrev_b32 v2, 2, v218
    s_lshl_b32 s20, s12, 6
    v_add_u32 v2, s20, v2
    v_mul_u32_u24 v2, 1152, v2
    s_mul_i32 s20, s13, 144
    v_lshlrev_b32 v3, 1, v213
    v_add3_u32 v231, v2, v3, s20
    v_mul_u32_u24 v226, 272, v214
    v_lshlrev_b32 v1, 4, v219
    v_add_u32 v226, v226, v1
    v_lshlrev_b32 v2, 2, v219
    s_lshl_b32 s20, s12, 6
    v_add_u32 v2, s20, v2
    v_mul_u32_u24 v2, 1152, v2
    s_mul_i32 s20, s13, 144
    v_lshlrev_b32 v3, 1, v214
    v_add3_u32 v232, v2, v3, s20
    v_mul_u32_u24 v227, 272, v215
    v_lshlrev_b32 v1, 4, v220
    v_add_u32 v227, v227, v1
    v_lshlrev_b32 v2, 2, v220
    s_lshl_b32 s20, s12, 6
    v_add_u32 v2, s20, v2
    v_mul_u32_u24 v2, 1152, v2
    s_mul_i32 s20, s13, 144
    v_lshlrev_b32 v3, 1, v215
    v_add3_u32 v233, v2, v3, s20
    v_mul_u32_u24 v228, 272, v216
    v_lshlrev_b32 v1, 4, v221
    v_add_u32 v228, v228, v1
    v_lshlrev_b32 v2, 2, v221
    s_lshl_b32 s20, s12, 6
    v_add_u32 v2, s20, v2
    v_mul_u32_u24 v2, 1152, v2
    s_mul_i32 s20, s13, 144
    v_lshlrev_b32 v3, 1, v216
    v_add3_u32 v234, v2, v3, s20
    v_mov_b32 v0, 0
    v_mov_b32 v1, 0
    v_mov_b32 v2, 0
    v_mov_b32 v3, 0
    v_mov_b32 v4, 0
    v_mov_b32 v5, 0
    v_mov_b32 v6, 0
    v_mov_b32 v7, 0
    v_mov_b32 v8, 0
    v_mov_b32 v9, 0
    v_mov_b32 v10, 0
    v_mov_b32 v11, 0
    v_mov_b32 v12, 0
    v_mov_b32 v13, 0
    v_mov_b32 v14, 0
    v_mov_b32 v15, 0
    v_mov_b32 v16, 0
    v_mov_b32 v17, 0
    v_mov_b32 v18, 0
    v_mov_b32 v19, 0
    v_mov_b32 v20, 0
    v_mov_b32 v21, 0
    v_mov_b32 v22, 0
    v_mov_b32 v23, 0
    v_mov_b32 v24, 0
    v_mov_b32 v25, 0
    v_mov_b32 v26, 0
    v_mov_b32 v27, 0
    v_mov_b32 v28, 0
    v_mov_b32 v29, 0
    v_mov_b32 v30, 0
    v_mov_b32 v31, 0
    v_mov_b32 v32, 0
    v_mov_b32 v33, 0
    v_mov_b32 v34, 0
    v_mov_b32 v35, 0
    v_mov_b32 v36, 0
    v_mov_b32 v37, 0
    v_mov_b32 v38, 0
    v_mov_b32 v39, 0
    v_mov_b32 v40, 0
    v_mov_b32 v41, 0
    v_mov_b32 v42, 0
    v_mov_b32 v43, 0
    v_mov_b32 v44, 0
    v_mov_b32 v45, 0
    v_mov_b32 v46, 0
    v_mov_b32 v47, 0
    v_mov_b32 v48, 0
    v_mov_b32 v49, 0
    v_mov_b32 v50, 0
    v_mov_b32 v51, 0
    v_mov_b32 v52, 0
    v_mov_b32 v53, 0
    v_mov_b32 v54, 0
    v_mov_b32 v55, 0
    v_mov_b32 v56, 0
    v_mov_b32 v57, 0
    v_mov_b32 v58, 0
    v_mov_b32 v59, 0
    v_mov_b32 v60, 0
    v_mov_b32 v61, 0
    v_mov_b32 v62, 0
    v_mov_b32 v63, 0
    v_mov_b32 v64, 0
    v_mov_b32 v65, 0
    v_mov_b32 v66, 0
    v_mov_b32 v67, 0
    v_mov_b32 v68, 0
    v_mov_b32 v69, 0
    v_mov_b32 v70, 0
    v_mov_b32 v71, 0
    v_mov_b32 v72, 0
    v_mov_b32 v73, 0
    v_mov_b32 v74, 0
    v_mov_b32 v75, 0
    v_mov_b32 v76, 0
    v_mov_b32 v77, 0
    v_mov_b32 v78, 0
    v_mov_b32 v79, 0
    s_barrier
    s_barrier
    s_mul_i32 s42, s18, 36160
    s_mov_b32 s50, 0x00ff00ff
    s_mov_b32 s51, 0x00ff00ff
    s_add_u32 m0, s42, 0
    s_nop 0
    buffer_load_dwordx4 v192, s[32:35], s41 offen offset:0 lds
    buffer_load_dwordx4 v192, s[32:35], s41 offen offset:1024 lds
    buffer_load_dwordx4 v192, s[32:35], s41 offen offset:2048 lds
    buffer_load_dwordx4 v192, s[32:35], s41 offen offset:3072 lds
    s_add_u32 m0, s42, 4096
    s_add_u32 s43, s41, 4096
    s_mov_b64 exec, s[50:51]
    buffer_load_dwordx4 v192, s[32:35], s43 offen lds
    s_mov_b64 exec, -1
    s_add_u32 s41, s41, 5120
    s_add_u32 m0, s42, 5120
    s_nop 0
    buffer_load_dwordx4 v192, s[32:35], s41 offen offset:0 lds
    buffer_load_dwordx4 v192, s[32:35], s41 offen offset:1024 lds
    buffer_load_dwordx4 v192, s[32:35], s41 offen offset:2048 lds
    buffer_load_dwordx4 v192, s[32:35], s41 offen offset:3072 lds
    s_add_u32 m0, s42, 9216
    s_add_u32 s43, s41, 4096
    s_mov_b64 exec, s[50:51]
    buffer_load_dwordx4 v192, s[32:35], s43 offen lds
    s_mov_b64 exec, -1
    s_add_u32 s41, s41, 5120
    s_add_u32 m0, s42, 10240
    s_nop 0
    buffer_load_dwordx4 v192, s[32:35], s41 offen offset:0 lds
    buffer_load_dwordx4 v192, s[32:35], s41 offen offset:1024 lds
    buffer_load_dwordx4 v192, s[32:35], s41 offen offset:2048 lds
    buffer_load_dwordx4 v192, s[32:35], s41 offen offset:3072 lds
    s_add_u32 m0, s42, 14336
    s_add_u32 s43, s41, 4096
    s_mov_b64 exec, s[50:51]
    buffer_load_dwordx4 v192, s[32:35], s43 offen lds
    s_mov_b64 exec, -1
    s_add_u32 s41, s41, 5120
    s_add_u32 m0, s42, 15360
    s_nop 0
    buffer_load_dwordx4 v192, s[32:35], s41 offen offset:0 lds
    buffer_load_dwordx4 v192, s[32:35], s41 offen offset:1024 lds
    buffer_load_dwordx4 v192, s[32:35], s41 offen offset:2048 lds
    buffer_load_dwordx4 v192, s[32:35], s41 offen offset:3072 lds
    s_add_u32 m0, s42, 19456
    s_add_u32 s43, s41, 4096
    s_mov_b64 exec, s[50:51]
    buffer_load_dwordx4 v192, s[32:35], s43 offen lds
    s_mov_b64 exec, -1
    s_add_u32 s41, s41, 5120
    s_add_u32 m0, s42, 20480
    s_nop 0
    buffer_load_dwordx4 v192, s[32:35], s41 offen offset:0 lds
    buffer_load_dwordx4 v192, s[32:35], s41 offen offset:1024 lds
    buffer_load_dwordx4 v192, s[32:35], s41 offen offset:2048 lds
    buffer_load_dwordx4 v192, s[32:35], s41 offen offset:3072 lds
    s_add_u32 m0, s42, 24576
    s_add_u32 s43, s41, 4096
    s_mov_b64 exec, s[50:51]
    buffer_load_dwordx4 v192, s[32:35], s43 offen lds
    s_mov_b64 exec, -1
    s_add_u32 s41, s41, 5120
    s_add_u32 m0, s42, 25600
    s_nop 0
    buffer_load_dwordx4 v192, s[32:35], s41 offen offset:0 lds
    buffer_load_dwordx4 v192, s[32:35], s41 offen offset:1024 lds
    buffer_load_dwordx4 v192, s[32:35], s41 offen offset:2048 lds
    buffer_load_dwordx4 v192, s[32:35], s41 offen offset:3072 lds
    s_add_u32 m0, s42, 29696
    s_add_u32 s43, s41, 4096
    s_mov_b64 exec, s[50:51]
    buffer_load_dwordx4 v192, s[32:35], s43 offen lds
    s_mov_b64 exec, -1
    s_add_u32 s41, s41, 5120
    s_add_u32 m0, s42, 30720
    s_nop 0
    buffer_load_dwordx4 v192, s[32:35], s41 offen offset:0 lds
    buffer_load_dwordx4 v192, s[32:35], s41 offen offset:1024 lds
    buffer_load_dwordx4 v192, s[32:35], s41 offen offset:2048 lds
    buffer_load_dwordx4 v192, s[32:35], s41 offen offset:3072 lds
    s_add_u32 m0, s42, 34816
    s_add_u32 s43, s41, 4096
    s_mov_b64 exec, s[50:51]
    buffer_load_dwordx4 v192, s[32:35], s43 offen lds
    s_mov_b64 exec, -1
    s_add_u32 s41, s41, 5120
    v_add_u32 v222, s42, v192
    s_barrier
    s_waitcnt vmcnt(0)
    v_mul_f32 v206, 0x40088e99, v206
    v_mul_f32 v207, 0x40088e99, v207
    v_mul_f32 v208, 0x40088e99, v208
    v_mul_f32 v209, 0x40088e99, v209
    v_mul_f32 v210, 0x40088e99, v210
    buffer_load_dwordx4 v[80:83], v188, s[28:31], s40 offen sc1
    buffer_load_dwordx4 v[84:87], v189, s[28:31], s40 offen sc1
    buffer_load_dwordx4 v[88:91], v190, s[28:31], s40 offen sc1
    buffer_load_dwordx4 v[92:95], v191, s[28:31], s40 offen sc1
    s_add_u32 s40, s40, 1024
    buffer_load_dwordx4 v[116:119], v188, s[28:31], s40 offen sc1
    buffer_load_dwordx4 v[120:123], v189, s[28:31], s40 offen sc1
    buffer_load_dwordx4 v[124:127], v190, s[28:31], s40 offen sc1
    buffer_load_dwordx4 v[128:131], v191, s[28:31], s40 offen sc1
    s_add_u32 s40, s40, 1024
    ds_read_b128 v[96:99], v222 offset:0
    ds_read_b128 v[100:103], v222 offset:1024
    ds_read_b128 v[104:107], v222 offset:2048
    ds_read_b128 v[108:111], v222 offset:3072
    ds_read_b128 v[112:115], v222 offset:4096
    buffer_load_dwordx4 v[152:155], v188, s[28:31], s40 offen sc1
    buffer_load_dwordx4 v[156:159], v189, s[28:31], s40 offen sc1
    buffer_load_dwordx4 v[160:163], v190, s[28:31], s40 offen sc1
    buffer_load_dwordx4 v[164:167], v191, s[28:31], s40 offen sc1
    s_add_u32 s40, s40, 1024
    ds_read_b128 v[132:135], v222 offset:5120
    ds_read_b128 v[136:139], v222 offset:6144
    ds_read_b128 v[140:143], v222 offset:7168
    ds_read_b128 v[144:147], v222 offset:8192
    ds_read_b128 v[148:151], v222 offset:9216
    s_waitcnt lgkmcnt(5)
    s_waitcnt vmcnt(8)
    v_mfma_f32_16x16x32_bf16 v[0:3], v[80:83], v[96:99], v[0:3]
    v_mfma_f32_16x16x32_bf16 v[4:7], v[80:83], v[100:103], v[4:7]
    v_mfma_f32_16x16x32_bf16 v[8:11], v[80:83], v[104:107], v[8:11]
    v_mfma_f32_16x16x32_bf16 v[12:15], v[80:83], v[108:111], v[12:15]
    v_mfma_f32_16x16x32_bf16 v[16:19], v[80:83], v[112:115], v[16:19]
    v_mfma_f32_16x16x32_bf16 v[20:23], v[84:87], v[96:99], v[20:23]
    v_mfma_f32_16x16x32_bf16 v[24:27], v[84:87], v[100:103], v[24:27]
    v_mfma_f32_16x16x32_bf16 v[28:31], v[84:87], v[104:107], v[28:31]
    v_mfma_f32_16x16x32_bf16 v[32:35], v[84:87], v[108:111], v[32:35]
    v_mfma_f32_16x16x32_bf16 v[36:39], v[84:87], v[112:115], v[36:39]
    v_mfma_f32_16x16x32_bf16 v[40:43], v[88:91], v[96:99], v[40:43]
    v_mfma_f32_16x16x32_bf16 v[44:47], v[88:91], v[100:103], v[44:47]
    v_mfma_f32_16x16x32_bf16 v[48:51], v[88:91], v[104:107], v[48:51]
    v_mfma_f32_16x16x32_bf16 v[52:55], v[88:91], v[108:111], v[52:55]
    v_mfma_f32_16x16x32_bf16 v[56:59], v[88:91], v[112:115], v[56:59]
    v_mfma_f32_16x16x32_bf16 v[60:63], v[92:95], v[96:99], v[60:63]
    v_mfma_f32_16x16x32_bf16 v[64:67], v[92:95], v[100:103], v[64:67]
    v_mfma_f32_16x16x32_bf16 v[68:71], v[92:95], v[104:107], v[68:71]
    v_mfma_f32_16x16x32_bf16 v[72:75], v[92:95], v[108:111], v[72:75]
    v_mfma_f32_16x16x32_bf16 v[76:79], v[92:95], v[112:115], v[76:79]
    buffer_load_dwordx4 v[80:83], v188, s[28:31], s40 offen sc1
    buffer_load_dwordx4 v[84:87], v189, s[28:31], s40 offen sc1
    buffer_load_dwordx4 v[88:91], v190, s[28:31], s40 offen sc1
    buffer_load_dwordx4 v[92:95], v191, s[28:31], s40 offen sc1
    s_add_u32 s40, s40, 1024
    ds_read_b128 v[168:171], v222 offset:10240
    ds_read_b128 v[172:175], v222 offset:11264
    ds_read_b128 v[176:179], v222 offset:12288
    ds_read_b128 v[180:183], v222 offset:13312
    ds_read_b128 v[184:187], v222 offset:14336
    s_waitcnt lgkmcnt(5)
    s_waitcnt vmcnt(8)
    v_mfma_f32_16x16x32_bf16 v[0:3], v[116:119], v[132:135], v[0:3]
    v_mfma_f32_16x16x32_bf16 v[4:7], v[116:119], v[136:139], v[4:7]
    v_mfma_f32_16x16x32_bf16 v[8:11], v[116:119], v[140:143], v[8:11]
    v_mfma_f32_16x16x32_bf16 v[12:15], v[116:119], v[144:147], v[12:15]
    v_mfma_f32_16x16x32_bf16 v[16:19], v[116:119], v[148:151], v[16:19]
    v_mfma_f32_16x16x32_bf16 v[20:23], v[120:123], v[132:135], v[20:23]
    v_mfma_f32_16x16x32_bf16 v[24:27], v[120:123], v[136:139], v[24:27]
    v_mfma_f32_16x16x32_bf16 v[28:31], v[120:123], v[140:143], v[28:31]
    v_mfma_f32_16x16x32_bf16 v[32:35], v[120:123], v[144:147], v[32:35]
    v_mfma_f32_16x16x32_bf16 v[36:39], v[120:123], v[148:151], v[36:39]
    v_mfma_f32_16x16x32_bf16 v[40:43], v[124:127], v[132:135], v[40:43]
    v_mfma_f32_16x16x32_bf16 v[44:47], v[124:127], v[136:139], v[44:47]
    v_mfma_f32_16x16x32_bf16 v[48:51], v[124:127], v[140:143], v[48:51]
    v_mfma_f32_16x16x32_bf16 v[52:55], v[124:127], v[144:147], v[52:55]
    v_mfma_f32_16x16x32_bf16 v[56:59], v[124:127], v[148:151], v[56:59]
    v_mfma_f32_16x16x32_bf16 v[60:63], v[128:131], v[132:135], v[60:63]
    v_mfma_f32_16x16x32_bf16 v[64:67], v[128:131], v[136:139], v[64:67]
    v_mfma_f32_16x16x32_bf16 v[68:71], v[128:131], v[140:143], v[68:71]
    v_mfma_f32_16x16x32_bf16 v[72:75], v[128:131], v[144:147], v[72:75]
    v_mfma_f32_16x16x32_bf16 v[76:79], v[128:131], v[148:151], v[76:79]
    buffer_load_dwordx4 v[116:119], v188, s[28:31], s40 offen sc1
    buffer_load_dwordx4 v[120:123], v189, s[28:31], s40 offen sc1
    buffer_load_dwordx4 v[124:127], v190, s[28:31], s40 offen sc1
    buffer_load_dwordx4 v[128:131], v191, s[28:31], s40 offen sc1
    s_add_u32 s40, s40, 1024
    ds_read_b128 v[96:99], v222 offset:15360
    ds_read_b128 v[100:103], v222 offset:16384
    ds_read_b128 v[104:107], v222 offset:17408
    ds_read_b128 v[108:111], v222 offset:18432
    ds_read_b128 v[112:115], v222 offset:19456
    s_waitcnt lgkmcnt(5)
    s_waitcnt vmcnt(8)
    v_mfma_f32_16x16x32_bf16 v[0:3], v[152:155], v[168:171], v[0:3]
    v_mfma_f32_16x16x32_bf16 v[4:7], v[152:155], v[172:175], v[4:7]
    v_mfma_f32_16x16x32_bf16 v[8:11], v[152:155], v[176:179], v[8:11]
    v_mfma_f32_16x16x32_bf16 v[12:15], v[152:155], v[180:183], v[12:15]
    v_mfma_f32_16x16x32_bf16 v[16:19], v[152:155], v[184:187], v[16:19]
    v_mfma_f32_16x16x32_bf16 v[20:23], v[156:159], v[168:171], v[20:23]
    v_mfma_f32_16x16x32_bf16 v[24:27], v[156:159], v[172:175], v[24:27]
    v_mfma_f32_16x16x32_bf16 v[28:31], v[156:159], v[176:179], v[28:31]
    v_mfma_f32_16x16x32_bf16 v[32:35], v[156:159], v[180:183], v[32:35]
    v_mfma_f32_16x16x32_bf16 v[36:39], v[156:159], v[184:187], v[36:39]
    v_mfma_f32_16x16x32_bf16 v[40:43], v[160:163], v[168:171], v[40:43]
    v_mfma_f32_16x16x32_bf16 v[44:47], v[160:163], v[172:175], v[44:47]
    v_mfma_f32_16x16x32_bf16 v[48:51], v[160:163], v[176:179], v[48:51]
    v_mfma_f32_16x16x32_bf16 v[52:55], v[160:163], v[180:183], v[52:55]
    v_mfma_f32_16x16x32_bf16 v[56:59], v[160:163], v[184:187], v[56:59]
    v_mfma_f32_16x16x32_bf16 v[60:63], v[164:167], v[168:171], v[60:63]
    v_mfma_f32_16x16x32_bf16 v[64:67], v[164:167], v[172:175], v[64:67]
    v_mfma_f32_16x16x32_bf16 v[68:71], v[164:167], v[176:179], v[68:71]
    v_mfma_f32_16x16x32_bf16 v[72:75], v[164:167], v[180:183], v[72:75]
    v_mfma_f32_16x16x32_bf16 v[76:79], v[164:167], v[184:187], v[76:79]
    buffer_load_dwordx4 v[152:155], v188, s[28:31], s40 offen sc1
    buffer_load_dwordx4 v[156:159], v189, s[28:31], s40 offen sc1
    buffer_load_dwordx4 v[160:163], v190, s[28:31], s40 offen sc1
    buffer_load_dwordx4 v[164:167], v191, s[28:31], s40 offen sc1
    s_add_u32 s40, s40, 1024
    ds_read_b128 v[132:135], v222 offset:20480
    ds_read_b128 v[136:139], v222 offset:21504
    ds_read_b128 v[140:143], v222 offset:22528
    ds_read_b128 v[144:147], v222 offset:23552
    ds_read_b128 v[148:151], v222 offset:24576
    s_waitcnt lgkmcnt(5)
    s_waitcnt vmcnt(8)
    v_mfma_f32_16x16x32_bf16 v[0:3], v[80:83], v[96:99], v[0:3]
    v_mfma_f32_16x16x32_bf16 v[4:7], v[80:83], v[100:103], v[4:7]
    v_mfma_f32_16x16x32_bf16 v[8:11], v[80:83], v[104:107], v[8:11]
    v_mfma_f32_16x16x32_bf16 v[12:15], v[80:83], v[108:111], v[12:15]
    v_mfma_f32_16x16x32_bf16 v[16:19], v[80:83], v[112:115], v[16:19]
    v_mfma_f32_16x16x32_bf16 v[20:23], v[84:87], v[96:99], v[20:23]
    v_mfma_f32_16x16x32_bf16 v[24:27], v[84:87], v[100:103], v[24:27]
    v_mfma_f32_16x16x32_bf16 v[28:31], v[84:87], v[104:107], v[28:31]
    v_mfma_f32_16x16x32_bf16 v[32:35], v[84:87], v[108:111], v[32:35]
    v_mfma_f32_16x16x32_bf16 v[36:39], v[84:87], v[112:115], v[36:39]
    v_mfma_f32_16x16x32_bf16 v[40:43], v[88:91], v[96:99], v[40:43]
    v_mfma_f32_16x16x32_bf16 v[44:47], v[88:91], v[100:103], v[44:47]
    v_mfma_f32_16x16x32_bf16 v[48:51], v[88:91], v[104:107], v[48:51]
    v_mfma_f32_16x16x32_bf16 v[52:55], v[88:91], v[108:111], v[52:55]
    v_mfma_f32_16x16x32_bf16 v[56:59], v[88:91], v[112:115], v[56:59]
    v_mfma_f32_16x16x32_bf16 v[60:63], v[92:95], v[96:99], v[60:63]
    v_mfma_f32_16x16x32_bf16 v[64:67], v[92:95], v[100:103], v[64:67]
    v_mfma_f32_16x16x32_bf16 v[68:71], v[92:95], v[104:107], v[68:71]
    v_mfma_f32_16x16x32_bf16 v[72:75], v[92:95], v[108:111], v[72:75]
    v_mfma_f32_16x16x32_bf16 v[76:79], v[92:95], v[112:115], v[76:79]
    buffer_load_dwordx4 v[80:83], v188, s[28:31], s40 offen sc1
    buffer_load_dwordx4 v[84:87], v189, s[28:31], s40 offen sc1
    buffer_load_dwordx4 v[88:91], v190, s[28:31], s40 offen sc1
    buffer_load_dwordx4 v[92:95], v191, s[28:31], s40 offen sc1
    s_add_u32 s40, s40, 1024
    ds_read_b128 v[168:171], v222 offset:25600
    ds_read_b128 v[172:175], v222 offset:26624
    ds_read_b128 v[176:179], v222 offset:27648
    ds_read_b128 v[180:183], v222 offset:28672
    ds_read_b128 v[184:187], v222 offset:29696
    s_waitcnt lgkmcnt(5)
    s_waitcnt vmcnt(8)
    v_mfma_f32_16x16x32_bf16 v[0:3], v[116:119], v[132:135], v[0:3]
    v_mfma_f32_16x16x32_bf16 v[4:7], v[116:119], v[136:139], v[4:7]
    v_mfma_f32_16x16x32_bf16 v[8:11], v[116:119], v[140:143], v[8:11]
    v_mfma_f32_16x16x32_bf16 v[12:15], v[116:119], v[144:147], v[12:15]
    v_mfma_f32_16x16x32_bf16 v[16:19], v[116:119], v[148:151], v[16:19]
    v_mfma_f32_16x16x32_bf16 v[20:23], v[120:123], v[132:135], v[20:23]
    v_mfma_f32_16x16x32_bf16 v[24:27], v[120:123], v[136:139], v[24:27]
    v_mfma_f32_16x16x32_bf16 v[28:31], v[120:123], v[140:143], v[28:31]
    v_mfma_f32_16x16x32_bf16 v[32:35], v[120:123], v[144:147], v[32:35]
    v_mfma_f32_16x16x32_bf16 v[36:39], v[120:123], v[148:151], v[36:39]
    v_mfma_f32_16x16x32_bf16 v[40:43], v[124:127], v[132:135], v[40:43]
    v_mfma_f32_16x16x32_bf16 v[44:47], v[124:127], v[136:139], v[44:47]
    v_mfma_f32_16x16x32_bf16 v[48:51], v[124:127], v[140:143], v[48:51]
    v_mfma_f32_16x16x32_bf16 v[52:55], v[124:127], v[144:147], v[52:55]
    v_mfma_f32_16x16x32_bf16 v[56:59], v[124:127], v[148:151], v[56:59]
    v_mfma_f32_16x16x32_bf16 v[60:63], v[128:131], v[132:135], v[60:63]
    v_mfma_f32_16x16x32_bf16 v[64:67], v[128:131], v[136:139], v[64:67]
    v_mfma_f32_16x16x32_bf16 v[68:71], v[128:131], v[140:143], v[68:71]
    v_mfma_f32_16x16x32_bf16 v[72:75], v[128:131], v[144:147], v[72:75]
    v_mfma_f32_16x16x32_bf16 v[76:79], v[128:131], v[148:151], v[76:79]
    buffer_load_dwordx4 v[116:119], v188, s[28:31], s40 offen sc1
    buffer_load_dwordx4 v[120:123], v189, s[28:31], s40 offen sc1
    buffer_load_dwordx4 v[124:127], v190, s[28:31], s40 offen sc1
    buffer_load_dwordx4 v[128:131], v191, s[28:31], s40 offen sc1
    s_add_u32 s40, s40, 1024
    buffer_load_dwordx4 v[132:135], v192, s[32:35], s41 offen offset:0
    buffer_load_dwordx4 v[136:139], v192, s[32:35], s41 offen offset:1024
    buffer_load_dwordx4 v[140:143], v192, s[32:35], s41 offen offset:2048
    buffer_load_dwordx4 v[144:147], v192, s[32:35], s41 offen offset:3072
    buffer_load_dwordx4 v[148:151], v193, s[32:35], s41 offen
    s_add_u32 s41, s41, 5120
    ds_read_b128 v[96:99], v222 offset:30720
    ds_read_b128 v[100:103], v222 offset:31744
    ds_read_b128 v[104:107], v222 offset:32768
    ds_read_b128 v[108:111], v222 offset:33792
    ds_read_b128 v[112:115], v222 offset:34816
    s_waitcnt lgkmcnt(5)
    s_waitcnt vmcnt(13)
    v_mfma_f32_16x16x32_bf16 v[0:3], v[152:155], v[168:171], v[0:3]
    v_mfma_f32_16x16x32_bf16 v[4:7], v[152:155], v[172:175], v[4:7]
    v_mfma_f32_16x16x32_bf16 v[8:11], v[152:155], v[176:179], v[8:11]
    v_mfma_f32_16x16x32_bf16 v[12:15], v[152:155], v[180:183], v[12:15]
    v_mfma_f32_16x16x32_bf16 v[16:19], v[152:155], v[184:187], v[16:19]
    v_mfma_f32_16x16x32_bf16 v[20:23], v[156:159], v[168:171], v[20:23]
    v_mfma_f32_16x16x32_bf16 v[24:27], v[156:159], v[172:175], v[24:27]
    v_mfma_f32_16x16x32_bf16 v[28:31], v[156:159], v[176:179], v[28:31]
    v_mfma_f32_16x16x32_bf16 v[32:35], v[156:159], v[180:183], v[32:35]
    v_mfma_f32_16x16x32_bf16 v[36:39], v[156:159], v[184:187], v[36:39]
    v_mfma_f32_16x16x32_bf16 v[40:43], v[160:163], v[168:171], v[40:43]
    v_mfma_f32_16x16x32_bf16 v[44:47], v[160:163], v[172:175], v[44:47]
    v_mfma_f32_16x16x32_bf16 v[48:51], v[160:163], v[176:179], v[48:51]
    v_mfma_f32_16x16x32_bf16 v[52:55], v[160:163], v[180:183], v[52:55]
    v_mfma_f32_16x16x32_bf16 v[56:59], v[160:163], v[184:187], v[56:59]
    v_mfma_f32_16x16x32_bf16 v[60:63], v[164:167], v[168:171], v[60:63]
    v_mfma_f32_16x16x32_bf16 v[64:67], v[164:167], v[172:175], v[64:67]
    v_mfma_f32_16x16x32_bf16 v[68:71], v[164:167], v[176:179], v[68:71]
    v_mfma_f32_16x16x32_bf16 v[72:75], v[164:167], v[180:183], v[72:75]
    v_mfma_f32_16x16x32_bf16 v[76:79], v[164:167], v[184:187], v[76:79]
    buffer_load_dwordx2 v[152:153], v248, s[28:31], s40 offen sc1
    buffer_load_dwordx2 v[154:155], v248, s[28:31], s40 offen offset:512 sc1
    buffer_load_dwordx2 v[156:157], v249, s[28:31], s40 offen sc1
    buffer_load_dwordx2 v[158:159], v249, s[28:31], s40 offen offset:512 sc1
    buffer_load_dwordx2 v[160:161], v250, s[28:31], s40 offen sc1
    buffer_load_dwordx2 v[162:163], v250, s[28:31], s40 offen offset:512 sc1
    buffer_load_dwordx2 v[164:165], v251, s[28:31], s40 offen sc1
    buffer_load_dwordx2 v[166:167], v251, s[28:31], s40 offen offset:512 sc1
    s_add_u32 s40, s40, 1024
    buffer_load_dwordx4 v[168:171], v192, s[32:35], s41 offen offset:0
    buffer_load_dwordx4 v[172:175], v192, s[32:35], s41 offen offset:1024
    buffer_load_dwordx4 v[176:179], v192, s[32:35], s41 offen offset:2048
    buffer_load_dwordx4 v[180:183], v192, s[32:35], s41 offen offset:3072
    buffer_load_dwordx4 v[184:187], v193, s[32:35], s41 offen
    s_add_u32 s41, s41, 5120
    s_waitcnt lgkmcnt(0)
    s_waitcnt vmcnt(22)
    v_mfma_f32_16x16x32_bf16 v[0:3], v[80:83], v[96:99], v[0:3]
    v_mfma_f32_16x16x32_bf16 v[4:7], v[80:83], v[100:103], v[4:7]
    v_mfma_f32_16x16x32_bf16 v[8:11], v[80:83], v[104:107], v[8:11]
    v_mfma_f32_16x16x32_bf16 v[12:15], v[80:83], v[108:111], v[12:15]
    v_mfma_f32_16x16x32_bf16 v[16:19], v[80:83], v[112:115], v[16:19]
    v_mfma_f32_16x16x32_bf16 v[20:23], v[84:87], v[96:99], v[20:23]
    v_mfma_f32_16x16x32_bf16 v[24:27], v[84:87], v[100:103], v[24:27]
    v_mfma_f32_16x16x32_bf16 v[28:31], v[84:87], v[104:107], v[28:31]
    v_mfma_f32_16x16x32_bf16 v[32:35], v[84:87], v[108:111], v[32:35]
    v_mfma_f32_16x16x32_bf16 v[36:39], v[84:87], v[112:115], v[36:39]
    v_mfma_f32_16x16x32_bf16 v[40:43], v[88:91], v[96:99], v[40:43]
    v_mfma_f32_16x16x32_bf16 v[44:47], v[88:91], v[100:103], v[44:47]
    v_mfma_f32_16x16x32_bf16 v[48:51], v[88:91], v[104:107], v[48:51]
    v_mfma_f32_16x16x32_bf16 v[52:55], v[88:91], v[108:111], v[52:55]
    v_mfma_f32_16x16x32_bf16 v[56:59], v[88:91], v[112:115], v[56:59]
    v_mfma_f32_16x16x32_bf16 v[60:63], v[92:95], v[96:99], v[60:63]
    v_mfma_f32_16x16x32_bf16 v[64:67], v[92:95], v[100:103], v[64:67]
    v_mfma_f32_16x16x32_bf16 v[68:71], v[92:95], v[104:107], v[68:71]
    v_mfma_f32_16x16x32_bf16 v[72:75], v[92:95], v[108:111], v[72:75]
    v_mfma_f32_16x16x32_bf16 v[76:79], v[92:95], v[112:115], v[76:79]
    buffer_load_dwordx4 v[80:83], v188, s[28:31], s40 offen sc1
    buffer_load_dwordx4 v[84:87], v189, s[28:31], s40 offen sc1
    buffer_load_dwordx4 v[88:91], v190, s[28:31], s40 offen sc1
    buffer_load_dwordx4 v[92:95], v191, s[28:31], s40 offen sc1
    s_add_u32 s40, s40, 1024
    buffer_load_dwordx4 v[96:99], v192, s[32:35], s41 offen offset:0
    buffer_load_dwordx4 v[100:103], v192, s[32:35], s41 offen offset:1024
    buffer_load_dwordx4 v[104:107], v192, s[32:35], s41 offen offset:2048
    buffer_load_dwordx4 v[108:111], v192, s[32:35], s41 offen offset:3072
    buffer_load_dwordx4 v[112:115], v193, s[32:35], s41 offen
    s_add_u32 s41, s41, 5120
    s_waitcnt vmcnt(22)
    v_mfma_f32_16x16x32_bf16 v[0:3], v[116:119], v[132:135], v[0:3]
    v_mfma_f32_16x16x32_bf16 v[4:7], v[116:119], v[136:139], v[4:7]
    v_mfma_f32_16x16x32_bf16 v[8:11], v[116:119], v[140:143], v[8:11]
    v_mfma_f32_16x16x32_bf16 v[12:15], v[116:119], v[144:147], v[12:15]
    v_mfma_f32_16x16x32_bf16 v[16:19], v[116:119], v[148:151], v[16:19]
    v_mfma_f32_16x16x32_bf16 v[20:23], v[120:123], v[132:135], v[20:23]
    v_mfma_f32_16x16x32_bf16 v[24:27], v[120:123], v[136:139], v[24:27]
    v_mfma_f32_16x16x32_bf16 v[28:31], v[120:123], v[140:143], v[28:31]
    v_mfma_f32_16x16x32_bf16 v[32:35], v[120:123], v[144:147], v[32:35]
    v_mfma_f32_16x16x32_bf16 v[36:39], v[120:123], v[148:151], v[36:39]
    v_mfma_f32_16x16x32_bf16 v[40:43], v[124:127], v[132:135], v[40:43]
    v_mfma_f32_16x16x32_bf16 v[44:47], v[124:127], v[136:139], v[44:47]
    v_mfma_f32_16x16x32_bf16 v[48:51], v[124:127], v[140:143], v[48:51]
    v_mfma_f32_16x16x32_bf16 v[52:55], v[124:127], v[144:147], v[52:55]
    v_mfma_f32_16x16x32_bf16 v[56:59], v[124:127], v[148:151], v[56:59]
    v_mfma_f32_16x16x32_bf16 v[60:63], v[128:131], v[132:135], v[60:63]
    v_mfma_f32_16x16x32_bf16 v[64:67], v[128:131], v[136:139], v[64:67]
    v_mfma_f32_16x16x32_bf16 v[68:71], v[128:131], v[140:143], v[68:71]
    v_mfma_f32_16x16x32_bf16 v[72:75], v[128:131], v[144:147], v[72:75]
    v_mfma_f32_16x16x32_bf16 v[76:79], v[128:131], v[148:151], v[76:79]
    buffer_load_dwordx4 v[116:119], v188, s[28:31], s40 offen sc1
    buffer_load_dwordx4 v[120:123], v189, s[28:31], s40 offen sc1
    buffer_load_dwordx4 v[124:127], v190, s[28:31], s40 offen sc1
    buffer_load_dwordx4 v[128:131], v191, s[28:31], s40 offen sc1
    s_add_u32 s40, s40, 1024
    buffer_load_dwordx4 v[132:135], v192, s[32:35], s41 offen offset:0
    buffer_load_dwordx4 v[136:139], v192, s[32:35], s41 offen offset:1024
    buffer_load_dwordx4 v[140:143], v192, s[32:35], s41 offen offset:2048
    buffer_load_dwordx4 v[144:147], v192, s[32:35], s41 offen offset:3072
    buffer_load_dwordx4 v[148:151], v193, s[32:35], s41 offen
    s_add_u32 s41, s41, 5120
    s_waitcnt vmcnt(18)
    v_mfma_f32_16x16x32_bf16 v[0:3], v[152:155], v[168:171], v[0:3]
    v_mfma_f32_16x16x32_bf16 v[4:7], v[152:155], v[172:175], v[4:7]
    v_mfma_f32_16x16x32_bf16 v[8:11], v[152:155], v[176:179], v[8:11]
    v_mfma_f32_16x16x32_bf16 v[12:15], v[152:155], v[180:183], v[12:15]
    v_mfma_f32_16x16x32_bf16 v[16:19], v[152:155], v[184:187], v[16:19]
    v_mfma_f32_16x16x32_bf16 v[20:23], v[156:159], v[168:171], v[20:23]
    v_mfma_f32_16x16x32_bf16 v[24:27], v[156:159], v[172:175], v[24:27]
    v_mfma_f32_16x16x32_bf16 v[28:31], v[156:159], v[176:179], v[28:31]
    v_mfma_f32_16x16x32_bf16 v[32:35], v[156:159], v[180:183], v[32:35]
    v_mfma_f32_16x16x32_bf16 v[36:39], v[156:159], v[184:187], v[36:39]
    v_mfma_f32_16x16x32_bf16 v[40:43], v[160:163], v[168:171], v[40:43]
    v_mfma_f32_16x16x32_bf16 v[44:47], v[160:163], v[172:175], v[44:47]
    v_mfma_f32_16x16x32_bf16 v[48:51], v[160:163], v[176:179], v[48:51]
    v_mfma_f32_16x16x32_bf16 v[52:55], v[160:163], v[180:183], v[52:55]
    v_mfma_f32_16x16x32_bf16 v[56:59], v[160:163], v[184:187], v[56:59]
    v_mfma_f32_16x16x32_bf16 v[60:63], v[164:167], v[168:171], v[60:63]
    v_mfma_f32_16x16x32_bf16 v[64:67], v[164:167], v[172:175], v[64:67]
    v_mfma_f32_16x16x32_bf16 v[68:71], v[164:167], v[176:179], v[68:71]
    v_mfma_f32_16x16x32_bf16 v[72:75], v[164:167], v[180:183], v[72:75]
    v_mfma_f32_16x16x32_bf16 v[76:79], v[164:167], v[184:187], v[76:79]
    buffer_load_dwordx4 v[152:155], v188, s[28:31], s40 offen sc1
    buffer_load_dwordx4 v[156:159], v189, s[28:31], s40 offen sc1
    buffer_load_dwordx4 v[160:163], v190, s[28:31], s40 offen sc1
    buffer_load_dwordx4 v[164:167], v191, s[28:31], s40 offen sc1
    s_add_u32 s40, s40, 1024
    buffer_load_dwordx4 v[168:171], v192, s[32:35], s41 offen offset:0
    buffer_load_dwordx4 v[172:175], v192, s[32:35], s41 offen offset:1024
    buffer_load_dwordx4 v[176:179], v192, s[32:35], s41 offen offset:2048
    buffer_load_dwordx4 v[180:183], v192, s[32:35], s41 offen offset:3072
    buffer_load_dwordx4 v[184:187], v193, s[32:35], s41 offen
    s_add_u32 s41, s41, 5120
    s_waitcnt vmcnt(18)
    v_mfma_f32_16x16x32_bf16 v[0:3], v[80:83], v[96:99], v[0:3]
    v_mfma_f32_16x16x32_bf16 v[4:7], v[80:83], v[100:103], v[4:7]
    v_mfma_f32_16x16x32_bf16 v[8:11], v[80:83], v[104:107], v[8:11]
    v_mfma_f32_16x16x32_bf16 v[12:15], v[80:83], v[108:111], v[12:15]
    v_mfma_f32_16x16x32_bf16 v[16:19], v[80:83], v[112:115], v[16:19]
    v_mfma_f32_16x16x32_bf16 v[20:23], v[84:87], v[96:99], v[20:23]
    v_mfma_f32_16x16x32_bf16 v[24:27], v[84:87], v[100:103], v[24:27]
    v_mfma_f32_16x16x32_bf16 v[28:31], v[84:87], v[104:107], v[28:31]
    v_mfma_f32_16x16x32_bf16 v[32:35], v[84:87], v[108:111], v[32:35]
    v_mfma_f32_16x16x32_bf16 v[36:39], v[84:87], v[112:115], v[36:39]
    v_mfma_f32_16x16x32_bf16 v[40:43], v[88:91], v[96:99], v[40:43]
    v_mfma_f32_16x16x32_bf16 v[44:47], v[88:91], v[100:103], v[44:47]
    v_mfma_f32_16x16x32_bf16 v[48:51], v[88:91], v[104:107], v[48:51]
    v_mfma_f32_16x16x32_bf16 v[52:55], v[88:91], v[108:111], v[52:55]
    v_mfma_f32_16x16x32_bf16 v[56:59], v[88:91], v[112:115], v[56:59]
    v_mfma_f32_16x16x32_bf16 v[60:63], v[92:95], v[96:99], v[60:63]
    v_mfma_f32_16x16x32_bf16 v[64:67], v[92:95], v[100:103], v[64:67]
    v_mfma_f32_16x16x32_bf16 v[68:71], v[92:95], v[104:107], v[68:71]
    v_mfma_f32_16x16x32_bf16 v[72:75], v[92:95], v[108:111], v[72:75]
    v_mfma_f32_16x16x32_bf16 v[76:79], v[92:95], v[112:115], v[76:79]
    buffer_load_dwordx4 v[80:83], v188, s[28:31], s40 offen sc1
    buffer_load_dwordx4 v[84:87], v189, s[28:31], s40 offen sc1
    buffer_load_dwordx4 v[88:91], v190, s[28:31], s40 offen sc1
    buffer_load_dwordx4 v[92:95], v191, s[28:31], s40 offen sc1
    s_add_u32 s40, s40, 1024
    buffer_load_dwordx4 v[96:99], v192, s[32:35], s41 offen offset:0
    buffer_load_dwordx4 v[100:103], v192, s[32:35], s41 offen offset:1024
    buffer_load_dwordx4 v[104:107], v192, s[32:35], s41 offen offset:2048
    buffer_load_dwordx4 v[108:111], v192, s[32:35], s41 offen offset:3072
    buffer_load_dwordx4 v[112:115], v193, s[32:35], s41 offen
    s_add_u32 s41, s41, 5120
    s_waitcnt vmcnt(18)
    v_mfma_f32_16x16x32_bf16 v[0:3], v[116:119], v[132:135], v[0:3]
    v_mfma_f32_16x16x32_bf16 v[4:7], v[116:119], v[136:139], v[4:7]
    v_mfma_f32_16x16x32_bf16 v[8:11], v[116:119], v[140:143], v[8:11]
    v_mfma_f32_16x16x32_bf16 v[12:15], v[116:119], v[144:147], v[12:15]
    v_mfma_f32_16x16x32_bf16 v[16:19], v[116:119], v[148:151], v[16:19]
    v_mfma_f32_16x16x32_bf16 v[20:23], v[120:123], v[132:135], v[20:23]
    v_mfma_f32_16x16x32_bf16 v[24:27], v[120:123], v[136:139], v[24:27]
    v_mfma_f32_16x16x32_bf16 v[28:31], v[120:123], v[140:143], v[28:31]
    v_mfma_f32_16x16x32_bf16 v[32:35], v[120:123], v[144:147], v[32:35]
    v_mfma_f32_16x16x32_bf16 v[36:39], v[120:123], v[148:151], v[36:39]
    v_mfma_f32_16x16x32_bf16 v[40:43], v[124:127], v[132:135], v[40:43]
    v_mfma_f32_16x16x32_bf16 v[44:47], v[124:127], v[136:139], v[44:47]
    v_mfma_f32_16x16x32_bf16 v[48:51], v[124:127], v[140:143], v[48:51]
    v_mfma_f32_16x16x32_bf16 v[52:55], v[124:127], v[144:147], v[52:55]
    v_mfma_f32_16x16x32_bf16 v[56:59], v[124:127], v[148:151], v[56:59]
    v_mfma_f32_16x16x32_bf16 v[60:63], v[128:131], v[132:135], v[60:63]
    v_mfma_f32_16x16x32_bf16 v[64:67], v[128:131], v[136:139], v[64:67]
    v_mfma_f32_16x16x32_bf16 v[68:71], v[128:131], v[140:143], v[68:71]
    v_mfma_f32_16x16x32_bf16 v[72:75], v[128:131], v[144:147], v[72:75]
    v_mfma_f32_16x16x32_bf16 v[76:79], v[128:131], v[148:151], v[76:79]
    buffer_load_dwordx4 v[116:119], v188, s[28:31], s40 offen sc1
    buffer_load_dwordx4 v[120:123], v189, s[28:31], s40 offen sc1
    buffer_load_dwordx4 v[124:127], v190, s[28:31], s40 offen sc1
    buffer_load_dwordx4 v[128:131], v191, s[28:31], s40 offen sc1
    s_add_u32 s40, s40, 1024
    buffer_load_dwordx4 v[132:135], v192, s[32:35], s41 offen offset:0
    buffer_load_dwordx4 v[136:139], v192, s[32:35], s41 offen offset:1024
    buffer_load_dwordx4 v[140:143], v192, s[32:35], s41 offen offset:2048
    buffer_load_dwordx4 v[144:147], v192, s[32:35], s41 offen offset:3072
    buffer_load_dwordx4 v[148:151], v193, s[32:35], s41 offen
    s_add_u32 s41, s41, 5120
    s_waitcnt vmcnt(18)
    v_mfma_f32_16x16x32_bf16 v[0:3], v[152:155], v[168:171], v[0:3]
    v_mfma_f32_16x16x32_bf16 v[4:7], v[152:155], v[172:175], v[4:7]
    v_mfma_f32_16x16x32_bf16 v[8:11], v[152:155], v[176:179], v[8:11]
    v_mfma_f32_16x16x32_bf16 v[12:15], v[152:155], v[180:183], v[12:15]
    v_mfma_f32_16x16x32_bf16 v[16:19], v[152:155], v[184:187], v[16:19]
    v_mfma_f32_16x16x32_bf16 v[20:23], v[156:159], v[168:171], v[20:23]
    v_mfma_f32_16x16x32_bf16 v[24:27], v[156:159], v[172:175], v[24:27]
    v_mfma_f32_16x16x32_bf16 v[28:31], v[156:159], v[176:179], v[28:31]
    v_mfma_f32_16x16x32_bf16 v[32:35], v[156:159], v[180:183], v[32:35]
    v_mfma_f32_16x16x32_bf16 v[36:39], v[156:159], v[184:187], v[36:39]
    v_mfma_f32_16x16x32_bf16 v[40:43], v[160:163], v[168:171], v[40:43]
    v_mfma_f32_16x16x32_bf16 v[44:47], v[160:163], v[172:175], v[44:47]
    v_mfma_f32_16x16x32_bf16 v[48:51], v[160:163], v[176:179], v[48:51]
    v_mfma_f32_16x16x32_bf16 v[52:55], v[160:163], v[180:183], v[52:55]
    v_mfma_f32_16x16x32_bf16 v[56:59], v[160:163], v[184:187], v[56:59]
    v_mfma_f32_16x16x32_bf16 v[60:63], v[164:167], v[168:171], v[60:63]
    v_mfma_f32_16x16x32_bf16 v[64:67], v[164:167], v[172:175], v[64:67]
    v_mfma_f32_16x16x32_bf16 v[68:71], v[164:167], v[176:179], v[68:71]
    v_mfma_f32_16x16x32_bf16 v[72:75], v[164:167], v[180:183], v[72:75]
    v_mfma_f32_16x16x32_bf16 v[76:79], v[164:167], v[184:187], v[76:79]
    buffer_load_dwordx4 v[152:155], v188, s[28:31], s40 offen sc1
    buffer_load_dwordx4 v[156:159], v189, s[28:31], s40 offen sc1
    buffer_load_dwordx4 v[160:163], v190, s[28:31], s40 offen sc1
    buffer_load_dwordx4 v[164:167], v191, s[28:31], s40 offen sc1
    s_add_u32 s40, s40, 1024
    buffer_load_dwordx4 v[168:171], v192, s[32:35], s41 offen offset:0
    buffer_load_dwordx4 v[172:175], v192, s[32:35], s41 offen offset:1024
    buffer_load_dwordx4 v[176:179], v192, s[32:35], s41 offen offset:2048
    buffer_load_dwordx4 v[180:183], v192, s[32:35], s41 offen offset:3072
    buffer_load_dwordx4 v[184:187], v193, s[32:35], s41 offen
    s_add_u32 s41, s41, 5120
    s_waitcnt vmcnt(18)
    v_mfma_f32_16x16x32_bf16 v[0:3], v[80:83], v[96:99], v[0:3]
    v_mfma_f32_16x16x32_bf16 v[4:7], v[80:83], v[100:103], v[4:7]
    v_mfma_f32_16x16x32_bf16 v[8:11], v[80:83], v[104:107], v[8:11]
    v_mfma_f32_16x16x32_bf16 v[12:15], v[80:83], v[108:111], v[12:15]
    v_mfma_f32_16x16x32_bf16 v[16:19], v[80:83], v[112:115], v[16:19]
    v_mfma_f32_16x16x32_bf16 v[20:23], v[84:87], v[96:99], v[20:23]
    v_mfma_f32_16x16x32_bf16 v[24:27], v[84:87], v[100:103], v[24:27]
    v_mfma_f32_16x16x32_bf16 v[28:31], v[84:87], v[104:107], v[28:31]
    v_mfma_f32_16x16x32_bf16 v[32:35], v[84:87], v[108:111], v[32:35]
    v_mfma_f32_16x16x32_bf16 v[36:39], v[84:87], v[112:115], v[36:39]
    v_mfma_f32_16x16x32_bf16 v[40:43], v[88:91], v[96:99], v[40:43]
    v_mfma_f32_16x16x32_bf16 v[44:47], v[88:91], v[100:103], v[44:47]
    v_mfma_f32_16x16x32_bf16 v[48:51], v[88:91], v[104:107], v[48:51]
    v_mfma_f32_16x16x32_bf16 v[52:55], v[88:91], v[108:111], v[52:55]
    v_mfma_f32_16x16x32_bf16 v[56:59], v[88:91], v[112:115], v[56:59]
    v_mfma_f32_16x16x32_bf16 v[60:63], v[92:95], v[96:99], v[60:63]
    v_mfma_f32_16x16x32_bf16 v[64:67], v[92:95], v[100:103], v[64:67]
    v_mfma_f32_16x16x32_bf16 v[68:71], v[92:95], v[104:107], v[68:71]
    v_mfma_f32_16x16x32_bf16 v[72:75], v[92:95], v[108:111], v[72:75]
    v_mfma_f32_16x16x32_bf16 v[76:79], v[92:95], v[112:115], v[76:79]
    buffer_load_dwordx4 v[80:83], v188, s[28:31], s40 offen sc1
    buffer_load_dwordx4 v[84:87], v189, s[28:31], s40 offen sc1
    buffer_load_dwordx4 v[88:91], v190, s[28:31], s40 offen sc1
    buffer_load_dwordx4 v[92:95], v191, s[28:31], s40 offen sc1
    s_add_u32 s40, s40, 1024
    buffer_load_dwordx4 v[96:99], v192, s[32:35], s41 offen offset:0
    buffer_load_dwordx4 v[100:103], v192, s[32:35], s41 offen offset:1024
    buffer_load_dwordx4 v[104:107], v192, s[32:35], s41 offen offset:2048
    buffer_load_dwordx4 v[108:111], v192, s[32:35], s41 offen offset:3072
    buffer_load_dwordx4 v[112:115], v193, s[32:35], s41 offen
    s_add_u32 s41, s41, 5120
    s_waitcnt vmcnt(18)
    v_mfma_f32_16x16x32_bf16 v[0:3], v[116:119], v[132:135], v[0:3]
    v_mfma_f32_16x16x32_bf16 v[4:7], v[116:119], v[136:139], v[4:7]
    v_mfma_f32_16x16x32_bf16 v[8:11], v[116:119], v[140:143], v[8:11]
    v_mfma_f32_16x16x32_bf16 v[12:15], v[116:119], v[144:147], v[12:15]
    v_mfma_f32_16x16x32_bf16 v[16:19], v[116:119], v[148:151], v[16:19]
    v_mfma_f32_16x16x32_bf16 v[20:23], v[120:123], v[132:135], v[20:23]
    v_mfma_f32_16x16x32_bf16 v[24:27], v[120:123], v[136:139], v[24:27]
    v_mfma_f32_16x16x32_bf16 v[28:31], v[120:123], v[140:143], v[28:31]
    v_mfma_f32_16x16x32_bf16 v[32:35], v[120:123], v[144:147], v[32:35]
    v_mfma_f32_16x16x32_bf16 v[36:39], v[120:123], v[148:151], v[36:39]
    v_mfma_f32_16x16x32_bf16 v[40:43], v[124:127], v[132:135], v[40:43]
    v_mfma_f32_16x16x32_bf16 v[44:47], v[124:127], v[136:139], v[44:47]
    v_mfma_f32_16x16x32_bf16 v[48:51], v[124:127], v[140:143], v[48:51]
    v_mfma_f32_16x16x32_bf16 v[52:55], v[124:127], v[144:147], v[52:55]
    v_mfma_f32_16x16x32_bf16 v[56:59], v[124:127], v[148:151], v[56:59]
    v_mfma_f32_16x16x32_bf16 v[60:63], v[128:131], v[132:135], v[60:63]
    v_mfma_f32_16x16x32_bf16 v[64:67], v[128:131], v[136:139], v[64:67]
    v_mfma_f32_16x16x32_bf16 v[68:71], v[128:131], v[140:143], v[68:71]
    v_mfma_f32_16x16x32_bf16 v[72:75], v[128:131], v[144:147], v[72:75]
    v_mfma_f32_16x16x32_bf16 v[76:79], v[128:131], v[148:151], v[76:79]
    buffer_load_dwordx4 v[116:119], v188, s[28:31], s40 offen sc1
    buffer_load_dwordx4 v[120:123], v189, s[28:31], s40 offen sc1
    buffer_load_dwordx4 v[124:127], v190, s[28:31], s40 offen sc1
    buffer_load_dwordx4 v[128:131], v191, s[28:31], s40 offen sc1
    s_add_u32 s40, s40, 1024
    buffer_load_dwordx4 v[132:135], v192, s[32:35], s41 offen offset:0
    buffer_load_dwordx4 v[136:139], v192, s[32:35], s41 offen offset:1024
    buffer_load_dwordx4 v[140:143], v192, s[32:35], s41 offen offset:2048
    buffer_load_dwordx4 v[144:147], v192, s[32:35], s41 offen offset:3072
    buffer_load_dwordx4 v[148:151], v193, s[32:35], s41 offen
    s_add_u32 s41, s41, 5120
    s_waitcnt vmcnt(18)
    v_mfma_f32_16x16x32_bf16 v[0:3], v[152:155], v[168:171], v[0:3]
    v_mfma_f32_16x16x32_bf16 v[4:7], v[152:155], v[172:175], v[4:7]
    v_mfma_f32_16x16x32_bf16 v[8:11], v[152:155], v[176:179], v[8:11]
    v_mfma_f32_16x16x32_bf16 v[12:15], v[152:155], v[180:183], v[12:15]
    v_mfma_f32_16x16x32_bf16 v[16:19], v[152:155], v[184:187], v[16:19]
    v_mfma_f32_16x16x32_bf16 v[20:23], v[156:159], v[168:171], v[20:23]
    v_mfma_f32_16x16x32_bf16 v[24:27], v[156:159], v[172:175], v[24:27]
    v_mfma_f32_16x16x32_bf16 v[28:31], v[156:159], v[176:179], v[28:31]
    v_mfma_f32_16x16x32_bf16 v[32:35], v[156:159], v[180:183], v[32:35]
    v_mfma_f32_16x16x32_bf16 v[36:39], v[156:159], v[184:187], v[36:39]
    v_mfma_f32_16x16x32_bf16 v[40:43], v[160:163], v[168:171], v[40:43]
    v_mfma_f32_16x16x32_bf16 v[44:47], v[160:163], v[172:175], v[44:47]
    v_mfma_f32_16x16x32_bf16 v[48:51], v[160:163], v[176:179], v[48:51]
    v_mfma_f32_16x16x32_bf16 v[52:55], v[160:163], v[180:183], v[52:55]
    v_mfma_f32_16x16x32_bf16 v[56:59], v[160:163], v[184:187], v[56:59]
    v_mfma_f32_16x16x32_bf16 v[60:63], v[164:167], v[168:171], v[60:63]
    v_mfma_f32_16x16x32_bf16 v[64:67], v[164:167], v[172:175], v[64:67]
    v_mfma_f32_16x16x32_bf16 v[68:71], v[164:167], v[176:179], v[68:71]
    v_mfma_f32_16x16x32_bf16 v[72:75], v[164:167], v[180:183], v[72:75]
    v_mfma_f32_16x16x32_bf16 v[76:79], v[164:167], v[184:187], v[76:79]
    buffer_load_dwordx2 v[152:153], v248, s[28:31], s40 offen sc1
    buffer_load_dwordx2 v[154:155], v248, s[28:31], s40 offen offset:512 sc1
    buffer_load_dwordx2 v[156:157], v249, s[28:31], s40 offen sc1
    buffer_load_dwordx2 v[158:159], v249, s[28:31], s40 offen offset:512 sc1
    buffer_load_dwordx2 v[160:161], v250, s[28:31], s40 offen sc1
    buffer_load_dwordx2 v[162:163], v250, s[28:31], s40 offen offset:512 sc1
    buffer_load_dwordx2 v[164:165], v251, s[28:31], s40 offen sc1
    buffer_load_dwordx2 v[166:167], v251, s[28:31], s40 offen offset:512 sc1
    s_add_u32 s40, s40, 1024
    buffer_load_dwordx4 v[168:171], v192, s[32:35], s41 offen offset:0
    buffer_load_dwordx4 v[172:175], v192, s[32:35], s41 offen offset:1024
    buffer_load_dwordx4 v[176:179], v192, s[32:35], s41 offen offset:2048
    buffer_load_dwordx4 v[180:183], v192, s[32:35], s41 offen offset:3072
    buffer_load_dwordx4 v[184:187], v193, s[32:35], s41 offen
    s_add_u32 s41, s41, 5120
    s_waitcnt vmcnt(22)
    v_mfma_f32_16x16x32_bf16 v[0:3], v[80:83], v[96:99], v[0:3]
    v_mfma_f32_16x16x32_bf16 v[4:7], v[80:83], v[100:103], v[4:7]
    v_mfma_f32_16x16x32_bf16 v[8:11], v[80:83], v[104:107], v[8:11]
    v_mfma_f32_16x16x32_bf16 v[12:15], v[80:83], v[108:111], v[12:15]
    v_mfma_f32_16x16x32_bf16 v[16:19], v[80:83], v[112:115], v[16:19]
    v_mfma_f32_16x16x32_bf16 v[20:23], v[84:87], v[96:99], v[20:23]
    v_mfma_f32_16x16x32_bf16 v[24:27], v[84:87], v[100:103], v[24:27]
    v_mfma_f32_16x16x32_bf16 v[28:31], v[84:87], v[104:107], v[28:31]
    v_mfma_f32_16x16x32_bf16 v[32:35], v[84:87], v[108:111], v[32:35]
    v_mfma_f32_16x16x32_bf16 v[36:39], v[84:87], v[112:115], v[36:39]
    v_mfma_f32_16x16x32_bf16 v[40:43], v[88:91], v[96:99], v[40:43]
    v_mfma_f32_16x16x32_bf16 v[44:47], v[88:91], v[100:103], v[44:47]
    v_mfma_f32_16x16x32_bf16 v[48:51], v[88:91], v[104:107], v[48:51]
    v_mfma_f32_16x16x32_bf16 v[52:55], v[88:91], v[108:111], v[52:55]
    v_mfma_f32_16x16x32_bf16 v[56:59], v[88:91], v[112:115], v[56:59]
    v_mfma_f32_16x16x32_bf16 v[60:63], v[92:95], v[96:99], v[60:63]
    v_mfma_f32_16x16x32_bf16 v[64:67], v[92:95], v[100:103], v[64:67]
    v_mfma_f32_16x16x32_bf16 v[68:71], v[92:95], v[104:107], v[68:71]
    v_mfma_f32_16x16x32_bf16 v[72:75], v[92:95], v[108:111], v[72:75]
    v_mfma_f32_16x16x32_bf16 v[76:79], v[92:95], v[112:115], v[76:79]
    s_waitcnt vmcnt(13)
    v_mfma_f32_16x16x32_bf16 v[0:3], v[116:119], v[132:135], v[0:3]
    v_mfma_f32_16x16x32_bf16 v[4:7], v[116:119], v[136:139], v[4:7]
    v_mfma_f32_16x16x32_bf16 v[8:11], v[116:119], v[140:143], v[8:11]
    v_mfma_f32_16x16x32_bf16 v[12:15], v[116:119], v[144:147], v[12:15]
    v_mfma_f32_16x16x32_bf16 v[16:19], v[116:119], v[148:151], v[16:19]
    v_mfma_f32_16x16x32_bf16 v[20:23], v[120:123], v[132:135], v[20:23]
    v_mfma_f32_16x16x32_bf16 v[24:27], v[120:123], v[136:139], v[24:27]
    v_mfma_f32_16x16x32_bf16 v[28:31], v[120:123], v[140:143], v[28:31]
    v_mfma_f32_16x16x32_bf16 v[32:35], v[120:123], v[144:147], v[32:35]
    v_mfma_f32_16x16x32_bf16 v[36:39], v[120:123], v[148:151], v[36:39]
    v_mfma_f32_16x16x32_bf16 v[40:43], v[124:127], v[132:135], v[40:43]
    v_mfma_f32_16x16x32_bf16 v[44:47], v[124:127], v[136:139], v[44:47]
    v_mfma_f32_16x16x32_bf16 v[48:51], v[124:127], v[140:143], v[48:51]
    v_mfma_f32_16x16x32_bf16 v[52:55], v[124:127], v[144:147], v[52:55]
    v_mfma_f32_16x16x32_bf16 v[56:59], v[124:127], v[148:151], v[56:59]
    v_mfma_f32_16x16x32_bf16 v[60:63], v[128:131], v[132:135], v[60:63]
    v_mfma_f32_16x16x32_bf16 v[64:67], v[128:131], v[136:139], v[64:67]
    v_mfma_f32_16x16x32_bf16 v[68:71], v[128:131], v[140:143], v[68:71]
    v_mfma_f32_16x16x32_bf16 v[72:75], v[128:131], v[144:147], v[72:75]
    v_mfma_f32_16x16x32_bf16 v[76:79], v[128:131], v[148:151], v[76:79]
    s_waitcnt vmcnt(0)
    v_mfma_f32_16x16x32_bf16 v[0:3], v[152:155], v[168:171], v[0:3]
    v_mfma_f32_16x16x32_bf16 v[4:7], v[152:155], v[172:175], v[4:7]
    v_mfma_f32_16x16x32_bf16 v[8:11], v[152:155], v[176:179], v[8:11]
    v_mfma_f32_16x16x32_bf16 v[12:15], v[152:155], v[180:183], v[12:15]
    v_mfma_f32_16x16x32_bf16 v[16:19], v[152:155], v[184:187], v[16:19]
    v_mfma_f32_16x16x32_bf16 v[20:23], v[156:159], v[168:171], v[20:23]
    v_mfma_f32_16x16x32_bf16 v[24:27], v[156:159], v[172:175], v[24:27]
    v_mfma_f32_16x16x32_bf16 v[28:31], v[156:159], v[176:179], v[28:31]
    v_mfma_f32_16x16x32_bf16 v[32:35], v[156:159], v[180:183], v[32:35]
    v_mfma_f32_16x16x32_bf16 v[36:39], v[156:159], v[184:187], v[36:39]
    v_mfma_f32_16x16x32_bf16 v[40:43], v[160:163], v[168:171], v[40:43]
    v_mfma_f32_16x16x32_bf16 v[44:47], v[160:163], v[172:175], v[44:47]
    v_mfma_f32_16x16x32_bf16 v[48:51], v[160:163], v[176:179], v[48:51]
    v_mfma_f32_16x16x32_bf16 v[52:55], v[160:163], v[180:183], v[52:55]
    v_mfma_f32_16x16x32_bf16 v[56:59], v[160:163], v[184:187], v[56:59]
    v_mfma_f32_16x16x32_bf16 v[60:63], v[164:167], v[168:171], v[60:63]
    v_mfma_f32_16x16x32_bf16 v[64:67], v[164:167], v[172:175], v[64:67]
    v_mfma_f32_16x16x32_bf16 v[68:71], v[164:167], v[176:179], v[68:71]
    v_mfma_f32_16x16x32_bf16 v[72:75], v[164:167], v[180:183], v[72:75]
    v_mfma_f32_16x16x32_bf16 v[76:79], v[164:167], v[184:187], v[76:79]
    v_and_b32 v80, 15, v254
    v_lshrrev_b32 v81, 4, v254
    v_mul_u32_u24 v82, 272, v80
    v_lshlrev_b32 v81, 4, v81
    v_add_u32 v82, v82, v81
    s_mul_i32 s20, s18, 36160
    v_add_u32 v82, s20, v82
    s_nop 4
    ds_write_b128 v82, v[0:3] offset:0
    ds_write_b128 v82, v[4:7] offset:4352
    ds_write_b128 v82, v[8:11] offset:8704
    ds_write_b128 v82, v[12:15] offset:13056
    ds_write_b128 v82, v[20:23] offset:64
    ds_write_b128 v82, v[24:27] offset:4416
    ds_write_b128 v82, v[28:31] offset:8768
    ds_write_b128 v82, v[32:35] offset:13120
    ds_write_b128 v82, v[40:43] offset:128
    ds_write_b128 v82, v[44:47] offset:4480
    ds_write_b128 v82, v[48:51] offset:8832
    ds_write_b128 v82, v[52:55] offset:13184
    ds_write_b128 v82, v[60:63] offset:192
    ds_write_b128 v82, v[64:67] offset:4544
    ds_write_b128 v82, v[68:71] offset:8896
    ds_write_b128 v82, v[72:75] offset:13248
    v_cmp_gt_u32 vcc, 8, v80
    s_and_saveexec_b64 s[44:45], vcc
    ds_write_b128 v82, v[16:19] offset:17408
    ds_write_b128 v82, v[36:39] offset:17472
    ds_write_b128 v82, v[56:59] offset:17536
    ds_write_b128 v82, v[76:79] offset:17600
    s_mov_b64 exec, s[44:45]
    s_waitcnt lgkmcnt(0)
    s_barrier
    s_mov_b32 s28, s56
    s_and_b32 s29, s57, 0xffff
    s_mov_b32 s30, 2359296
    s_mov_b32 s31, 0x20000
    v_add_u32 v1, 72320, v224
    ds_read_b128 v[8:11], v224 offset:0
    ds_read_b128 v[12:15], v224 offset:36160
    ds_read_b128 v[16:19], v1 offset:0
    ds_read_b128 v[20:23], v1 offset:36160
    v_add_u32 v1, 72320, v225
    ds_read_b128 v[24:27], v225 offset:0
    ds_read_b128 v[28:31], v225 offset:36160
    ds_read_b128 v[32:35], v1 offset:0
    ds_read_b128 v[36:39], v1 offset:36160
    v_add_u32 v1, 72320, v226
    ds_read_b128 v[40:43], v226 offset:0
    ds_read_b128 v[44:47], v226 offset:36160
    ds_read_b128 v[48:51], v1 offset:0
    ds_read_b128 v[52:55], v1 offset:36160
    s_waitcnt lgkmcnt(8)
    v_add_u32 v1, 72320, v227
    ds_read_b128 v[56:59], v227 offset:0
    ds_read_b128 v[60:63], v227 offset:36160
    ds_read_b128 v[64:67], v1 offset:0
    ds_read_b128 v[68:71], v1 offset:36160
    s_cmp_ge_u32 s18, 2
    s_cbranch_scc1 back_kernel_r4skip
    s_waitcnt lgkmcnt(8)
    v_add_u32 v1, 72320, v228
    ds_read_b128 v[72:75], v228 offset:0
    ds_read_b128 v[76:79], v228 offset:36160
    ds_read_b128 v[80:83], v1 offset:0
    ds_read_b128 v[84:87], v1 offset:36160
back_kernel_r4skip:
    v_lshlrev_b32 v4, 16, v196
    v_and_b32 v5, 0xffff0000, v196
    v_lshlrev_b32 v6, 16, v197
    v_and_b32 v7, 0xffff0000, v197
    s_waitcnt lgkmcnt(0)
    v_pk_add_f32 v[8:9], v[8:9], v[12:13]
    v_pk_add_f32 v[16:17], v[16:17], v[20:21]
    v_pk_add_f32 v[10:11], v[10:11], v[14:15]
    v_pk_add_f32 v[18:19], v[18:19], v[22:23]
    v_pk_add_f32 v[8:9], v[8:9], v[16:17]
    v_pk_add_f32 v[10:11], v[10:11], v[18:19]
    v_pk_fma_f32 v[8:9], v[8:9], v[206:207], v[4:5] op_sel_hi:[1,0,1]
    v_pk_fma_f32 v[10:11], v[10:11], v[206:207], v[6:7] op_sel_hi:[1,0,1]
    v_cvt_pk_bf16_f32 v12, v8, v9
    v_cvt_pk_bf16_f32 v13, v10, v11
    buffer_store_short v12, v230, s[28:31], 0 offen
    v_add_u32 v3, 1152, v230
    buffer_store_short_d16_hi v12, v3, s[28:31], 0 offen
    buffer_store_short v13, v230, s[28:31], 0 offen offset:2304
    buffer_store_short_d16_hi v13, v3, s[28:31], 0 offen offset:2304
    v_lshlrev_b32 v4, 16, v198
    v_and_b32 v5, 0xffff0000, v198
    v_lshlrev_b32 v6, 16, v199
    v_and_b32 v7, 0xffff0000, v199
    v_pk_add_f32 v[24:25], v[24:25], v[28:29]
    v_pk_add_f32 v[32:33], v[32:33], v[36:37]
    v_pk_add_f32 v[26:27], v[26:27], v[30:31]
    v_pk_add_f32 v[34:35], v[34:35], v[38:39]
    v_pk_add_f32 v[24:25], v[24:25], v[32:33]
    v_pk_add_f32 v[26:27], v[26:27], v[34:35]
    v_pk_fma_f32 v[24:25], v[24:25], v[206:207], v[4:5] op_sel:[0,1,0]
    v_pk_fma_f32 v[26:27], v[26:27], v[206:207], v[6:7] op_sel:[0,1,0]
    v_cvt_pk_bf16_f32 v28, v24, v25
    v_cvt_pk_bf16_f32 v29, v26, v27
    buffer_store_short v28, v231, s[28:31], 0 offen
    v_add_u32 v3, 1152, v231
    buffer_store_short_d16_hi v28, v3, s[28:31], 0 offen
    buffer_store_short v29, v231, s[28:31], 0 offen offset:2304
    buffer_store_short_d16_hi v29, v3, s[28:31], 0 offen offset:2304
    v_lshlrev_b32 v4, 16, v200
    v_and_b32 v5, 0xffff0000, v200
    v_lshlrev_b32 v6, 16, v201
    v_and_b32 v7, 0xffff0000, v201
    v_pk_add_f32 v[40:41], v[40:41], v[44:45]
    v_pk_add_f32 v[48:49], v[48:49], v[52:53]
    v_pk_add_f32 v[42:43], v[42:43], v[46:47]
    v_pk_add_f32 v[50:51], v[50:51], v[54:55]
    v_pk_add_f32 v[40:41], v[40:41], v[48:49]
    v_pk_add_f32 v[42:43], v[42:43], v[50:51]
    v_pk_fma_f32 v[40:41], v[40:41], v[208:209], v[4:5] op_sel_hi:[1,0,1]
    v_pk_fma_f32 v[42:43], v[42:43], v[208:209], v[6:7] op_sel_hi:[1,0,1]
    v_cvt_pk_bf16_f32 v44, v40, v41
    v_cvt_pk_bf16_f32 v45, v42, v43
    buffer_store_short v44, v232, s[28:31], 0 offen
    v_add_u32 v3, 1152, v232
    buffer_store_short_d16_hi v44, v3, s[28:31], 0 offen
    buffer_store_short v45, v232, s[28:31], 0 offen offset:2304
    buffer_store_short_d16_hi v45, v3, s[28:31], 0 offen offset:2304
    v_lshlrev_b32 v4, 16, v202
    v_and_b32 v5, 0xffff0000, v202
    v_lshlrev_b32 v6, 16, v203
    v_and_b32 v7, 0xffff0000, v203
    v_pk_add_f32 v[56:57], v[56:57], v[60:61]
    v_pk_add_f32 v[64:65], v[64:65], v[68:69]
    v_pk_add_f32 v[58:59], v[58:59], v[62:63]
    v_pk_add_f32 v[66:67], v[66:67], v[70:71]
    v_pk_add_f32 v[56:57], v[56:57], v[64:65]
    v_pk_add_f32 v[58:59], v[58:59], v[66:67]
    v_pk_fma_f32 v[56:57], v[56:57], v[208:209], v[4:5] op_sel:[0,1,0]
    v_pk_fma_f32 v[58:59], v[58:59], v[208:209], v[6:7] op_sel:[0,1,0]
    v_cvt_pk_bf16_f32 v60, v56, v57
    v_cvt_pk_bf16_f32 v61, v58, v59
    buffer_store_short v60, v233, s[28:31], 0 offen
    v_add_u32 v3, 1152, v233
    buffer_store_short_d16_hi v60, v3, s[28:31], 0 offen
    buffer_store_short v61, v233, s[28:31], 0 offen offset:2304
    buffer_store_short_d16_hi v61, v3, s[28:31], 0 offen offset:2304
    s_cmp_ge_u32 s18, 2
    s_cbranch_scc1 back_kernel_fin
    v_lshlrev_b32 v4, 16, v204
    v_and_b32 v5, 0xffff0000, v204
    v_lshlrev_b32 v6, 16, v205
    v_and_b32 v7, 0xffff0000, v205
    v_pk_add_f32 v[72:73], v[72:73], v[76:77]
    v_pk_add_f32 v[80:81], v[80:81], v[84:85]
    v_pk_add_f32 v[74:75], v[74:75], v[78:79]
    v_pk_add_f32 v[82:83], v[82:83], v[86:87]
    v_pk_add_f32 v[72:73], v[72:73], v[80:81]
    v_pk_add_f32 v[74:75], v[74:75], v[82:83]
    v_pk_fma_f32 v[72:73], v[72:73], v[210:211], v[4:5] op_sel_hi:[1,0,1]
    v_pk_fma_f32 v[74:75], v[74:75], v[210:211], v[6:7] op_sel_hi:[1,0,1]
    v_cvt_pk_bf16_f32 v76, v72, v73
    v_cvt_pk_bf16_f32 v77, v74, v75
    buffer_store_short v76, v234, s[28:31], 0 offen
    v_add_u32 v3, 1152, v234
    buffer_store_short_d16_hi v76, v3, s[28:31], 0 offen
    buffer_store_short v77, v234, s[28:31], 0 offen offset:2304
    buffer_store_short_d16_hi v77, v3, s[28:31], 0 offen offset:2304
back_kernel_fin:
back_kernel_end:
    s_endpgm

.section .rodata,"a"
.p2align 6
.amdhsa_kernel front_kernel
  .amdhsa_next_free_vgpr 160
  .amdhsa_next_free_sgpr 96
  .amdhsa_accum_offset 160
  .amdhsa_group_segment_fixed_size 0
  .amdhsa_kernarg_size 152
  .amdhsa_user_sgpr_count 2
  .amdhsa_user_sgpr_kernarg_segment_ptr 1
  .amdhsa_system_sgpr_workgroup_id_x 1
  .amdhsa_float_denorm_mode_32 3
.end_amdhsa_kernel
.p2align 6
.amdhsa_kernel back_kernel
  .amdhsa_next_free_vgpr 256
  .amdhsa_next_free_sgpr 96
  .amdhsa_accum_offset 256
  .amdhsa_group_segment_fixed_size 0
  .amdhsa_kernarg_size 152
  .amdhsa_user_sgpr_count 2
  .amdhsa_user_sgpr_kernarg_segment_ptr 1
  .amdhsa_system_sgpr_workgroup_id_x 1
  .amdhsa_float_denorm_mode_32 3
.end_amdhsa_kernel
```
